```python
import torch

def _softmax(x, axis=-1):
    return torch.softmax(x, dim=axis)
def _gelu(x):
    return torch.nn.functional.gelu(x, approximate="tanh")
def _silu(x):
    return torch.nn.functional.silu(x)
def _sigmoid(x):
    return torch.sigmoid(x)
def _layernorm(x, axis=-1, eps=1e-5):
    m = x.mean(dim=axis, keepdim=True)
    v = x.var(dim=axis, keepdim=True, unbiased=False)
    return (x - m) / torch.sqrt(v + eps)
def _scatter_add(tgt, idx, src, axis=0):
    return tgt.clone().index_add_(axis, idx, src)
def _segment_sum(src, seg, n):
    out = torch.zeros((n,) + src.shape[1:], dtype=src.dtype)
    return out.index_add_(0, seg, src)
def _pad(x, pw):
    flat = tuple(v for pair in reversed(pw) for v in pair)
    return torch.nn.functional.pad(x, flat)

kernel_name = 'standalone__dense_activation_gelu__prompt'

def setup_inputs():

    _w = (lambda a: (lambda t: t.to(torch.bfloat16) if t.is_floating_point() else t)(torch.as_tensor(a)))
    B, S, D, F = 1, 2048, 576, 4608
    return {
        "x": _w((lambda *s: torch.randn(*s, dtype=torch.bfloat16) * 0.05)(B, S, D)),
        "w1": _w((lambda *s: torch.randn(*s, dtype=torch.bfloat16) * 3.2)(D, F) * (D ** -0.5)),
        "b1": _w((lambda *s: torch.randn(*s, dtype=torch.bfloat16) * 3.2)(F) * 0.01),
        "w2": _w((lambda *s: torch.randn(*s, dtype=torch.bfloat16) * 0.05)(F, D) * (F ** -0.5)),
        "b2": _w((lambda *s: torch.randn(*s, dtype=torch.bfloat16) * 0.1)(D) * 0.01),
    }

def reference(x, w1, b1, w2, b2):
    h = torch.einsum("bsd,df->bsf", x, w1) + b1
    h = _gelu(h)
    return torch.einsum("bsf,fd->bsd", h, w2) + b2
```

```asm
; @launch grid=(256,1,1) block=(512,1,1) lds=163840
.amdgcn_target "amdgcn-amd-amdhsa--gfx950"
.text
.globl standalone__dense_activation_gelu__prompt_kernel
.p2align 8
.type standalone__dense_activation_gelu__prompt_kernel,@function
standalone__dense_activation_gelu__prompt_kernel:
    s_cmp_ge_u32 s2, 256
    s_cbranch_scc1 L_main_end
    s_load_dwordx16 s[4:19], s[0:1], 0
    v_lshrrev_b32 v6, 6, v0
    v_and_b32 v1, 63, v0
    v_readfirstlane_b32 s40, v6
    s_and_b32 s51, s2, 7
    s_lshr_b32 s52, s2, 3
    s_and_b32 s42, s51, 1
    s_lshl_b32 s42, s42, 3
    s_lshr_b32 s43, s52, 2
    s_add_u32 s42, s42, s43
    s_lshr_b32 s43, s51, 1
    s_lshl_b32 s43, s43, 2
    s_and_b32 s52, s52, 3
    s_add_u32 s43, s43, s52
    s_and_b32 s41, s40, 3
    s_and_b32 s55, s43, 1
    s_lshl_b32 s44, s55, 5
    s_lshl_b32 s51, s42, 7
    s_lshl_b32 s52, s41, 5
    s_add_u32 s51, s51, s52
    s_mul_i32 s46, s51, 1152
    s_lshl_b32 s49, s41, 12
    s_lshl_b32 s50, s41, 11
    s_mul_i32 s96, s43, 576
    s_mul_i32 s52, s41, 147456
    s_add_u32 s47, s96, s52
    s_lshl_b32 s52, s44, 1
    s_add_u32 s47, s47, s52
    s_mul_i32 s51, s43, 9
    s_add_u32 s51, s51, 1
    s_lshr_b32 s51, s51, 1
    s_sub_u32 s51, 3, s51
    s_and_b32 s51, s51, 7
    s_cmp_lt_u32 s51, 2
    s_cselect_b32 s53, 2, 0
    s_lshl_b32 s52, s53, 7
    s_sub_u32 s84, s47, s52
    s_add_u32 s47, s47, s52
    v_lshrrev_b32 v6, 3, v1
    v_mul_u32_u24 v3, 1152, v6
    v_mul_u32_u24 v20, 9216, v6
    v_mov_b32 v5, v3
    v_lshrrev_b32 v6, 4, v1
    v_and_b32 v7, 7, v1
    v_xor_b32 v4, v6, v7
    v_lshl_add_u32 v3, v4, 4, v3
    v_xor_b32 v4, 64, v3
    v_add_u32 v4, 8192, v4
    v_and_b32 v6, 1, v6
    v_lshlrev_b32 v6, 1, v6
    v_xor_b32 v7, v6, v7
    v_lshl_add_u32 v20, v7, 4, v20
    v_lshlrev_b32 v24, 1, v0
    s_getpc_b64 s[72:73]
L_pc:
    s_sub_u32 s72, s72, L_pc-standalone__dense_activation_gelu__prompt_kernel
    s_subb_u32 s73, s73, 0
    s_lshr_b32 s97, s2, 3
    s_lshl_b32 s97, s97, 3
    s_add_u32 s97, s97, s40
    s_lshl_b32 s97, s97, 8
    v_and_b32 v54, 1, v1
    v_lshl_add_u32 v54, v54, 7, s97
    v_min_u32 v54, L_main_end-standalone__dense_activation_gelu__prompt_kernel, v54
    global_load_dword v255, v54, s[72:73]
    s_waitcnt lgkmcnt(0)
    s_mov_b32 s20, s4
    s_mov_b32 s21, s5
    s_mov_b32 s22, 2359296
    s_mov_b32 s23, 0x20000
    s_mov_b32 s24, s6
    s_mov_b32 s25, s7
    s_mov_b32 s26, 5308416
    s_mov_b32 s27, 0x20000
    s_cmp_ge_u32 s40, 4
    s_cbranch_scc1 L_half1
    s_add_u32 m0, s49, 57344
    s_add_u32 s51, s46, 0
    buffer_load_dwordx4 v3, s[20:23], s51 offen lds
    buffer_load_dwordx4 v4, s[20:23], s51 offen offset:1024 lds
    s_add_u32 m0, s50, 0
    s_add_u32 s51, s47, 0
    buffer_load_dwordx4 v20, s[24:27], s51 offen lds
    s_add_u32 m0, s49, 73728
    s_add_u32 s51, s46, 128
    buffer_load_dwordx4 v3, s[20:23], s51 offen lds
    buffer_load_dwordx4 v4, s[20:23], s51 offen offset:1024 lds
    s_add_u32 m0, s50, 8192
    s_add_u32 s51, s47, 589824
    buffer_load_dwordx4 v20, s[24:27], s51 offen lds
    s_add_u32 m0, s49, 90112
    s_add_u32 s51, s46, 256
    buffer_load_dwordx4 v3, s[20:23], s51 offen lds
    buffer_load_dwordx4 v4, s[20:23], s51 offen offset:1024 lds
    s_add_u32 m0, s50, 16384
    s_add_u32 s51, s47, 1179648
    buffer_load_dwordx4 v20, s[24:27], s51 offen lds
    s_mov_b32 s99, s53
    s_mov_b32 s36, s8
    s_mov_b32 s37, s9
    s_mov_b32 s38, 9216
    s_mov_b32 s39, 0x20000
    buffer_load_ushort v31, v24, s[36:39], s96 offen
    v_bfe_u32 v48, v1, 2, 2
    v_and_b32 v49, 3, v1
    v_lshrrev_b32 v50, 4, v1
    v_and_b32 v52, 15, v1
    v_lshl_add_u32 v51, v50, 3, v48
    v_lshlrev_b32 v6, 3, v49
    v_lshl_add_u32 v8, v51, 7, v6
    v_and_b32 v6, 1, v50
    v_lshrrev_b32 v7, 1, v48
    v_lshl_add_u32 v7, v6, 1, v7
    v_lshl_add_u32 v8, v7, 5, v8
    v_xor_b32 v11, 32, v8
    v_and_b32 v7, 1, v49
    v_lshl_add_u32 v7, v7, 1, v6
    v_lshlrev_b32 v7, 4, v7
    v_lshl_add_u32 v25, v51, 6, v7
    v_lshrrev_b32 v7, 1, v49
    v_lshl_add_u32 v25, v7, 3, v25
    v_add_u32 v9, 65536, v8
    v_add_u32 v12, 65536, v11
    v_add_u32 v26, 65536, v25
    v_add_u32 v10, 131072, v8
    v_add_u32 v13, 131072, v11
    v_add_u32 v27, 131072, v25
    v_lshrrev_b32 v7, 1, v52
    v_xor_b32 v7, v7, v50
    v_lshlrev_b32 v7, 4, v7
    v_lshl_add_u32 v7, v52, 7, v7
    v_add_u32 v7, s49, v7
    v_xor_b32 v51, 64, v7
    v_add_u32 v32, 57344, v7
    v_add_u32 v34, 122880, v7
    v_add_u32 v33, 57344, v51
    v_add_u32 v35, 122880, v51
    s_xor_b32 s52, s55, 1
    s_lshl_b32 s45, s52, 8
    v_lshlrev_b32 v2, 4, v1
    v_mov_b32 v23, 0xc0135761
    s_mov_b32 s53, 0xbdd2d3e8
    s_lshr_b32 s54, s43, 2
    s_bfe_u32 s90, s43, 0x10001
    s_mul_i32 s52, s41, 294912
    s_add_u32 s48, s96, s52
    s_lshl_b32 s52, s45, 1
    s_add_u32 s48, s48, s52
    v_lshrrev_b32 v51, 2, v1
    v_mul_u32_u24 v21, 9216, v51
    v_mul_u32_u24 v47, 1152, v51
    v_lshrrev_b32 v7, 5, v1
    v_xor_b32 v7, v7, v49
    v_lshl_add_u32 v21, v7, 4, v21
    v_bfe_u32 v7, v1, 1, 2
    v_xor_b32 v7, v7, v50
    v_lshl_add_u32 v5, v7, 5, v5
    v_and_b32 v7, 1, v7
    v_lshl_add_u32 v47, v7, 5, v47
    v_and_b32 v7, 1, v1
    v_lshl_add_u32 v5, v7, 4, v5
    v_lshl_add_u32 v47, v7, 4, v47
    v_add_u32 v28, s50, v2
    v_add_u32 v29, 65536, v28
    v_add_u32 v30, 131072, v28
    v_lshlrev_b32 v22, 4, v52
    v_lshl_add_u32 v22, v6, 10, v22
    v_lshrrev_b32 v7, 1, v50
    v_lshl_add_u32 v22, v7, 8, v22
    v_add_u32 v22, s50, v22
    v_add_u32 v22, 147456, v22
    v_lshrrev_b32 v51, 2, v1
    v_lshlrev_b32 v7, 3, v49
    v_lshl_add_u32 v14, v51, 7, v7
    v_bfe_u32 v7, v1, 3, 2
    v_xor_b32 v7, 2, v7
    s_lshl_b32 s97, s90, 1
    v_xor_b32 v7, s97, v7
    v_lshl_add_u32 v14, v7, 5, v14
    v_xor_b32 v17, 64, v14
    v_add_u32 v15, 65536, v14
    v_add_u32 v16, 131072, v14
    v_add_u32 v18, 65536, v17
    v_add_u32 v19, 131072, v17
    s_mov_b32 s28, s10
    s_mov_b32 s29, s11
    s_mov_b32 s30, 5308416
    s_mov_b32 s31, 0x20000
    s_mov_b32 s32, s18
    s_mov_b32 s33, s19
    s_mov_b32 s34, 38010880
    s_mov_b32 s35, 0x20000
    s_mov_b32 s4, s12
    s_mov_b32 s5, s13
    s_mov_b32 s6, 1152
    s_mov_b32 s7, 0x20000
    s_mov_b32 s8, s14
    s_mov_b32 s9, s15
    s_mov_b32 s10, 2359296
    s_mov_b32 s11, 0x20000
    s_add_u32 s72, s54, 1
    s_and_b32 s72, s72, 3
    s_add_u32 s73, s54, 2
    s_and_b32 s73, s73, 3
    s_add_u32 s74, s54, 3
    s_and_b32 s74, s74, 3
    s_mov_b32 s75, s54
    s_lshr_b32 s89, s43, 1
    s_mul_i32 s96, s89, 576
    s_mul_i32 s92, s55, 640
    s_mul_i32 s97, s55, 320
    s_add_u32 s97, s97, s96
    s_lshl_b32 s93, s41, 5
    s_add_u32 s93, s93, s97
    s_mul_i32 s68, s93, 1152
    s_lshl_b32 s93, s41, 4
    s_add_u32 s97, s97, s93
    s_mul_i32 s97, s97, 1152
    s_add_u32 s97, s97, s92
    s_lshl_b32 s93, s72, 7
    s_add_u32 s56, s97, s93
    s_lshl_b32 s93, s73, 7
    s_add_u32 s57, s97, s93
    s_lshl_b32 s93, s74, 7
    s_add_u32 s58, s97, s93
    s_lshl_b32 s93, s75, 7
    s_add_u32 s59, s97, s93
    s_xor_b32 s97, s55, 1
    s_mul_i32 s97, s97, 320
    s_add_u32 s97, s97, s96
    s_lshl_b32 s93, s41, 5
    s_add_u32 s93, s93, s97
    s_mul_i32 s69, s93, 1152
    s_lshl_b32 s93, s41, 4
    s_add_u32 s97, s97, s93
    s_mul_i32 s97, s97, 1152
    s_add_u32 s97, s97, s92
    s_lshl_b32 s93, s72, 7
    s_add_u32 s60, s97, s93
    s_lshl_b32 s93, s73, 7
    s_add_u32 s61, s97, s93
    s_lshl_b32 s93, s74, 7
    s_add_u32 s62, s97, s93
    s_lshl_b32 s93, s75, 7
    s_add_u32 s63, s97, s93
    s_and_b32 s97, s41, 1
    s_xor_b32 s93, s97, s55
    s_lshl_b32 s93, s93, 5
    s_add_u32 s93, s93, s96
    s_add_u32 s93, s93, 256
    s_mul_i32 s70, s93, 1152
    s_lshl_b32 s97, s97, 4
    s_lshr_b32 s93, s41, 1
    s_xor_b32 s93, s93, s55
    s_lshl_b32 s93, s93, 5
    s_add_u32 s97, s97, s93
    s_add_u32 s97, s97, s96
    s_add_u32 s97, s97, 256
    s_mul_i32 s97, s97, 1152
    s_add_u32 s97, s97, s92
    s_lshl_b32 s93, s72, 7
    s_add_u32 s64, s97, s93
    s_lshl_b32 s93, s73, 7
    s_add_u32 s65, s97, s93
    s_lshl_b32 s93, s74, 7
    s_add_u32 s66, s97, s93
    s_lshl_b32 s93, s75, 7
    s_add_u32 s67, s97, s93
    s_lshl_b32 s93, s55, 6
    s_add_u32 s93, s93, 512
    s_add_u32 s68, s68, s93
    s_add_u32 s69, s69, s93
    s_add_u32 s70, s70, s93
    s_xor_b32 s52, s43, 1
    s_mul_i32 s52, s52, 9
    s_add_u32 s52, s52, 1
    s_lshr_b32 s52, s52, 1
    s_sub_u32 s52, 3, s52
    s_and_b32 s52, s52, 7
    s_cmp_lt_u32 s52, 2
    s_cselect_b32 s52, 2, 0
    s_mul_i32 s93, s99, 73728
    s_sub_u32 s12, s56, s93
    s_add_u32 s56, s56, s93
    s_sub_u32 s13, s57, s93
    s_add_u32 s57, s57, s93
    s_sub_u32 s14, s58, s93
    s_add_u32 s58, s58, s93
    s_sub_u32 s15, s59, s93
    s_add_u32 s59, s59, s93
    s_sub_u32 s85, s68, s93
    s_add_u32 s68, s68, s93
    s_mul_i32 s93, s52, 73728
    s_sub_u32 s16, s60, s93
    s_add_u32 s60, s60, s93
    s_sub_u32 s17, s61, s93
    s_add_u32 s61, s61, s93
    s_sub_u32 s18, s62, s93
    s_add_u32 s62, s62, s93
    s_sub_u32 s19, s63, s93
    s_add_u32 s63, s63, s93
    s_sub_u32 s86, s69, s93
    s_add_u32 s69, s69, s93
    s_lshl_b32 s96, s42, 1
    s_add_u32 s96, s96, s55
    s_mul_i32 s96, s96, 72
    s_lshl_b32 s92, s89, 10
    s_add_u32 s97, s96, s40
    s_add_u32 s93, s97, 64
    s_lshl_b32 s93, s93, 13
    s_add_u32 s71, s93, s92
    s_add_u32 s97, s97, s40
    s_lshl_b32 s93, s97, 13
    s_add_u32 s93, s93, s92
    s_lshl_b32 s72, s72, 17
    s_add_u32 s72, s72, s93
    s_lshl_b32 s73, s73, 17
    s_add_u32 s73, s73, s93
    s_lshl_b32 s74, s74, 17
    s_add_u32 s74, s74, s93
    s_lshl_b32 s75, s75, 17
    s_add_u32 s75, s75, s93
    s_lshl_b32 s81, s90, 13
    s_xor_b32 s80, s81, 8192
    s_lshl_b32 s93, s54, 4
    s_add_u32 s97, s97, s93
    s_add_u32 s97, s97, s90
    s_lshl_b32 s97, s97, 13
    s_sub_u32 s93, s54, 1
    s_and_b32 s93, s93, 3
    s_lshl_b32 s93, s93, 11
    s_add_u32 s77, s97, s93
    s_sub_u32 s93, s54, 2
    s_and_b32 s93, s93, 3
    s_lshl_b32 s93, s93, 11
    s_add_u32 s78, s97, s93
    s_sub_u32 s93, s54, 3
    s_and_b32 s93, s93, 3
    s_lshl_b32 s93, s93, 11
    s_add_u32 s79, s97, s93
    s_xor_b32 s93, s92, 1024
    s_add_u32 s76, s97, s93
    s_add_u32 s96, s96, s89
    s_add_u32 s96, s96, 64
    s_lshl_b32 s92, s96, 13
    s_lshl_b32 s96, s42, 4
    s_add_u32 s96, s96, s43
    s_xor_b32 s97, s96, 1
    s_mul_i32 s96, s96, 73728
    s_add_u32 s82, s96, 18874368
    s_mul_i32 s97, s97, 73728
    s_add_u32 s97, s97, 18874368
    s_add_u32 s83, s97, s50
    s_mov_b32 s3, 0xffff0000
    v_lshrrev_b32 v7, 3, v1
    v_and_b32 v51, 7, v1
    s_lshl_b32 s96, s40, 7
    v_lshl_add_u32 v7, v7, 10, s96
    v_lshl_add_u32 v40, v51, 4, v7
    v_lshl_add_u32 v7, v6, 4, v52
    v_mul_u32_u24 v41, 1152, v7
    v_lshrrev_b32 v7, 1, v50
    v_lshl_add_u32 v41, v7, 4, v41
    v_lshlrev_b32 v7, 3, v50
    s_lshl_b32 s96, s54, 7
    s_lshl_b32 s97, s90, 6
    s_add_u32 s96, s96, s97
    s_add_u32 s96, s96, 0
    s_mul_i32 s97, s55, 640
    s_add_u32 s96, s96, s97
    s_add_u32 s94, s46, s96
    buffer_load_dwordx2 v[42:43], v7, s[4:7], s96 offen
    s_and_b32 s96, s40, 1
    s_lshl_b32 s96, s96, 3
    v_add_u32 v51, s96, v51
    v_lshrrev_b32 v7, 5, v1
    v_lshl_add_u32 v51, v7, 4, v51
    v_mul_u32_u24 v51, 1152, v51
    v_lshlrev_b32 v7, 2, v6
    v_add_u32 v44, v51, v7
    s_lshr_b32 s96, s89, 2
    s_lshl_b32 s96, s96, 5
    s_lshl_b32 s97, s55, 6
    s_add_u32 s96, s96, s97
    s_lshr_b32 s97, s40, 1
    s_lshl_b32 s97, s97, 3
    s_add_u32 s96, s96, s97
    s_add_u32 s96, s96, 512
    buffer_load_dword v45, v7, s[4:7], s96 offen
    s_and_b32 s97, s89, 3
    s_lshl_b32 s97, s97, 5
    s_lshl_b32 s95, s42, 7
    s_add_u32 s97, s97, s95
    s_mul_i32 s97, s97, 1152
    s_add_u32 s95, s97, s96
    v_and_b32 v51, 8, v1
    v_cmp_eq_u32 vcc, 0, v51
    v_mov_b32 v7, 1073741824
    s_nop 0
    v_cndmask_b32 v44, v7, v44, vcc
    s_lshl_b32 s96, s44, 2
    s_add_u32 s96, s96, 155648
    s_lshl_b32 s38, s99, 8
    s_add_u32 s96, s96, s38
    s_lshl_b32 s38, s38, 1
    s_lshl_b32 s97, s45, 2
    s_add_u32 s97, s97, 155648
    v_lshl_add_u32 v24, v50, 4, s96
    v_lshrrev_b32 v53, 1, v50
    v_lshl_add_u32 v53, v53, 4, s97
    v_lshlrev_b32 v54, 2, v0
    v_add_u32 v54, 155648, v54
    s_waitcnt vmcnt(2)
    v_lshlrev_b32 v55, 16, v31
    ds_write_b32 v54, v55 offset:0
    v_lshl_add_u32 v31, v6, 6, v53
    s_add_u32 m0, s49, 106496
    s_add_u32 s51, s46, 384
    buffer_load_dwordx4 v3, s[20:23], s51 offen lds
    buffer_load_dwordx4 v4, s[20:23], s51 offen offset:1024 lds
    s_add_u32 m0, s50, 24576
    s_add_u32 s51, s47, 1769472
    buffer_load_dwordx4 v20, s[24:27], s51 offen lds
    s_add_u32 m0, s49, 122880
    s_add_u32 s51, s46, 512
    buffer_load_dwordx4 v3, s[20:23], s51 offen lds
    buffer_load_dwordx4 v4, s[20:23], s51 offen offset:1024 lds
    s_add_u32 m0, s50, 32768
    s_add_u32 s51, s47, 2359296
    buffer_load_dwordx4 v20, s[24:27], s51 offen lds
    s_waitcnt lgkmcnt(0)
    s_barrier
    ds_read_b128 v[80:83], v24 offset:0
    ds_read_b128 v[84:87], v24 offset:64
    ds_read_b128 v[88:91], v24 offset:0
    ds_read_b128 v[92:95], v24 offset:64
    ds_read_b128 v[112:115], v32 offset:0
    ds_read_b64_tr_b16 v[64:65], v8 offset:0
    ds_read_b64_tr_b16 v[66:67], v8 offset:512
    ds_read_b128 v[120:123], v33 offset:0
    ds_read_b64_tr_b16 v[68:69], v8 offset:4096
    ds_read_b64_tr_b16 v[70:71], v8 offset:4608
    ds_read_b128 v[116:119], v32 offset:2048
    ds_read_b64_tr_b16 v[72:73], v11 offset:0
    ds_read_b64_tr_b16 v[74:75], v11 offset:512
    ds_read_b128 v[124:127], v33 offset:2048
    ds_read_b64_tr_b16 v[76:77], v11 offset:4096
    ds_read_b64_tr_b16 v[78:79], v11 offset:4608
    s_waitcnt lgkmcnt(9)
    v_mfma_f32_16x16x32_bf16 v[80:83], v[64:67], v[112:115], v[80:83]
    s_barrier
    ds_read_b64_tr_b16 v[36:37], v8 offset:8192
    ds_read_b128 v[128:131], v32 offset:16384
    s_add_u32 m0, s49, 139264
    s_add_u32 s51, s46, 640
    buffer_load_dwordx4 v3, s[20:23], s51 offen lds
    s_waitcnt lgkmcnt(8)
    v_mfma_f32_16x16x32_bf16 v[80:83], v[68:71], v[120:123], v[80:83]
    ds_read_b64_tr_b16 v[38:39], v8 offset:8704
    s_waitcnt lgkmcnt(8)
    v_mfma_f32_16x16x32_bf16 v[88:91], v[64:67], v[116:119], v[88:91]
    ds_read_b64_tr_b16 v[64:65], v8 offset:12288
    ds_read_b128 v[136:139], v33 offset:16384
    buffer_load_dwordx4 v4, s[20:23], s51 offen offset:1024 lds
    s_waitcnt lgkmcnt(7)
    v_mfma_f32_16x16x32_bf16 v[88:91], v[68:71], v[124:127], v[88:91]
    ds_read_b64_tr_b16 v[66:67], v8 offset:12800
    v_mfma_f32_16x16x32_bf16 v[84:87], v[72:75], v[112:115], v[84:87]
    ds_read_b64_tr_b16 v[68:69], v11 offset:8192
    ds_read_b128 v[132:135], v32 offset:18432
    s_waitcnt lgkmcnt(8)
    v_mfma_f32_16x16x32_bf16 v[84:87], v[76:79], v[120:123], v[84:87]
    ds_read_b64_tr_b16 v[70:71], v11 offset:8704
    s_add_u32 m0, s50, 40960
    s_add_u32 s51, s47, 2949120
    buffer_load_dwordx4 v20, s[24:27], s51 offen lds
    v_mfma_f32_16x16x32_bf16 v[92:95], v[72:75], v[116:119], v[92:95]
    ds_read_b64_tr_b16 v[72:73], v11 offset:12288
    ds_read_b128 v[140:143], v33 offset:18432
    v_mfma_f32_16x16x32_bf16 v[92:95], v[76:79], v[124:127], v[92:95]
    ds_read_b64_tr_b16 v[74:75], v11 offset:12800
    s_waitcnt lgkmcnt(6)
    v_mfma_f32_16x16x32_bf16 v[80:83], v[36:39], v[128:131], v[80:83]
    s_barrier
    ds_read_b64_tr_b16 v[76:77], v8 offset:16384
    ds_read_b128 v[144:147], v32 offset:32768
    s_add_u32 m0, s49, 57344
    s_add_u32 s51, s46, 768
    buffer_load_dwordx4 v3, s[20:23], s51 offen lds
    v_mfma_f32_16x16x32_bf16 v[80:83], v[64:67], v[136:139], v[80:83]
    ds_read_b64_tr_b16 v[78:79], v8 offset:16896
    s_waitcnt lgkmcnt(4)
    v_mfma_f32_16x16x32_bf16 v[88:91], v[36:39], v[132:135], v[88:91]
    ds_read_b64_tr_b16 v[36:37], v8 offset:20480
    ds_read_b128 v[152:155], v33 offset:32768
    buffer_load_dwordx4 v4, s[20:23], s51 offen offset:1024 lds
    v_mfma_f32_16x16x32_bf16 v[88:91], v[64:67], v[140:143], v[88:91]
    ds_read_b64_tr_b16 v[38:39], v8 offset:20992
    s_waitcnt lgkmcnt(6)
    v_mfma_f32_16x16x32_bf16 v[84:87], v[68:71], v[128:131], v[84:87]
    ds_read_b64_tr_b16 v[64:65], v11 offset:16384
    ds_read_b128 v[148:151], v32 offset:34816
    v_mfma_f32_16x16x32_bf16 v[84:87], v[72:75], v[136:139], v[84:87]
    ds_read_b64_tr_b16 v[66:67], v11 offset:16896
    s_add_u32 m0, s50, 0
    s_add_u32 s51, s47, 3538944
    buffer_load_dwordx4 v20, s[24:27], s51 offen lds
    v_mfma_f32_16x16x32_bf16 v[92:95], v[68:71], v[132:135], v[92:95]
    ds_read_b64_tr_b16 v[68:69], v11 offset:20480
    ds_read_b128 v[156:159], v33 offset:34816
    v_mfma_f32_16x16x32_bf16 v[92:95], v[72:75], v[140:143], v[92:95]
    ds_read_b64_tr_b16 v[70:71], v11 offset:20992
    s_waitcnt lgkmcnt(6)
    v_mfma_f32_16x16x32_bf16 v[80:83], v[76:79], v[144:147], v[80:83]
    s_waitcnt vmcnt(9)
    s_barrier
    ds_read_b64_tr_b16 v[72:73], v8 offset:24576
    ds_read_b128 v[160:163], v32 offset:49152
    s_add_u32 m0, s49, 73728
    s_add_u32 s51, s46, 896
    buffer_load_dwordx4 v3, s[20:23], s51 offen lds
    v_mfma_f32_16x16x32_bf16 v[80:83], v[36:39], v[152:155], v[80:83]
    ds_read_b64_tr_b16 v[74:75], v8 offset:25088
    s_waitcnt lgkmcnt(4)
    v_mfma_f32_16x16x32_bf16 v[88:91], v[76:79], v[148:151], v[88:91]
    ds_read_b64_tr_b16 v[76:77], v8 offset:28672
    ds_read_b128 v[168:171], v33 offset:49152
    buffer_load_dwordx4 v4, s[20:23], s51 offen offset:1024 lds
    v_mfma_f32_16x16x32_bf16 v[88:91], v[36:39], v[156:159], v[88:91]
    ds_read_b64_tr_b16 v[78:79], v8 offset:29184
    s_waitcnt lgkmcnt(6)
    v_mfma_f32_16x16x32_bf16 v[84:87], v[64:67], v[144:147], v[84:87]
    ds_read_b64_tr_b16 v[36:37], v11 offset:24576
    ds_read_b128 v[164:167], v32 offset:51200
    v_mfma_f32_16x16x32_bf16 v[84:87], v[68:71], v[152:155], v[84:87]
    ds_read_b64_tr_b16 v[38:39], v11 offset:25088
    s_add_u32 m0, s50, 8192
    s_add_u32 s51, s47, 4128768
    buffer_load_dwordx4 v20, s[24:27], s51 offen lds
    v_mfma_f32_16x16x32_bf16 v[92:95], v[64:67], v[148:151], v[92:95]
    ds_read_b64_tr_b16 v[64:65], v11 offset:28672
    ds_read_b128 v[172:175], v33 offset:51200
    v_mfma_f32_16x16x32_bf16 v[92:95], v[68:71], v[156:159], v[92:95]
    ds_read_b64_tr_b16 v[66:67], v11 offset:29184
    s_waitcnt lgkmcnt(6)
    v_mfma_f32_16x16x32_bf16 v[80:83], v[72:75], v[160:163], v[80:83]
    s_waitcnt vmcnt(9)
    s_barrier
    ds_read_b64_tr_b16 v[68:69], v8 offset:32768
    ds_read_b128 v[176:179], v34 offset:0
    s_add_u32 m0, s49, 90112
    s_add_u32 s51, s46, 1024
    buffer_load_dwordx4 v3, s[20:23], s51 offen lds
    v_mfma_f32_16x16x32_bf16 v[80:83], v[76:79], v[168:171], v[80:83]
    ds_read_b64_tr_b16 v[70:71], v8 offset:33280
    s_waitcnt lgkmcnt(4)
    v_mfma_f32_16x16x32_bf16 v[88:91], v[72:75], v[164:167], v[88:91]
    ds_read_b64_tr_b16 v[72:73], v8 offset:36864
    ds_read_b128 v[184:187], v35 offset:0
    buffer_load_dwordx4 v4, s[20:23], s51 offen offset:1024 lds
    v_mfma_f32_16x16x32_bf16 v[88:91], v[76:79], v[172:175], v[88:91]
    ds_read_b64_tr_b16 v[74:75], v8 offset:37376
    s_waitcnt lgkmcnt(6)
    v_mfma_f32_16x16x32_bf16 v[84:87], v[36:39], v[160:163], v[84:87]
    ds_read_b64_tr_b16 v[76:77], v11 offset:32768
    ds_read_b128 v[180:183], v34 offset:2048
    v_mfma_f32_16x16x32_bf16 v[84:87], v[64:67], v[168:171], v[84:87]
    ds_read_b64_tr_b16 v[78:79], v11 offset:33280
    s_add_u32 m0, s50, 16384
    s_add_u32 s51, s47, 4718592
    buffer_load_dwordx4 v20, s[24:27], s51 offen lds
    v_mfma_f32_16x16x32_bf16 v[92:95], v[36:39], v[164:167], v[92:95]
    ds_read_b64_tr_b16 v[36:37], v11 offset:36864
    ds_read_b128 v[188:191], v35 offset:2048
    v_mfma_f32_16x16x32_bf16 v[92:95], v[64:67], v[172:175], v[92:95]
    ds_read_b64_tr_b16 v[38:39], v11 offset:37376
    s_waitcnt lgkmcnt(6)
    v_mfma_f32_16x16x32_bf16 v[80:83], v[68:71], v[176:179], v[80:83]
    s_waitcnt vmcnt(9)
    s_barrier
    ds_read_b64_tr_b16 v[64:65], v8 offset:40960
    ds_read_b128 v[192:195], v34 offset:16384
    v_xor_b32 v46, 64, v20
    v_add_u32 v46, 72704, v46
    s_add_u32 m0, s50, 24576
    s_add_u32 s51, s47, 128
    buffer_load_dwordx4 v20, s[24:27], s51 offen lds
    v_mfma_f32_16x16x32_bf16 v[80:83], v[72:75], v[184:187], v[80:83]
    ds_read_b64_tr_b16 v[66:67], v8 offset:41472
    s_waitcnt lgkmcnt(4)
    v_mfma_f32_16x16x32_bf16 v[88:91], v[68:71], v[180:183], v[88:91]
    ds_read_b64_tr_b16 v[68:69], v8 offset:45056
    ds_read_b128 v[200:203], v35 offset:16384
    buffer_load_dwordx4 v46, s[24:27], s51 offen offset:1024 lds
    v_mfma_f32_16x16x32_bf16 v[88:91], v[72:75], v[188:191], v[88:91]
    ds_read_b64_tr_b16 v[70:71], v8 offset:45568
    s_waitcnt lgkmcnt(6)
    v_mfma_f32_16x16x32_bf16 v[84:87], v[76:79], v[176:179], v[84:87]
    ds_read_b64_tr_b16 v[72:73], v11 offset:40960
    ds_read_b128 v[196:199], v34 offset:18432
    s_add_u32 m0, s50, 49152
    s_add_u32 s51, s47, 589952
    buffer_load_dwordx4 v20, s[24:27], s51 offen lds
    v_mfma_f32_16x16x32_bf16 v[84:87], v[36:39], v[184:187], v[84:87]
    ds_read_b64_tr_b16 v[74:75], v11 offset:41472
    v_mfma_f32_16x16x32_bf16 v[92:95], v[76:79], v[180:183], v[92:95]
    ds_read_b64_tr_b16 v[76:77], v11 offset:45056
    ds_read_b128 v[204:207], v35 offset:18432
    buffer_load_dwordx4 v46, s[24:27], s51 offen offset:1024 lds
    v_mfma_f32_16x16x32_bf16 v[92:95], v[36:39], v[188:191], v[92:95]
    ds_read_b64_tr_b16 v[78:79], v11 offset:45568
    s_waitcnt lgkmcnt(6)
    v_mfma_f32_16x16x32_bf16 v[80:83], v[64:67], v[192:195], v[80:83]
    s_waitcnt vmcnt(10)
    s_barrier
    ds_read_b64_tr_b16 v[36:37], v8 offset:0
    ds_read_b128 v[208:211], v32 offset:0
    s_add_u32 m0, s50, 32768
    s_add_u32 s51, s47, 1179776
    buffer_load_dwordx4 v20, s[24:27], s51 offen lds
    v_mfma_f32_16x16x32_bf16 v[80:83], v[68:71], v[200:203], v[80:83]
    ds_read_b64_tr_b16 v[38:39], v8 offset:512
    s_waitcnt lgkmcnt(4)
    v_mfma_f32_16x16x32_bf16 v[88:91], v[64:67], v[196:199], v[88:91]
    ds_read_b64_tr_b16 v[64:65], v8 offset:4096
    ds_read_b128 v[216:219], v33 offset:0
    buffer_load_dwordx4 v46, s[24:27], s51 offen offset:1024 lds
    v_mfma_f32_16x16x32_bf16 v[88:91], v[68:71], v[204:207], v[88:91]
    ds_read_b64_tr_b16 v[66:67], v8 offset:4608
    s_waitcnt lgkmcnt(6)
    v_mfma_f32_16x16x32_bf16 v[84:87], v[72:75], v[192:195], v[84:87]
    ds_read_b64_tr_b16 v[68:69], v11 offset:0
    ds_read_b128 v[212:215], v32 offset:2048
    s_add_u32 m0, s50, 106496
    s_add_u32 s51, s47, 1769600
    buffer_load_dwordx4 v20, s[24:27], s51 offen lds
    v_mfma_f32_16x16x32_bf16 v[84:87], v[76:79], v[200:203], v[84:87]
    ds_read_b64_tr_b16 v[70:71], v11 offset:512
    v_mfma_f32_16x16x32_bf16 v[92:95], v[72:75], v[196:199], v[92:95]
    ds_read_b64_tr_b16 v[72:73], v11 offset:4096
    ds_read_b128 v[220:223], v33 offset:2048
    buffer_load_dwordx4 v46, s[24:27], s51 offen offset:1024 lds
    v_mfma_f32_16x16x32_bf16 v[92:95], v[76:79], v[204:207], v[92:95]
    ds_read_b64_tr_b16 v[74:75], v11 offset:4608
    s_waitcnt lgkmcnt(6)
    v_mfma_f32_16x16x32_bf16 v[80:83], v[36:39], v[208:211], v[80:83]
    s_waitcnt vmcnt(11)
    s_barrier
    ds_read_b64_tr_b16 v[76:77], v8 offset:8192
    ds_read_b128 v[224:227], v32 offset:16384
    s_add_u32 m0, s50, 40960
    s_add_u32 s51, s47, 2359424
    buffer_load_dwordx4 v20, s[24:27], s51 offen lds
    v_mfma_f32_16x16x32_bf16 v[80:83], v[64:67], v[216:219], v[80:83]
    ds_read_b64_tr_b16 v[78:79], v8 offset:8704
    s_waitcnt lgkmcnt(4)
    v_mfma_f32_16x16x32_bf16 v[88:91], v[36:39], v[212:215], v[88:91]
    ds_read_b64_tr_b16 v[36:37], v8 offset:12288
    ds_read_b128 v[232:235], v33 offset:16384
    buffer_load_dwordx4 v46, s[24:27], s51 offen offset:1024 lds
    v_mfma_f32_16x16x32_bf16 v[88:91], v[64:67], v[220:223], v[88:91]
    ds_read_b64_tr_b16 v[38:39], v8 offset:12800
    s_waitcnt lgkmcnt(6)
    v_mfma_f32_16x16x32_bf16 v[84:87], v[68:71], v[208:211], v[84:87]
    ds_read_b64_tr_b16 v[64:65], v11 offset:8192
    ds_read_b128 v[228:231], v32 offset:18432
    s_add_u32 m0, s50, 114688
    s_add_u32 s51, s47, 2949248
    buffer_load_dwordx4 v20, s[24:27], s51 offen lds
    v_mfma_f32_16x16x32_bf16 v[84:87], v[72:75], v[216:219], v[84:87]
    ds_read_b64_tr_b16 v[66:67], v11 offset:8704
    v_mfma_f32_16x16x32_bf16 v[92:95], v[68:71], v[212:215], v[92:95]
    ds_read_b64_tr_b16 v[68:69], v11 offset:12288
    ds_read_b128 v[236:239], v33 offset:18432
    buffer_load_dwordx4 v46, s[24:27], s51 offen offset:1024 lds
    v_mfma_f32_16x16x32_bf16 v[92:95], v[72:75], v[220:223], v[92:95]
    ds_read_b64_tr_b16 v[70:71], v11 offset:12800
    s_waitcnt lgkmcnt(6)
    v_mfma_f32_16x16x32_bf16 v[80:83], v[76:79], v[224:227], v[80:83]
    s_waitcnt vmcnt(12)
    s_barrier
    ds_read_b64_tr_b16 v[72:73], v8 offset:16384
    ds_read_b128 v[240:243], v32 offset:32768
    s_add_u32 m0, s50, 0
    s_add_u32 s51, s47, 3539072
    buffer_load_dwordx4 v20, s[24:27], s51 offen lds
    v_mfma_f32_16x16x32_bf16 v[80:83], v[36:39], v[232:235], v[80:83]
    ds_read_b64_tr_b16 v[74:75], v8 offset:16896
    s_waitcnt lgkmcnt(4)
    v_mfma_f32_16x16x32_bf16 v[88:91], v[76:79], v[228:231], v[88:91]
    ds_read_b64_tr_b16 v[76:77], v8 offset:20480
    ds_read_b128 v[248:251], v33 offset:32768
    buffer_load_dwordx4 v46, s[24:27], s51 offen offset:1024 lds
    v_mfma_f32_16x16x32_bf16 v[88:91], v[36:39], v[236:239], v[88:91]
    ds_read_b64_tr_b16 v[78:79], v8 offset:20992
    s_waitcnt lgkmcnt(6)
    v_mfma_f32_16x16x32_bf16 v[84:87], v[64:67], v[224:227], v[84:87]
    ds_read_b64_tr_b16 v[36:37], v11 offset:16384
    ds_read_b128 v[244:247], v32 offset:34816
    s_add_u32 m0, s50, 57344
    s_add_u32 s51, s47, 4128896
    buffer_load_dwordx4 v20, s[24:27], s51 offen lds
    v_mfma_f32_16x16x32_bf16 v[84:87], v[68:71], v[232:235], v[84:87]
    ds_read_b64_tr_b16 v[38:39], v11 offset:16896
    v_mfma_f32_16x16x32_bf16 v[92:95], v[64:67], v[228:231], v[92:95]
    ds_read_b64_tr_b16 v[64:65], v11 offset:20480
    ds_read_b128 v[252:255], v33 offset:34816
    buffer_load_dwordx4 v46, s[24:27], s51 offen offset:1024 lds
    v_mfma_f32_16x16x32_bf16 v[92:95], v[68:71], v[236:239], v[92:95]
    ds_read_b64_tr_b16 v[66:67], v11 offset:20992
    s_waitcnt lgkmcnt(6)
    v_mfma_f32_16x16x32_bf16 v[80:83], v[72:75], v[240:243], v[80:83]
    s_waitcnt vmcnt(14)
    s_barrier
    ds_read_b64_tr_b16 v[68:69], v8 offset:24576
    ds_read_b128 v[96:99], v24 offset:256
    v_mfma_f32_16x16x32_bf16 v[80:83], v[76:79], v[248:251], v[80:83]
    ds_read_b64_tr_b16 v[70:71], v8 offset:25088
    s_add_u32 m0, s50, 8192
    s_add_u32 s51, s47, 4718720
    buffer_load_dwordx4 v20, s[24:27], s51 offen lds
    s_waitcnt lgkmcnt(4)
    v_mfma_f32_16x16x32_bf16 v[88:91], v[72:75], v[244:247], v[88:91]
    ds_read_b64_tr_b16 v[32:33], v8 offset:28672
    ds_read_b128 v[100:103], v24 offset:320
    v_mfma_f32_16x16x32_bf16 v[88:91], v[76:79], v[252:255], v[88:91]
    ds_read_b64_tr_b16 v[34:35], v8 offset:29184
    s_waitcnt lgkmcnt(6)
    v_mfma_f32_16x16x32_bf16 v[84:87], v[36:39], v[240:243], v[84:87]
    ds_read_b64_tr_b16 v[72:73], v11 offset:24576
    ds_read_b128 v[104:107], v24 offset:256
    v_mfma_f32_16x16x32_bf16 v[84:87], v[64:67], v[248:251], v[84:87]
    ds_read_b64_tr_b16 v[74:75], v11 offset:25088
    buffer_load_dwordx4 v46, s[24:27], s51 offen offset:1024 lds
    v_mfma_f32_16x16x32_bf16 v[92:95], v[36:39], v[244:247], v[92:95]
    ds_read_b64_tr_b16 v[76:77], v11 offset:28672
    ds_read_b128 v[108:111], v24 offset:320
    v_mfma_f32_16x16x32_bf16 v[92:95], v[64:67], v[252:255], v[92:95]
    ds_read_b64_tr_b16 v[78:79], v11 offset:29184
    s_waitcnt lgkmcnt(1)
    v_mfma_f32_16x16x32_bf16 v[96:99], v[68:71], v[112:115], v[96:99]
    s_waitcnt vmcnt(12)
    s_barrier
    ds_read_b64_tr_b16 v[36:37], v8 offset:49152
    s_add_u32 m0, s50, 16384
    s_add_u32 s51, s84, 256
    buffer_load_dwordx4 v20, s[24:27], s51 offen lds
    v_subrev_u32 v24, s38, v24
    v_mfma_f32_16x16x32_bf16 v[96:99], v[32:35], v[120:123], v[96:99]
    ds_read_b64_tr_b16 v[38:39], v8 offset:49664
    v_mfma_f32_16x16x32_bf16 v[104:107], v[68:71], v[116:119], v[104:107]
    ds_read_b64_tr_b16 v[64:65], v8 offset:53248
    buffer_load_dwordx4 v46, s[24:27], s51 offen offset:1024 lds
    v_mfma_f32_16x16x32_bf16 v[104:107], v[32:35], v[124:127], v[104:107]
    ds_read_b64_tr_b16 v[66:67], v8 offset:53760
    s_waitcnt lgkmcnt(4)
    v_mfma_f32_16x16x32_bf16 v[100:103], v[72:75], v[112:115], v[100:103]
    ds_read_b64_tr_b16 v[68:69], v11 offset:49152
    s_add_u32 m0, s50, 65536
    s_add_u32 s51, s84, 590080
    buffer_load_dwordx4 v20, s[24:27], s51 offen lds
    v_mul_f32 v48, v80, v80
    v_mul_f32 v49, v81, v81
    v_mfma_f32_16x16x32_bf16 v[100:103], v[76:79], v[120:123], v[100:103]
    ds_read_b64_tr_b16 v[70:71], v11 offset:49664
    v_mul_f32 v50, v82, v82
    v_mul_f32 v51, v83, v83
    v_fma_f32 v48, v48, s53, v23
    v_mfma_f32_16x16x32_bf16 v[108:111], v[72:75], v[116:119], v[108:111]
    ds_read_b64_tr_b16 v[32:33], v11 offset:53248
    buffer_load_dwordx4 v46, s[24:27], s51 offen offset:1024 lds
    v_fma_f32 v49, v49, s53, v23
    v_fma_f32 v50, v50, s53, v23
    v_mfma_f32_16x16x32_bf16 v[108:111], v[76:79], v[124:127], v[108:111]
    ds_read_b64_tr_b16 v[34:35], v11 offset:53760
    v_fma_f32 v51, v51, s53, v23
    v_mul_f32 v48, v80, v48
    v_mul_f32 v49, v81, v49
    s_waitcnt lgkmcnt(4)
    v_mfma_f32_16x16x32_bf16 v[96:99], v[36:39], v[128:131], v[96:99]
    ds_read_b64_tr_b16 v[72:73], v8 offset:32768
    v_mul_f32 v50, v82, v50
    v_mul_f32 v51, v83, v51
    v_mfma_f32_16x16x32_bf16 v[96:99], v[64:67], v[136:139], v[96:99]
    ds_read_b64_tr_b16 v[74:75], v8 offset:33280
    v_exp_f32 v48, v48
    v_mfma_f32_16x16x32_bf16 v[104:107], v[36:39], v[132:135], v[104:107]
    ds_read_b64_tr_b16 v[76:77], v8 offset:36864
    v_exp_f32 v49, v49
    v_exp_f32 v50, v50
    v_mfma_f32_16x16x32_bf16 v[104:107], v[64:67], v[140:143], v[104:107]
    ds_read_b64_tr_b16 v[78:79], v8 offset:37376
    v_exp_f32 v51, v51
    s_waitcnt lgkmcnt(4)
    v_mfma_f32_16x16x32_bf16 v[100:103], v[68:71], v[128:131], v[100:103]
    ds_read_b64_tr_b16 v[36:37], v11 offset:32768
    v_add_f32 v48, 1.0, v48
    v_add_f32 v49, 1.0, v49
    v_mfma_f32_16x16x32_bf16 v[100:103], v[32:35], v[136:139], v[100:103]
    ds_read_b64_tr_b16 v[38:39], v11 offset:33280
    v_add_f32 v50, 1.0, v50
    v_add_f32 v51, 1.0, v51
    v_mfma_f32_16x16x32_bf16 v[108:111], v[68:71], v[132:135], v[108:111]
    ds_read_b64_tr_b16 v[64:65], v11 offset:36864
    v_rcp_f32 v48, v48
    v_rcp_f32 v49, v49
    v_mfma_f32_16x16x32_bf16 v[108:111], v[32:35], v[140:143], v[108:111]
    ds_read_b64_tr_b16 v[66:67], v11 offset:37376
    v_rcp_f32 v50, v50
    s_waitcnt lgkmcnt(4)
    v_mfma_f32_16x16x32_bf16 v[96:99], v[72:75], v[144:147], v[96:99]
    s_waitcnt vmcnt(12)
    s_barrier
    ds_read_b64_tr_b16 v[68:69], v9 offset:40960
    s_add_u32 m0, s50, 24576
    s_add_u32 s51, s84, 1179904
    buffer_load_dwordx4 v20, s[24:27], s51 offen lds
    v_rcp_f32 v51, v51
    v_mfma_f32_16x16x32_bf16 v[96:99], v[76:79], v[152:155], v[96:99]
    ds_read_b64_tr_b16 v[70:71], v9 offset:41472
    v_mul_f32 v80, v80, v48
    v_mul_f32 v81, v81, v49
    v_mul_f32 v82, v82, v50
    v_mfma_f32_16x16x32_bf16 v[104:107], v[72:75], v[148:151], v[104:107]
    ds_read_b64_tr_b16 v[32:33], v9 offset:45056
    buffer_load_dwordx4 v46, s[24:27], s51 offen offset:1024 lds
    v_mul_f32 v83, v83, v51
    v_cvt_pk_bf16_f32 v56, v80, v81
    v_mfma_f32_16x16x32_bf16 v[104:107], v[76:79], v[156:159], v[104:107]
    ds_read_b64_tr_b16 v[34:35], v9 offset:45568
    v_cvt_pk_bf16_f32 v57, v82, v83
    ds_read_b128 v[80:83], v24 offset:512
    v_mul_f32 v52, v84, v84
    s_waitcnt lgkmcnt(5)
    v_mfma_f32_16x16x32_bf16 v[100:103], v[36:39], v[144:147], v[100:103]
    ds_read_b64_tr_b16 v[72:73], v12 offset:40960
    s_add_u32 m0, s50, 49152
    s_add_u32 s51, s84, 1769728
    buffer_load_dwordx4 v20, s[24:27], s51 offen lds
    v_mul_f32 v53, v85, v85
    v_mul_f32 v54, v86, v86
    v_mfma_f32_16x16x32_bf16 v[100:103], v[64:67], v[152:155], v[100:103]
    ds_read_b64_tr_b16 v[74:75], v12 offset:41472
    v_mul_f32 v55, v87, v87
    v_fma_f32 v52, v52, s53, v23
    v_fma_f32 v53, v53, s53, v23
    v_mfma_f32_16x16x32_bf16 v[108:111], v[36:39], v[148:151], v[108:111]
    ds_read_b64_tr_b16 v[76:77], v12 offset:45056
    buffer_load_dwordx4 v46, s[24:27], s51 offen offset:1024 lds
    v_fma_f32 v54, v54, s53, v23
    v_fma_f32 v55, v55, s53, v23
    v_mfma_f32_16x16x32_bf16 v[108:111], v[64:67], v[156:159], v[108:111]
    ds_read_b64_tr_b16 v[78:79], v12 offset:45568
    v_mul_f32 v52, v84, v52
    v_mul_f32 v53, v85, v53
    v_mul_f32 v54, v86, v54
    s_waitcnt lgkmcnt(5)
    v_mfma_f32_16x16x32_bf16 v[96:99], v[68:71], v[160:163], v[96:99]
    ds_read_b64_tr_b16 v[36:37], v8 offset:40960
    v_mul_f32 v55, v87, v55
    v_exp_f32 v52, v52
    v_mfma_f32_16x16x32_bf16 v[96:99], v[32:35], v[168:171], v[96:99]
    ds_read_b64_tr_b16 v[38:39], v8 offset:41472
    v_exp_f32 v53, v53
    v_mfma_f32_16x16x32_bf16 v[104:107], v[68:71], v[164:167], v[104:107]
    ds_read_b64_tr_b16 v[64:65], v8 offset:45056
    v_exp_f32 v54, v54
    v_mfma_f32_16x16x32_bf16 v[104:107], v[32:35], v[172:175], v[104:107]
    ds_read_b64_tr_b16 v[66:67], v8 offset:45568
    v_exp_f32 v55, v55
    v_add_f32 v52, 1.0, v52
    s_waitcnt lgkmcnt(4)
    v_mfma_f32_16x16x32_bf16 v[100:103], v[72:75], v[160:163], v[100:103]
    ds_read_b64_tr_b16 v[68:69], v11 offset:40960
    v_add_f32 v53, 1.0, v53
    v_add_f32 v54, 1.0, v54
    v_mfma_f32_16x16x32_bf16 v[100:103], v[76:79], v[168:171], v[100:103]
    ds_read_b64_tr_b16 v[70:71], v11 offset:41472
    v_add_f32 v55, 1.0, v55
    v_rcp_f32 v52, v52
    v_mfma_f32_16x16x32_bf16 v[108:111], v[72:75], v[164:167], v[108:111]
    ds_read_b64_tr_b16 v[32:33], v11 offset:45056
    v_rcp_f32 v53, v53
    v_mfma_f32_16x16x32_bf16 v[108:111], v[76:79], v[172:175], v[108:111]
    ds_read_b64_tr_b16 v[34:35], v11 offset:45568
    v_rcp_f32 v54, v54
    s_waitcnt lgkmcnt(4)
    v_mfma_f32_16x16x32_bf16 v[96:99], v[36:39], v[176:179], v[96:99]
    s_waitcnt vmcnt(12)
    s_barrier
    ds_read_b64_tr_b16 v[72:73], v9 offset:49152
    s_add_u32 m0, s50, 32768
    s_add_u32 s51, s84, 2359552
    buffer_load_dwordx4 v20, s[24:27], s51 offen lds
    v_rcp_f32 v55, v55
    v_mul_f32 v84, v84, v52
    v_mfma_f32_16x16x32_bf16 v[96:99], v[64:67], v[184:187], v[96:99]
    ds_read_b64_tr_b16 v[74:75], v9 offset:49664
    v_mul_f32 v85, v85, v53
    v_mul_f32 v86, v86, v54
    v_mul_f32 v87, v87, v55
    v_mfma_f32_16x16x32_bf16 v[104:107], v[36:39], v[180:183], v[104:107]
    ds_read_b64_tr_b16 v[76:77], v9 offset:53248
    buffer_load_dwordx4 v46, s[24:27], s51 offen offset:1024 lds
    v_cvt_pk_bf16_f32 v58, v84, v85
    v_cvt_pk_bf16_f32 v59, v86, v87
    v_mfma_f32_16x16x32_bf16 v[104:107], v[64:67], v[188:191], v[104:107]
    ds_read_b64_tr_b16 v[78:79], v9 offset:53760
    ds_read_b128 v[84:87], v24 offset:576
    ds_write_b128 v29, v[56:59] offset:16384
    s_waitcnt lgkmcnt(6)
    v_mfma_f32_16x16x32_bf16 v[100:103], v[68:71], v[176:179], v[100:103]
    ds_read_b64_tr_b16 v[36:37], v12 offset:49152
    s_add_u32 m0, s50, 73728
    s_add_u32 s51, s84, 2949376
    buffer_load_dwordx4 v20, s[24:27], s51 offen lds
    s_add_u32 s52, s82, 0
    buffer_store_dwordx4 v[56:59], v28, s[32:35], s52 offen sc1
    v_mfma_f32_16x16x32_bf16 v[100:103], v[32:35], v[184:187], v[100:103]
    ds_read_b64_tr_b16 v[38:39], v12 offset:49664
    v_mul_f32 v48, v88, v88
    v_mul_f32 v49, v89, v89
    v_mfma_f32_16x16x32_bf16 v[108:111], v[68:71], v[180:183], v[108:111]
    ds_read_b64_tr_b16 v[64:65], v12 offset:53248
    buffer_load_dwordx4 v46, s[24:27], s51 offen offset:1024 lds
    v_mul_f32 v50, v90, v90
    v_mul_f32 v51, v91, v91
    v_fma_f32 v48, v48, s53, v23
    v_mfma_f32_16x16x32_bf16 v[108:111], v[32:35], v[188:191], v[108:111]
    ds_read_b64_tr_b16 v[66:67], v12 offset:53760
    v_fma_f32 v49, v49, s53, v23
    v_fma_f32 v50, v50, s53, v23
    s_waitcnt lgkmcnt(6)
    v_mfma_f32_16x16x32_bf16 v[96:99], v[72:75], v[192:195], v[96:99]
    ds_read_b64_tr_b16 v[68:69], v8 offset:0
    v_fma_f32 v51, v51, s53, v23
    v_mul_f32 v48, v88, v48
    v_mul_f32 v49, v89, v49
    v_mfma_f32_16x16x32_bf16 v[96:99], v[76:79], v[200:203], v[96:99]
    ds_read_b64_tr_b16 v[70:71], v8 offset:512
    v_mul_f32 v50, v90, v50
    v_mul_f32 v51, v91, v51
    v_mfma_f32_16x16x32_bf16 v[104:107], v[72:75], v[196:199], v[104:107]
    ds_read_b64_tr_b16 v[32:33], v8 offset:4096
    v_exp_f32 v48, v48
    v_mfma_f32_16x16x32_bf16 v[104:107], v[76:79], v[204:207], v[104:107]
    ds_read_b64_tr_b16 v[34:35], v8 offset:4608
    v_exp_f32 v49, v49
    v_exp_f32 v50, v50
    s_waitcnt lgkmcnt(4)
    v_mfma_f32_16x16x32_bf16 v[100:103], v[36:39], v[192:195], v[100:103]
    ds_read_b64_tr_b16 v[72:73], v11 offset:0
    v_exp_f32 v51, v51
    v_mfma_f32_16x16x32_bf16 v[100:103], v[64:67], v[200:203], v[100:103]
    ds_read_b64_tr_b16 v[74:75], v11 offset:512
    v_add_f32 v48, 1.0, v48
    v_add_f32 v49, 1.0, v49
    v_mfma_f32_16x16x32_bf16 v[108:111], v[36:39], v[196:199], v[108:111]
    ds_read_b64_tr_b16 v[76:77], v11 offset:4096
    v_add_f32 v50, 1.0, v50
    v_add_f32 v51, 1.0, v51
    v_mfma_f32_16x16x32_bf16 v[108:111], v[64:67], v[204:207], v[108:111]
    ds_read_b64_tr_b16 v[78:79], v11 offset:4608
    v_rcp_f32 v48, v48
    v_rcp_f32 v49, v49
    s_waitcnt lgkmcnt(4)
    v_mfma_f32_16x16x32_bf16 v[96:99], v[68:71], v[208:211], v[96:99]
    s_waitcnt vmcnt(13)
    s_barrier
    ds_read_b64_tr_b16 v[36:37], v8 offset:57344
    s_add_u32 m0, s50, 40960
    s_add_u32 s51, s84, 3539200
    buffer_load_dwordx4 v20, s[24:27], s51 offen lds
    v_rcp_f32 v50, v50
    v_mfma_f32_16x16x32_bf16 v[96:99], v[32:35], v[216:219], v[96:99]
    ds_read_b64_tr_b16 v[38:39], v8 offset:57856
    v_rcp_f32 v51, v51
    v_mfma_f32_16x16x32_bf16 v[104:107], v[68:71], v[212:215], v[104:107]
    ds_read_b64_tr_b16 v[64:65], v8 offset:61440
    buffer_load_dwordx4 v46, s[24:27], s51 offen offset:1024 lds
    v_mul_f32 v88, v88, v48
    v_mul_f32 v89, v89, v49
    v_mul_f32 v90, v90, v50
    v_mfma_f32_16x16x32_bf16 v[104:107], v[32:35], v[220:223], v[104:107]
    ds_read_b64_tr_b16 v[66:67], v8 offset:61952
    v_mul_f32 v91, v91, v51
    v_cvt_pk_bf16_f32 v60, v88, v89
    s_waitcnt lgkmcnt(4)
    v_mfma_f32_16x16x32_bf16 v[100:103], v[72:75], v[208:211], v[100:103]
    ds_read_b64_tr_b16 v[68:69], v11 offset:57344
    s_add_u32 m0, s50, 114688
    s_add_u32 s51, s84, 4129024
    buffer_load_dwordx4 v20, s[24:27], s51 offen lds
    v_cvt_pk_bf16_f32 v61, v90, v91
    ds_read_b128 v[88:91], v24 offset:512
    v_mul_f32 v52, v92, v92
    v_mfma_f32_16x16x32_bf16 v[100:103], v[76:79], v[216:219], v[100:103]
    ds_read_b64_tr_b16 v[70:71], v11 offset:57856
    v_mul_f32 v53, v93, v93
    v_mul_f32 v54, v94, v94
    v_mfma_f32_16x16x32_bf16 v[108:111], v[72:75], v[212:215], v[108:111]
    ds_read_b64_tr_b16 v[32:33], v11 offset:61440
    buffer_load_dwordx4 v46, s[24:27], s51 offen offset:1024 lds
    v_mul_f32 v55, v95, v95
    v_fma_f32 v52, v52, s53, v23
    v_fma_f32 v53, v53, s53, v23
    v_mfma_f32_16x16x32_bf16 v[108:111], v[76:79], v[220:223], v[108:111]
    ds_read_b64_tr_b16 v[34:35], v11 offset:61952
    v_fma_f32 v54, v54, s53, v23
    v_fma_f32 v55, v55, s53, v23
    s_waitcnt lgkmcnt(5)
    v_mfma_f32_16x16x32_bf16 v[96:99], v[36:39], v[224:227], v[96:99]
    ds_read_b64_tr_b16 v[72:73], v8 offset:8192
    v_mul_f32 v52, v92, v52
    v_mul_f32 v53, v93, v53
    v_mul_f32 v54, v94, v54
    v_mfma_f32_16x16x32_bf16 v[96:99], v[64:67], v[232:235], v[96:99]
    ds_read_b64_tr_b16 v[74:75], v8 offset:8704
    v_mul_f32 v55, v95, v55
    v_exp_f32 v52, v52
    v_mfma_f32_16x16x32_bf16 v[104:107], v[36:39], v[228:231], v[104:107]
    ds_read_b64_tr_b16 v[76:77], v8 offset:12288
    v_exp_f32 v53, v53
    v_mfma_f32_16x16x32_bf16 v[104:107], v[64:67], v[236:239], v[104:107]
    ds_read_b64_tr_b16 v[78:79], v8 offset:12800
    v_exp_f32 v54, v54
    s_waitcnt lgkmcnt(4)
    v_mfma_f32_16x16x32_bf16 v[100:103], v[68:71], v[224:227], v[100:103]
    ds_read_b64_tr_b16 v[36:37], v11 offset:8192
    v_exp_f32 v55, v55
    v_add_f32 v52, 1.0, v52
    v_mfma_f32_16x16x32_bf16 v[100:103], v[32:35], v[232:235], v[100:103]
    ds_read_b64_tr_b16 v[38:39], v11 offset:8704
    v_add_f32 v53, 1.0, v53
    v_add_f32 v54, 1.0, v54
    v_mfma_f32_16x16x32_bf16 v[108:111], v[68:71], v[228:231], v[108:111]
    ds_read_b64_tr_b16 v[64:65], v11 offset:12288
    v_add_f32 v55, 1.0, v55
    v_rcp_f32 v52, v52
    v_mfma_f32_16x16x32_bf16 v[108:111], v[32:35], v[236:239], v[108:111]
    ds_read_b64_tr_b16 v[66:67], v11 offset:12800
    v_rcp_f32 v53, v53
    s_waitcnt lgkmcnt(4)
    v_mfma_f32_16x16x32_bf16 v[96:99], v[72:75], v[240:243], v[96:99]
    s_waitcnt vmcnt(13)
    s_barrier
    ds_read_b64_tr_b16 v[68:69], v8 offset:16384
    s_add_u32 m0, s50, 0
    s_add_u32 s51, s84, 4718848
    buffer_load_dwordx4 v20, s[24:27], s51 offen lds
    v_rcp_f32 v54, v54
    v_mfma_f32_16x16x32_bf16 v[96:99], v[76:79], v[248:251], v[96:99]
    ds_read_b64_tr_b16 v[70:71], v8 offset:16896
    v_rcp_f32 v55, v55
    v_mul_f32 v92, v92, v52
    v_mfma_f32_16x16x32_bf16 v[104:107], v[72:75], v[244:247], v[104:107]
    ds_read_b64_tr_b16 v[32:33], v8 offset:20480
    buffer_load_dwordx4 v46, s[24:27], s51 offen offset:1024 lds
    v_mul_f32 v93, v93, v53
    v_mul_f32 v94, v94, v54
    v_mul_f32 v95, v95, v55
    v_mfma_f32_16x16x32_bf16 v[104:107], v[76:79], v[252:255], v[104:107]
    ds_read_b64_tr_b16 v[34:35], v8 offset:20992
    v_cvt_pk_bf16_f32 v62, v92, v93
    v_cvt_pk_bf16_f32 v63, v94, v95
    s_waitcnt lgkmcnt(4)
    v_mfma_f32_16x16x32_bf16 v[100:103], v[36:39], v[240:243], v[100:103]
    ds_read_b64_tr_b16 v[72:73], v11 offset:16384
    s_add_u32 m0, s50, 57344
    s_add_u32 s51, s84, 384
    buffer_load_dwordx4 v20, s[24:27], s51 offen lds
    ds_read_b128 v[92:95], v24 offset:576
    ds_write_b128 v29, v[60:63] offset:17408
    v_mfma_f32_16x16x32_bf16 v[100:103], v[64:67], v[248:251], v[100:103]
    ds_read_b64_tr_b16 v[74:75], v11 offset:16896
    s_add_u32 s52, s82, 1024
    buffer_store_dwordx4 v[60:63], v28, s[32:35], s52 offen sc1
    v_mfma_f32_16x16x32_bf16 v[108:111], v[36:39], v[244:247], v[108:111]
    ds_read_b64_tr_b16 v[76:77], v11 offset:20480
    buffer_load_dwordx4 v46, s[24:27], s51 offen offset:1024 lds
    v_mfma_f32_16x16x32_bf16 v[108:111], v[64:67], v[252:255], v[108:111]
    ds_read_b64_tr_b16 v[78:79], v11 offset:20992
    s_waitcnt lgkmcnt(4)
    v_mfma_f32_16x16x32_bf16 v[80:83], v[68:71], v[112:115], v[80:83]
    ds_read_b64_tr_b16 v[36:37], v9 offset:0
    v_mfma_f32_16x16x32_bf16 v[80:83], v[32:35], v[120:123], v[80:83]
    ds_read_b64_tr_b16 v[38:39], v9 offset:512
    v_mfma_f32_16x16x32_bf16 v[88:91], v[68:71], v[116:119], v[88:91]
    ds_read_b64_tr_b16 v[64:65], v9 offset:4096
    v_mfma_f32_16x16x32_bf16 v[88:91], v[32:35], v[124:127], v[88:91]
    ds_read_b64_tr_b16 v[66:67], v9 offset:4608
    s_waitcnt lgkmcnt(4)
    v_mfma_f32_16x16x32_bf16 v[84:87], v[72:75], v[112:115], v[84:87]
    ds_read_b64_tr_b16 v[68:69], v12 offset:0
    v_mul_f32 v48, v96, v96
    v_mul_f32 v49, v97, v97
    v_mfma_f32_16x16x32_bf16 v[84:87], v[76:79], v[120:123], v[84:87]
    ds_read_b64_tr_b16 v[70:71], v12 offset:512
    v_mul_f32 v50, v98, v98
    v_mul_f32 v51, v99, v99
    v_fma_f32 v48, v48, s53, v23
    v_mfma_f32_16x16x32_bf16 v[92:95], v[72:75], v[116:119], v[92:95]
    ds_read_b64_tr_b16 v[32:33], v12 offset:4096
    v_fma_f32 v49, v49, s53, v23
    v_fma_f32 v50, v50, s53, v23
    v_mfma_f32_16x16x32_bf16 v[92:95], v[76:79], v[124:127], v[92:95]
    ds_read_b64_tr_b16 v[34:35], v12 offset:4608
    v_fma_f32 v51, v51, s53, v23
    v_mul_f32 v48, v96, v48
    v_mul_f32 v49, v97, v49
    s_waitcnt lgkmcnt(4)
    v_mfma_f32_16x16x32_bf16 v[80:83], v[36:39], v[128:131], v[80:83]
    s_waitcnt vmcnt(14)
    s_barrier
    ds_read_b64_tr_b16 v[72:73], v8 offset:24576
    s_add_u32 m0, s50, 8192
    s_add_u32 s51, s84, 590208
    buffer_load_dwordx4 v20, s[24:27], s51 offen lds
    v_mul_f32 v50, v98, v50
    v_mul_f32 v51, v99, v51
    v_mfma_f32_16x16x32_bf16 v[80:83], v[64:67], v[136:139], v[80:83]
    ds_read_b64_tr_b16 v[74:75], v8 offset:25088
    v_exp_f32 v48, v48
    v_mfma_f32_16x16x32_bf16 v[88:91], v[36:39], v[132:135], v[88:91]
    ds_read_b64_tr_b16 v[76:77], v8 offset:28672
    buffer_load_dwordx4 v46, s[24:27], s51 offen offset:1024 lds
    v_exp_f32 v49, v49
    v_exp_f32 v50, v50
    v_mfma_f32_16x16x32_bf16 v[88:91], v[64:67], v[140:143], v[88:91]
    ds_read_b64_tr_b16 v[78:79], v8 offset:29184
    v_exp_f32 v51, v51
    s_waitcnt lgkmcnt(4)
    v_mfma_f32_16x16x32_bf16 v[84:87], v[68:71], v[128:131], v[84:87]
    ds_read_b64_tr_b16 v[36:37], v11 offset:24576
    s_add_u32 m0, s50, 16384
    s_add_u32 s51, s84, 1180032
    buffer_load_dwordx4 v20, s[24:27], s51 offen lds
    v_add_f32 v48, 1.0, v48
    v_add_f32 v49, 1.0, v49
    v_mfma_f32_16x16x32_bf16 v[84:87], v[32:35], v[136:139], v[84:87]
    ds_read_b64_tr_b16 v[38:39], v11 offset:25088
    v_add_f32 v50, 1.0, v50
    v_add_f32 v51, 1.0, v51
    v_mfma_f32_16x16x32_bf16 v[92:95], v[68:71], v[132:135], v[92:95]
    ds_read_b64_tr_b16 v[64:65], v11 offset:28672
    buffer_load_dwordx4 v46, s[24:27], s51 offen offset:1024 lds
    v_rcp_f32 v48, v48
    v_rcp_f32 v49, v49
    v_mfma_f32_16x16x32_bf16 v[92:95], v[32:35], v[140:143], v[92:95]
    ds_read_b64_tr_b16 v[66:67], v11 offset:29184
    v_rcp_f32 v50, v50
    s_waitcnt lgkmcnt(4)
    v_mfma_f32_16x16x32_bf16 v[80:83], v[72:75], v[144:147], v[80:83]
    ds_read_b64_tr_b16 v[68:69], v8 offset:49152
    v_rcp_f32 v51, v51
    v_mfma_f32_16x16x32_bf16 v[80:83], v[76:79], v[152:155], v[80:83]
    ds_read_b64_tr_b16 v[70:71], v8 offset:49664
    v_mul_f32 v96, v96, v48
    v_mul_f32 v97, v97, v49
    v_mul_f32 v98, v98, v50
    v_mfma_f32_16x16x32_bf16 v[88:91], v[72:75], v[148:151], v[88:91]
    ds_read_b64_tr_b16 v[32:33], v8 offset:53248
    v_mul_f32 v99, v99, v51
    v_cvt_pk_bf16_f32 v56, v96, v97
    v_mfma_f32_16x16x32_bf16 v[88:91], v[76:79], v[156:159], v[88:91]
    ds_read_b64_tr_b16 v[34:35], v8 offset:53760
    v_cvt_pk_bf16_f32 v57, v98, v99
    ds_read_b128 v[96:99], v24 offset:768
    v_mul_f32 v52, v100, v100
    s_waitcnt lgkmcnt(5)
    v_mfma_f32_16x16x32_bf16 v[84:87], v[36:39], v[144:147], v[84:87]
    ds_read_b64_tr_b16 v[72:73], v11 offset:49152
    v_mul_f32 v53, v101, v101
    v_mul_f32 v54, v102, v102
    v_mfma_f32_16x16x32_bf16 v[84:87], v[64:67], v[152:155], v[84:87]
    ds_read_b64_tr_b16 v[74:75], v11 offset:49664
    v_mul_f32 v55, v103, v103
    v_fma_f32 v52, v52, s53, v23
    v_fma_f32 v53, v53, s53, v23
    v_mfma_f32_16x16x32_bf16 v[92:95], v[36:39], v[148:151], v[92:95]
    ds_read_b64_tr_b16 v[76:77], v11 offset:53248
    v_fma_f32 v54, v54, s53, v23
    v_fma_f32 v55, v55, s53, v23
    v_mfma_f32_16x16x32_bf16 v[92:95], v[64:67], v[156:159], v[92:95]
    ds_read_b64_tr_b16 v[78:79], v11 offset:53760
    v_mul_f32 v52, v100, v52
    v_mul_f32 v53, v101, v53
    v_mul_f32 v54, v102, v54
    s_waitcnt lgkmcnt(5)
    v_mfma_f32_16x16x32_bf16 v[80:83], v[68:71], v[160:163], v[80:83]
    s_waitcnt vmcnt(13)
    s_barrier
    ds_read_b64_tr_b16 v[36:37], v8 offset:32768
    s_add_u32 m0, s50, 24576
    s_add_u32 s51, s84, 1769856
    buffer_load_dwordx4 v20, s[24:27], s51 offen lds
    v_mul_f32 v55, v103, v55
    v_exp_f32 v52, v52
    v_mfma_f32_16x16x32_bf16 v[80:83], v[32:35], v[168:171], v[80:83]
    ds_read_b64_tr_b16 v[38:39], v8 offset:33280
    v_exp_f32 v53, v53
    v_mfma_f32_16x16x32_bf16 v[88:91], v[68:71], v[164:167], v[88:91]
    ds_read_b64_tr_b16 v[64:65], v8 offset:36864
    buffer_load_dwordx4 v46, s[24:27], s51 offen offset:1024 lds
    v_exp_f32 v54, v54
    v_mfma_f32_16x16x32_bf16 v[88:91], v[32:35], v[172:175], v[88:91]
    ds_read_b64_tr_b16 v[66:67], v8 offset:37376
    v_exp_f32 v55, v55
    v_add_f32 v52, 1.0, v52
    s_waitcnt lgkmcnt(4)
    v_mfma_f32_16x16x32_bf16 v[84:87], v[72:75], v[160:163], v[84:87]
    ds_read_b64_tr_b16 v[68:69], v11 offset:32768
    s_add_u32 m0, s50, 65536
    s_add_u32 s51, s84, 2359680
    buffer_load_dwordx4 v20, s[24:27], s51 offen lds
    v_add_f32 v53, 1.0, v53
    v_add_f32 v54, 1.0, v54
    v_mfma_f32_16x16x32_bf16 v[84:87], v[76:79], v[168:171], v[84:87]
    ds_read_b64_tr_b16 v[70:71], v11 offset:33280
    v_add_f32 v55, 1.0, v55
    v_rcp_f32 v52, v52
    v_mfma_f32_16x16x32_bf16 v[92:95], v[72:75], v[164:167], v[92:95]
    ds_read_b64_tr_b16 v[32:33], v11 offset:36864
    buffer_load_dwordx4 v46, s[24:27], s51 offen offset:1024 lds
    v_rcp_f32 v53, v53
    v_mfma_f32_16x16x32_bf16 v[92:95], v[76:79], v[172:175], v[92:95]
    ds_read_b64_tr_b16 v[34:35], v11 offset:37376
    v_rcp_f32 v54, v54
    s_waitcnt lgkmcnt(4)
    v_mfma_f32_16x16x32_bf16 v[80:83], v[36:39], v[176:179], v[80:83]
    ds_read_b64_tr_b16 v[72:73], v9 offset:8192
    v_rcp_f32 v55, v55
    v_mul_f32 v100, v100, v52
    v_mfma_f32_16x16x32_bf16 v[80:83], v[64:67], v[184:187], v[80:83]
    ds_read_b64_tr_b16 v[74:75], v9 offset:8704
    v_mul_f32 v101, v101, v53
    v_mul_f32 v102, v102, v54
    v_mul_f32 v103, v103, v55
    v_mfma_f32_16x16x32_bf16 v[88:91], v[36:39], v[180:183], v[88:91]
    ds_read_b64_tr_b16 v[76:77], v9 offset:12288
    v_cvt_pk_bf16_f32 v58, v100, v101
    v_cvt_pk_bf16_f32 v59, v102, v103
    v_mfma_f32_16x16x32_bf16 v[88:91], v[64:67], v[188:191], v[88:91]
    ds_read_b64_tr_b16 v[78:79], v9 offset:12800
    ds_read_b128 v[100:103], v24 offset:832
    ds_write_b128 v29, v[56:59] offset:32768
    s_waitcnt lgkmcnt(6)
    v_mfma_f32_16x16x32_bf16 v[84:87], v[68:71], v[176:179], v[84:87]
    ds_read_b64_tr_b16 v[36:37], v12 offset:8192
    s_add_u32 s52, s82, 16384
    buffer_store_dwordx4 v[56:59], v28, s[32:35], s52 offen sc1
    v_mfma_f32_16x16x32_bf16 v[84:87], v[32:35], v[184:187], v[84:87]
    ds_read_b64_tr_b16 v[38:39], v12 offset:8704
    v_mul_f32 v48, v104, v104
    v_mul_f32 v49, v105, v105
    v_mfma_f32_16x16x32_bf16 v[92:95], v[68:71], v[180:183], v[92:95]
    ds_read_b64_tr_b16 v[64:65], v12 offset:12288
    v_mul_f32 v50, v106, v106
    v_mul_f32 v51, v107, v107
    v_fma_f32 v48, v48, s53, v23
    v_mfma_f32_16x16x32_bf16 v[92:95], v[32:35], v[188:191], v[92:95]
    ds_read_b64_tr_b16 v[66:67], v12 offset:12800
    v_fma_f32 v49, v49, s53, v23
    v_fma_f32 v50, v50, s53, v23
    s_waitcnt lgkmcnt(6)
    v_mfma_f32_16x16x32_bf16 v[80:83], v[72:75], v[192:195], v[80:83]
    s_waitcnt vmcnt(14)
    s_barrier
    ds_read_b64_tr_b16 v[68:69], v8 offset:40960
    s_add_u32 m0, s50, 32768
    s_add_u32 s51, s84, 2949504
    buffer_load_dwordx4 v20, s[24:27], s51 offen lds
    v_fma_f32 v51, v51, s53, v23
    v_mul_f32 v48, v104, v48
    v_mul_f32 v49, v105, v49
    v_mfma_f32_16x16x32_bf16 v[80:83], v[76:79], v[200:203], v[80:83]
    ds_read_b64_tr_b16 v[70:71], v8 offset:41472
    v_mul_f32 v50, v106, v50
    v_mul_f32 v51, v107, v51
    v_mfma_f32_16x16x32_bf16 v[88:91], v[72:75], v[196:199], v[88:91]
    ds_read_b64_tr_b16 v[32:33], v8 offset:45056
    buffer_load_dwordx4 v46, s[24:27], s51 offen offset:1024 lds
    v_exp_f32 v48, v48
    v_mfma_f32_16x16x32_bf16 v[88:91], v[76:79], v[204:207], v[88:91]
    ds_read_b64_tr_b16 v[34:35], v8 offset:45568
    v_exp_f32 v49, v49
    v_exp_f32 v50, v50
    s_waitcnt lgkmcnt(4)
    v_mfma_f32_16x16x32_bf16 v[84:87], v[36:39], v[192:195], v[84:87]
    ds_read_b64_tr_b16 v[72:73], v11 offset:40960
    s_add_u32 m0, s50, 49152
    s_add_u32 s51, s84, 3539328
    buffer_load_dwordx4 v20, s[24:27], s51 offen lds
    v_exp_f32 v51, v51
    v_mfma_f32_16x16x32_bf16 v[84:87], v[64:67], v[200:203], v[84:87]
    ds_read_b64_tr_b16 v[74:75], v11 offset:41472
    v_add_f32 v48, 1.0, v48
    v_add_f32 v49, 1.0, v49
    v_mfma_f32_16x16x32_bf16 v[92:95], v[36:39], v[196:199], v[92:95]
    ds_read_b64_tr_b16 v[76:77], v11 offset:45056
    buffer_load_dwordx4 v46, s[24:27], s51 offen offset:1024 lds
    v_add_f32 v50, 1.0, v50
    v_add_f32 v51, 1.0, v51
    v_mfma_f32_16x16x32_bf16 v[92:95], v[64:67], v[204:207], v[92:95]
    ds_read_b64_tr_b16 v[78:79], v11 offset:45568
    v_rcp_f32 v48, v48
    v_rcp_f32 v49, v49
    s_waitcnt lgkmcnt(4)
    v_mfma_f32_16x16x32_bf16 v[80:83], v[68:71], v[208:211], v[80:83]
    ds_read_b64_tr_b16 v[36:37], v9 offset:49152
    v_rcp_f32 v50, v50
    v_mfma_f32_16x16x32_bf16 v[80:83], v[32:35], v[216:219], v[80:83]
    ds_read_b64_tr_b16 v[38:39], v9 offset:49664
    v_rcp_f32 v51, v51
    v_mfma_f32_16x16x32_bf16 v[88:91], v[68:71], v[212:215], v[88:91]
    ds_read_b64_tr_b16 v[64:65], v9 offset:53248
    v_mul_f32 v104, v104, v48
    v_mul_f32 v105, v105, v49
    v_mul_f32 v106, v106, v50
    v_mfma_f32_16x16x32_bf16 v[88:91], v[32:35], v[220:223], v[88:91]
    ds_read_b64_tr_b16 v[66:67], v9 offset:53760
    v_mul_f32 v107, v107, v51
    v_cvt_pk_bf16_f32 v60, v104, v105
    s_waitcnt lgkmcnt(4)
    v_mfma_f32_16x16x32_bf16 v[84:87], v[72:75], v[208:211], v[84:87]
    ds_read_b64_tr_b16 v[68:69], v12 offset:49152
    v_cvt_pk_bf16_f32 v61, v106, v107
    ds_read_b128 v[104:107], v24 offset:768
    v_mul_f32 v52, v108, v108
    v_mfma_f32_16x16x32_bf16 v[84:87], v[76:79], v[216:219], v[84:87]
    ds_read_b64_tr_b16 v[70:71], v12 offset:49664
    v_mul_f32 v53, v109, v109
    v_mul_f32 v54, v110, v110
    v_mfma_f32_16x16x32_bf16 v[92:95], v[72:75], v[212:215], v[92:95]
    ds_read_b64_tr_b16 v[32:33], v12 offset:53248
    v_mul_f32 v55, v111, v111
    v_fma_f32 v52, v52, s53, v23
    v_fma_f32 v53, v53, s53, v23
    v_mfma_f32_16x16x32_bf16 v[92:95], v[76:79], v[220:223], v[92:95]
    ds_read_b64_tr_b16 v[34:35], v12 offset:53760
    v_fma_f32 v54, v54, s53, v23
    v_fma_f32 v55, v55, s53, v23
    s_waitcnt lgkmcnt(5)
    v_mfma_f32_16x16x32_bf16 v[80:83], v[36:39], v[224:227], v[80:83]
    s_waitcnt vmcnt(13)
    s_barrier
    ds_read_b64_tr_b16 v[72:73], v8 offset:0
    s_add_u32 m0, s50, 40960
    s_add_u32 s51, s84, 4129152
    buffer_load_dwordx4 v20, s[24:27], s51 offen lds
    v_mul_f32 v52, v108, v52
    v_mul_f32 v53, v109, v53
    v_mul_f32 v54, v110, v54
    v_mfma_f32_16x16x32_bf16 v[80:83], v[64:67], v[232:235], v[80:83]
    ds_read_b64_tr_b16 v[74:75], v8 offset:512
    v_mul_f32 v55, v111, v55
    v_exp_f32 v52, v52
    v_mfma_f32_16x16x32_bf16 v[88:91], v[36:39], v[228:231], v[88:91]
    ds_read_b64_tr_b16 v[76:77], v8 offset:4096
    buffer_load_dwordx4 v46, s[24:27], s51 offen offset:1024 lds
    v_exp_f32 v53, v53
    v_mfma_f32_16x16x32_bf16 v[88:91], v[64:67], v[236:239], v[88:91]
    ds_read_b64_tr_b16 v[78:79], v8 offset:4608
    v_exp_f32 v54, v54
    s_waitcnt lgkmcnt(4)
    v_mfma_f32_16x16x32_bf16 v[84:87], v[68:71], v[224:227], v[84:87]
    ds_read_b64_tr_b16 v[36:37], v11 offset:0
    s_add_u32 m0, s50, 73728
    s_add_u32 s51, s84, 4718976
    buffer_load_dwordx4 v20, s[24:27], s51 offen lds
    v_exp_f32 v55, v55
    v_add_f32 v52, 1.0, v52
    v_mfma_f32_16x16x32_bf16 v[84:87], v[32:35], v[232:235], v[84:87]
    ds_read_b64_tr_b16 v[38:39], v11 offset:512
    v_add_f32 v53, 1.0, v53
    v_add_f32 v54, 1.0, v54
    v_mfma_f32_16x16x32_bf16 v[92:95], v[68:71], v[228:231], v[92:95]
    ds_read_b64_tr_b16 v[64:65], v11 offset:4096
    buffer_load_dwordx4 v46, s[24:27], s51 offen offset:1024 lds
    v_add_f32 v55, 1.0, v55
    v_rcp_f32 v52, v52
    v_mfma_f32_16x16x32_bf16 v[92:95], v[32:35], v[236:239], v[92:95]
    ds_read_b64_tr_b16 v[66:67], v11 offset:4608
    v_rcp_f32 v53, v53
    s_waitcnt lgkmcnt(4)
    v_mfma_f32_16x16x32_bf16 v[80:83], v[72:75], v[240:243], v[80:83]
    ds_read_b64_tr_b16 v[68:69], v8 offset:57344
    v_rcp_f32 v54, v54
    v_mfma_f32_16x16x32_bf16 v[80:83], v[76:79], v[248:251], v[80:83]
    ds_read_b64_tr_b16 v[70:71], v8 offset:57856
    v_rcp_f32 v55, v55
    v_mul_f32 v108, v108, v52
    v_mfma_f32_16x16x32_bf16 v[88:91], v[72:75], v[244:247], v[88:91]
    ds_read_b64_tr_b16 v[32:33], v8 offset:61440
    v_mul_f32 v109, v109, v53
    v_mul_f32 v110, v110, v54
    v_mul_f32 v111, v111, v55
    v_mfma_f32_16x16x32_bf16 v[88:91], v[76:79], v[252:255], v[88:91]
    ds_read_b64_tr_b16 v[34:35], v8 offset:61952
    v_cvt_pk_bf16_f32 v62, v108, v109
    v_cvt_pk_bf16_f32 v63, v110, v111
    s_waitcnt lgkmcnt(4)
    v_mfma_f32_16x16x32_bf16 v[84:87], v[36:39], v[240:243], v[84:87]
    ds_read_b64_tr_b16 v[72:73], v11 offset:57344
    ds_read_b128 v[108:111], v24 offset:832
    ds_write_b128 v29, v[60:63] offset:33792
    v_mfma_f32_16x16x32_bf16 v[84:87], v[64:67], v[248:251], v[84:87]
    ds_read_b64_tr_b16 v[74:75], v11 offset:57856
    s_add_u32 s52, s82, 17408
    buffer_store_dwordx4 v[60:63], v28, s[32:35], s52 offen sc1
    v_mfma_f32_16x16x32_bf16 v[92:95], v[36:39], v[244:247], v[92:95]
    ds_read_b64_tr_b16 v[76:77], v11 offset:61440
    v_mfma_f32_16x16x32_bf16 v[92:95], v[64:67], v[252:255], v[92:95]
    ds_read_b64_tr_b16 v[78:79], v11 offset:61952
    s_waitcnt lgkmcnt(4)
    v_mfma_f32_16x16x32_bf16 v[96:99], v[68:71], v[112:115], v[96:99]
    s_waitcnt vmcnt(14) lgkmcnt(3)
    s_barrier
    ds_read_b64_tr_b16 v[36:37], v8 offset:8192
    v_add_u32 v46, 146432, v21
    s_add_u32 m0, s50, 0
    s_nop 0
    buffer_load_dwordx4 v21, s[24:27], s48 offen lds
    v_mfma_f32_16x16x32_bf16 v[96:99], v[32:35], v[120:123], v[96:99]
    ds_read_b64_tr_b16 v[38:39], v8 offset:8704
    v_mfma_f32_16x16x32_bf16 v[104:107], v[68:71], v[116:119], v[104:107]
    ds_read_b64_tr_b16 v[64:65], v8 offset:12288
    buffer_load_dwordx4 v46, s[24:27], s48 offen offset:1024 lds
    v_mfma_f32_16x16x32_bf16 v[104:107], v[32:35], v[124:127], v[104:107]
    ds_read_b64_tr_b16 v[66:67], v8 offset:12800
    s_waitcnt lgkmcnt(4)
    v_mfma_f32_16x16x32_bf16 v[100:103], v[72:75], v[112:115], v[100:103]
    ds_read_b64_tr_b16 v[68:69], v11 offset:8192
    s_add_u32 m0, s50, 147456
    s_add_u32 s51, s48, 1179648
    buffer_load_dwordx4 v21, s[24:27], s51 offen lds
    v_mul_f32 v48, v80, v80
    v_mul_f32 v49, v81, v81
    v_mfma_f32_16x16x32_bf16 v[100:103], v[76:79], v[120:123], v[100:103]
    ds_read_b64_tr_b16 v[70:71], v11 offset:8704
    v_mul_f32 v50, v82, v82
    v_mul_f32 v51, v83, v83
    v_fma_f32 v48, v48, s53, v23
    v_mfma_f32_16x16x32_bf16 v[108:111], v[72:75], v[116:119], v[108:111]
    ds_read_b64_tr_b16 v[32:33], v11 offset:12288
    buffer_load_dwordx4 v46, s[24:27], s51 offen offset:1024 lds
    v_fma_f32 v49, v49, s53, v23
    v_fma_f32 v50, v50, s53, v23
    v_mfma_f32_16x16x32_bf16 v[108:111], v[76:79], v[124:127], v[108:111]
    ds_read_b64_tr_b16 v[34:35], v11 offset:12800
    v_fma_f32 v51, v51, s53, v23
    v_mul_f32 v48, v80, v48
    v_mul_f32 v49, v81, v49
    s_waitcnt lgkmcnt(4)
    v_mfma_f32_16x16x32_bf16 v[96:99], v[36:39], v[128:131], v[96:99]
    ds_read_b64_tr_b16 v[72:73], v8 offset:16384
    v_mul_f32 v50, v82, v50
    v_mul_f32 v51, v83, v51
    v_mfma_f32_16x16x32_bf16 v[96:99], v[64:67], v[136:139], v[96:99]
    ds_read_b64_tr_b16 v[74:75], v8 offset:16896
    v_exp_f32 v48, v48
    v_mfma_f32_16x16x32_bf16 v[104:107], v[36:39], v[132:135], v[104:107]
    ds_read_b64_tr_b16 v[76:77], v8 offset:20480
    v_exp_f32 v49, v49
    v_exp_f32 v50, v50
    v_mfma_f32_16x16x32_bf16 v[104:107], v[64:67], v[140:143], v[104:107]
    ds_read_b64_tr_b16 v[78:79], v8 offset:20992
    v_exp_f32 v51, v51
    s_waitcnt lgkmcnt(4)
    v_mfma_f32_16x16x32_bf16 v[100:103], v[68:71], v[128:131], v[100:103]
    ds_read_b64_tr_b16 v[36:37], v11 offset:16384
    v_add_f32 v48, 1.0, v48
    v_add_f32 v49, 1.0, v49
    v_mfma_f32_16x16x32_bf16 v[100:103], v[32:35], v[136:139], v[100:103]
    ds_read_b64_tr_b16 v[38:39], v11 offset:16896
    v_add_f32 v50, 1.0, v50
    v_add_f32 v51, 1.0, v51
    v_mfma_f32_16x16x32_bf16 v[108:111], v[68:71], v[132:135], v[108:111]
    ds_read_b64_tr_b16 v[64:65], v11 offset:20480
    v_rcp_f32 v48, v48
    v_rcp_f32 v49, v49
    v_mfma_f32_16x16x32_bf16 v[108:111], v[32:35], v[140:143], v[108:111]
    ds_read_b64_tr_b16 v[66:67], v11 offset:20992
    v_rcp_f32 v50, v50
    s_waitcnt lgkmcnt(4)
    v_mfma_f32_16x16x32_bf16 v[96:99], v[72:75], v[144:147], v[96:99]
    s_waitcnt vmcnt(14)
    s_barrier
    ds_read_b64_tr_b16 v[68:69], v8 offset:24576
    s_add_u32 m0, s50, 8192
    s_add_u32 s51, s48, 2359296
    buffer_load_dwordx4 v21, s[24:27], s51 offen lds
    v_rcp_f32 v51, v51
    v_mfma_f32_16x16x32_bf16 v[96:99], v[76:79], v[152:155], v[96:99]
    ds_read_b64_tr_b16 v[70:71], v8 offset:25088
    v_mul_f32 v80, v80, v48
    v_mul_f32 v81, v81, v49
    v_mfma_f32_16x16x32_bf16 v[104:107], v[72:75], v[148:151], v[104:107]
    ds_read_b64_tr_b16 v[32:33], v8 offset:28672
    buffer_load_dwordx4 v46, s[24:27], s51 offen offset:1024 lds
    v_mul_f32 v82, v82, v50
    v_mul_f32 v83, v83, v51
    v_cvt_pk_bf16_f32 v56, v80, v81
    v_mfma_f32_16x16x32_bf16 v[104:107], v[76:79], v[156:159], v[104:107]
    ds_read_b64_tr_b16 v[34:35], v8 offset:29184
    v_cvt_pk_bf16_f32 v57, v82, v83
    ds_read_b128 v[80:83], v31 offset:0
    s_waitcnt lgkmcnt(5)
    v_mfma_f32_16x16x32_bf16 v[100:103], v[36:39], v[144:147], v[100:103]
    ds_read_b64_tr_b16 v[72:73], v11 offset:24576
    s_add_u32 m0, s50, 57344
    s_add_u32 s51, s48, 3538944
    buffer_load_dwordx4 v21, s[24:27], s51 offen lds
    v_mul_f32 v52, v84, v84
    v_mul_f32 v53, v85, v85
    v_mul_f32 v54, v86, v86
    v_mfma_f32_16x16x32_bf16 v[100:103], v[64:67], v[152:155], v[100:103]
    ds_read_b64_tr_b16 v[74:75], v11 offset:25088
    v_mul_f32 v55, v87, v87
    v_fma_f32 v52, v52, s53, v23
    v_mfma_f32_16x16x32_bf16 v[108:111], v[36:39], v[148:151], v[108:111]
    ds_read_b64_tr_b16 v[76:77], v11 offset:28672
    buffer_load_dwordx4 v46, s[24:27], s51 offen offset:1024 lds
    v_fma_f32 v53, v53, s53, v23
    v_fma_f32 v54, v54, s53, v23
    v_fma_f32 v55, v55, s53, v23
    v_mfma_f32_16x16x32_bf16 v[108:111], v[64:67], v[156:159], v[108:111]
    ds_read_b64_tr_b16 v[78:79], v11 offset:29184
    v_mul_f32 v52, v84, v52
    v_mul_f32 v53, v85, v53
    s_waitcnt lgkmcnt(5)
    v_mfma_f32_16x16x32_bf16 v[96:99], v[68:71], v[160:163], v[96:99]
    ds_read_b64_tr_b16 v[36:37], v9 offset:0
    v_mul_f32 v54, v86, v54
    v_mul_f32 v55, v87, v55
    v_mfma_f32_16x16x32_bf16 v[96:99], v[32:35], v[168:171], v[96:99]
    ds_read_b64_tr_b16 v[38:39], v9 offset:512
    v_exp_f32 v52, v52
    v_exp_f32 v53, v53
    v_mfma_f32_16x16x32_bf16 v[104:107], v[68:71], v[164:167], v[104:107]
    ds_read_b64_tr_b16 v[64:65], v9 offset:4096
    v_exp_f32 v54, v54
    v_mfma_f32_16x16x32_bf16 v[104:107], v[32:35], v[172:175], v[104:107]
    ds_read_b64_tr_b16 v[66:67], v9 offset:4608
    v_exp_f32 v55, v55
    s_waitcnt lgkmcnt(4)
    v_mfma_f32_16x16x32_bf16 v[100:103], v[72:75], v[160:163], v[100:103]
    ds_read_b64_tr_b16 v[68:69], v12 offset:0
    v_add_f32 v52, 1.0, v52
    v_add_f32 v53, 1.0, v53
    v_mfma_f32_16x16x32_bf16 v[100:103], v[76:79], v[168:171], v[100:103]
    ds_read_b64_tr_b16 v[70:71], v12 offset:512
    v_add_f32 v54, 1.0, v54
    v_add_f32 v55, 1.0, v55
    v_mfma_f32_16x16x32_bf16 v[108:111], v[72:75], v[164:167], v[108:111]
    ds_read_b64_tr_b16 v[32:33], v12 offset:4096
    v_rcp_f32 v52, v52
    v_rcp_f32 v53, v53
    v_mfma_f32_16x16x32_bf16 v[108:111], v[76:79], v[172:175], v[108:111]
    ds_read_b64_tr_b16 v[34:35], v12 offset:4608
    v_rcp_f32 v54, v54
    s_waitcnt lgkmcnt(4)
    v_mfma_f32_16x16x32_bf16 v[96:99], v[36:39], v[176:179], v[96:99]
    s_waitcnt vmcnt(13)
    s_barrier
    ds_read_b64_tr_b16 v[72:73], v8 offset:32768
    s_add_u32 m0, s50, 16384
    s_add_u32 s51, s48, 4128768
    buffer_load_dwordx4 v21, s[24:27], s51 offen lds
    v_rcp_f32 v55, v55
    v_mfma_f32_16x16x32_bf16 v[96:99], v[64:67], v[184:187], v[96:99]
    ds_read_b64_tr_b16 v[74:75], v8 offset:33280
    v_mul_f32 v84, v84, v52
    v_mul_f32 v85, v85, v53
    v_mul_f32 v86, v86, v54
    v_mfma_f32_16x16x32_bf16 v[104:107], v[36:39], v[180:183], v[104:107]
    ds_read_b64_tr_b16 v[76:77], v8 offset:36864
    buffer_load_dwordx4 v46, s[24:27], s51 offen offset:1024 lds
    v_mul_f32 v87, v87, v55
    v_cvt_pk_bf16_f32 v58, v84, v85
    v_mfma_f32_16x16x32_bf16 v[104:107], v[64:67], v[188:191], v[104:107]
    ds_read_b64_tr_b16 v[78:79], v8 offset:37376
    v_cvt_pk_bf16_f32 v59, v86, v87
    ds_read_b128 v[84:87], v31 offset:0
    s_waitcnt lgkmcnt(5)
    v_mfma_f32_16x16x32_bf16 v[100:103], v[68:71], v[176:179], v[100:103]
    ds_read_b64_tr_b16 v[36:37], v11 offset:32768
    v_add_u32 v46, 8192, v5
    s_add_u32 m0, s50, 24576
    s_nop 0
    buffer_load_dwordx4 v5, s[28:31], s56 offen lds
    ds_write_b128 v29, v[56:59] offset:49152
    s_add_u32 s52, s82, 32768
    buffer_store_dwordx4 v[56:59], v28, s[32:35], s52 offen sc1
    v_mfma_f32_16x16x32_bf16 v[100:103], v[32:35], v[184:187], v[100:103]
    ds_read_b64_tr_b16 v[38:39], v11 offset:33280
    v_mul_f32 v48, v88, v88
    v_mfma_f32_16x16x32_bf16 v[108:111], v[68:71], v[180:183], v[108:111]
    ds_read_b64_tr_b16 v[64:65], v11 offset:36864
    buffer_load_dwordx4 v46, s[28:31], s56 offen offset:1024 lds
    v_mul_f32 v49, v89, v89
    v_mul_f32 v50, v90, v90
    v_mul_f32 v51, v91, v91
    v_mfma_f32_16x16x32_bf16 v[108:111], v[32:35], v[188:191], v[108:111]
    ds_read_b64_tr_b16 v[66:67], v11 offset:37376
    v_fma_f32 v48, v48, s53, v23
    v_fma_f32 v49, v49, s53, v23
    s_waitcnt lgkmcnt(6)
    v_mfma_f32_16x16x32_bf16 v[96:99], v[72:75], v[192:195], v[96:99]
    ds_read_b64_tr_b16 v[68:69], v8 offset:49152
    v_fma_f32 v50, v50, s53, v23
    v_fma_f32 v51, v51, s53, v23
    v_mul_f32 v48, v88, v48
    v_mfma_f32_16x16x32_bf16 v[96:99], v[76:79], v[200:203], v[96:99]
    ds_read_b64_tr_b16 v[70:71], v8 offset:49664
    v_mul_f32 v49, v89, v49
    v_mul_f32 v50, v90, v50
    v_mfma_f32_16x16x32_bf16 v[104:107], v[72:75], v[196:199], v[104:107]
    ds_read_b64_tr_b16 v[32:33], v8 offset:53248
    v_mul_f32 v51, v91, v51
    v_exp_f32 v48, v48
    v_mfma_f32_16x16x32_bf16 v[104:107], v[76:79], v[204:207], v[104:107]
    ds_read_b64_tr_b16 v[34:35], v8 offset:53760
    v_exp_f32 v49, v49
    s_waitcnt lgkmcnt(4)
    v_mfma_f32_16x16x32_bf16 v[100:103], v[36:39], v[192:195], v[100:103]
    ds_read_b64_tr_b16 v[72:73], v11 offset:49152
    v_exp_f32 v50, v50
    v_mfma_f32_16x16x32_bf16 v[100:103], v[64:67], v[200:203], v[100:103]
    ds_read_b64_tr_b16 v[74:75], v11 offset:49664
    v_exp_f32 v51, v51
    v_add_f32 v48, 1.0, v48
    v_mfma_f32_16x16x32_bf16 v[108:111], v[36:39], v[196:199], v[108:111]
    ds_read_b64_tr_b16 v[76:77], v11 offset:53248
    v_add_f32 v49, 1.0, v49
    v_add_f32 v50, 1.0, v50
    v_add_f32 v51, 1.0, v51
    v_mfma_f32_16x16x32_bf16 v[108:111], v[64:67], v[204:207], v[108:111]
    ds_read_b64_tr_b16 v[78:79], v11 offset:53760
    v_rcp_f32 v48, v48
    s_waitcnt lgkmcnt(4)
    v_mfma_f32_16x16x32_bf16 v[96:99], v[68:71], v[208:211], v[96:99]
    s_waitcnt vmcnt(14)
    s_barrier
    ds_read_b64_tr_b16 v[36:37], v8 offset:40960
    s_add_u32 m0, s50, 32768
    s_add_u32 s51, s56, 73728
    buffer_load_dwordx4 v5, s[28:31], s51 offen lds
    v_rcp_f32 v49, v49
    v_mfma_f32_16x16x32_bf16 v[96:99], v[32:35], v[216:219], v[96:99]
    ds_read_b64_tr_b16 v[38:39], v8 offset:41472
    v_rcp_f32 v50, v50
    v_mfma_f32_16x16x32_bf16 v[104:107], v[68:71], v[212:215], v[104:107]
    ds_read_b64_tr_b16 v[64:65], v8 offset:45056
    buffer_load_dwordx4 v46, s[28:31], s51 offen offset:1024 lds
    v_rcp_f32 v51, v51
    v_mul_f32 v88, v88, v48
    v_mfma_f32_16x16x32_bf16 v[104:107], v[32:35], v[220:223], v[104:107]
    ds_read_b64_tr_b16 v[66:67], v8 offset:45568
    v_mul_f32 v89, v89, v49
    v_mul_f32 v90, v90, v50
    v_mul_f32 v91, v91, v51
    s_waitcnt lgkmcnt(4)
    v_mfma_f32_16x16x32_bf16 v[100:103], v[72:75], v[208:211], v[100:103]
    ds_read_b64_tr_b16 v[68:69], v11 offset:40960
    s_add_u32 m0, s50, 65536
    s_add_u32 s51, s12, 147456
    buffer_load_dwordx4 v5, s[28:31], s51 offen lds
    v_cvt_pk_bf16_f32 v60, v88, v89
    v_cvt_pk_bf16_f32 v61, v90, v91
    v_mfma_f32_16x16x32_bf16 v[100:103], v[76:79], v[216:219], v[100:103]
    ds_read_b64_tr_b16 v[70:71], v11 offset:41472
    v_mul_f32 v52, v92, v92
    v_mul_f32 v53, v93, v93
    v_mul_f32 v54, v94, v94
    v_mfma_f32_16x16x32_bf16 v[108:111], v[72:75], v[212:215], v[108:111]
    ds_read_b64_tr_b16 v[32:33], v11 offset:45056
    buffer_load_dwordx4 v46, s[28:31], s51 offen offset:1024 lds
    v_mul_f32 v55, v95, v95
    v_fma_f32 v52, v52, s53, v23
    v_mfma_f32_16x16x32_bf16 v[108:111], v[76:79], v[220:223], v[108:111]
    ds_read_b64_tr_b16 v[34:35], v11 offset:45568
    v_fma_f32 v53, v53, s53, v23
    v_fma_f32 v54, v54, s53, v23
    v_fma_f32 v55, v55, s53, v23
    s_waitcnt lgkmcnt(4)
    v_mfma_f32_16x16x32_bf16 v[96:99], v[36:39], v[224:227], v[96:99]
    ds_read_b64_tr_b16 v[72:73], v9 offset:8192
    v_mul_f32 v52, v92, v52
    v_mul_f32 v53, v93, v53
    v_mfma_f32_16x16x32_bf16 v[96:99], v[64:67], v[232:235], v[96:99]
    ds_read_b64_tr_b16 v[74:75], v9 offset:8704
    v_mul_f32 v54, v94, v54
    v_mul_f32 v55, v95, v55
    v_mfma_f32_16x16x32_bf16 v[104:107], v[36:39], v[228:231], v[104:107]
    ds_read_b64_tr_b16 v[76:77], v9 offset:12288
    v_exp_f32 v52, v52
    v_exp_f32 v53, v53
    v_mfma_f32_16x16x32_bf16 v[104:107], v[64:67], v[236:239], v[104:107]
    ds_read_b64_tr_b16 v[78:79], v9 offset:12800
    v_exp_f32 v54, v54
    s_waitcnt lgkmcnt(4)
    v_mfma_f32_16x16x32_bf16 v[100:103], v[68:71], v[224:227], v[100:103]
    ds_read_b64_tr_b16 v[36:37], v12 offset:8192
    v_exp_f32 v55, v55
    v_mfma_f32_16x16x32_bf16 v[100:103], v[32:35], v[232:235], v[100:103]
    ds_read_b64_tr_b16 v[38:39], v12 offset:8704
    v_add_f32 v52, 1.0, v52
    v_add_f32 v53, 1.0, v53
    v_mfma_f32_16x16x32_bf16 v[108:111], v[68:71], v[228:231], v[108:111]
    ds_read_b64_tr_b16 v[64:65], v12 offset:12288
    v_add_f32 v54, 1.0, v54
    v_add_f32 v55, 1.0, v55
    v_mfma_f32_16x16x32_bf16 v[108:111], v[32:35], v[236:239], v[108:111]
    ds_read_b64_tr_b16 v[66:67], v12 offset:12800
    v_rcp_f32 v52, v52
    v_rcp_f32 v53, v53
    s_waitcnt lgkmcnt(4)
    v_mfma_f32_16x16x32_bf16 v[96:99], v[72:75], v[240:243], v[96:99]
    s_waitcnt vmcnt(15)
    s_barrier
    ds_read_b64_tr_b16 v[68:69], v25 offset:0
    v_rcp_f32 v54, v54
    v_mfma_f32_16x16x32_bf16 v[96:99], v[76:79], v[248:251], v[96:99]
    ds_read_b64_tr_b16 v[70:71], v25 offset:256
    s_add_u32 m0, s50, 40960
    s_add_u32 s51, s12, 221184
    buffer_load_dwordx4 v5, s[28:31], s51 offen lds
    v_rcp_f32 v55, v55
    v_mfma_f32_16x16x32_bf16 v[104:107], v[72:75], v[244:247], v[104:107]
    ds_read_b64_tr_b16 v[32:33], v25 offset:2048
    v_mul_f32 v92, v92, v52
    v_mul_f32 v93, v93, v53
    v_mul_f32 v94, v94, v54
    v_mfma_f32_16x16x32_bf16 v[104:107], v[76:79], v[252:255], v[104:107]
    ds_read_b64_tr_b16 v[34:35], v25 offset:2304
    v_mul_f32 v95, v95, v55
    v_cvt_pk_bf16_f32 v62, v92, v93
    s_waitcnt lgkmcnt(4)
    v_mfma_f32_16x16x32_bf16 v[100:103], v[36:39], v[240:243], v[100:103]
    ds_read_b64_tr_b16 v[72:73], v25 offset:4096
    v_cvt_pk_bf16_f32 v63, v94, v95
    ds_write_b128 v29, v[60:63] offset:50176
    v_mfma_f32_16x16x32_bf16 v[100:103], v[64:67], v[248:251], v[100:103]
    ds_read_b64_tr_b16 v[74:75], v25 offset:4352
    buffer_load_dwordx4 v46, s[28:31], s51 offen offset:1024 lds
    s_add_u32 s52, s82, 33792
    buffer_store_dwordx4 v[60:63], v28, s[32:35], s52 offen sc1
    v_mfma_f32_16x16x32_bf16 v[108:111], v[36:39], v[244:247], v[108:111]
    ds_read_b64_tr_b16 v[76:77], v25 offset:6144
    v_mfma_f32_16x16x32_bf16 v[108:111], v[64:67], v[252:255], v[108:111]
    ds_read_b64_tr_b16 v[78:79], v25 offset:6400
    v_lshrrev_b32 v6, 2, v1
    v_and_b32 v7, 3, v1
    v_lshlrev_b32 v7, 3, v7
    v_lshl_add_u32 v6, v6, 6, v7
    v_bfe_u32 v7, v1, 4, 1
    v_lshl_add_u32 v8, v7, 5, v6
    v_add_u32 v9, 65536, v8
    v_add_u32 v10, 131072, v8
    s_waitcnt lgkmcnt(5)
    v_mfma_f32_16x16x32_bf16 v[80:83], v[68:71], v[112:115], v[80:83]
    s_waitcnt vmcnt(16) lgkmcnt(3)
    s_barrier
    ds_read_b64_tr_b16 v[36:37], v27 offset:16384
    v_mfma_f32_16x16x32_bf16 v[80:83], v[32:35], v[120:123], v[80:83]
    ds_read_b64_tr_b16 v[38:39], v27 offset:16640
    v_add_u32 v46, 17408, v47
    s_add_u32 m0, s50, 49152
    s_nop 0
    buffer_load_dwordx4 v47, s[28:31], s68 offen lds
    v_mfma_f32_16x16x32_bf16 v[84:87], v[68:71], v[116:119], v[84:87]
    ds_read_b64_tr_b16 v[64:65], v27 offset:18432
    v_mfma_f32_16x16x32_bf16 v[84:87], v[32:35], v[124:127], v[84:87]
    ds_read_b64_tr_b16 v[66:67], v27 offset:18688
    s_waitcnt lgkmcnt(4)
    v_mfma_f32_16x16x32_bf16 v[80:83], v[72:75], v[128:131], v[80:83]
    ds_read_b64_tr_b16 v[68:69], v27 offset:20480
    v_mul_f32 v48, v96, v96
    v_mul_f32 v49, v97, v97
    v_mul_f32 v50, v98, v98
    v_mul_f32 v51, v99, v99
    v_fma_f32 v48, v48, s53, v23
    v_mfma_f32_16x16x32_bf16 v[80:83], v[76:79], v[136:139], v[80:83]
    ds_read_b64_tr_b16 v[70:71], v27 offset:20736
    buffer_load_dwordx4 v46, s[28:31], s68 offen offset:1024 lds
    v_fma_f32 v49, v49, s53, v23
    v_fma_f32 v50, v50, s53, v23
    v_fma_f32 v51, v51, s53, v23
    v_mul_f32 v48, v96, v48
    v_mul_f32 v49, v97, v49
    v_mfma_f32_16x16x32_bf16 v[84:87], v[72:75], v[132:135], v[84:87]
    ds_read_b64_tr_b16 v[32:33], v27 offset:22528
    v_mul_f32 v50, v98, v50
    v_mul_f32 v51, v99, v51
    v_exp_f32 v48, v48
    v_exp_f32 v49, v49
    v_mfma_f32_16x16x32_bf16 v[84:87], v[76:79], v[140:143], v[84:87]
    ds_read_b64_tr_b16 v[34:35], v27 offset:22784
    v_exp_f32 v50, v50
    v_exp_f32 v51, v51
    s_waitcnt lgkmcnt(4)
    v_mfma_f32_16x16x32_bf16 v[80:83], v[36:39], v[144:147], v[80:83]
    s_waitcnt vmcnt(16)
    s_barrier
    ds_read_b64_tr_b16 v[72:73], v25 offset:8192
    v_add_f32 v48, 1.0, v48
    v_add_f32 v49, 1.0, v49
    v_add_f32 v50, 1.0, v50
    v_add_f32 v51, 1.0, v51
    v_rcp_f32 v48, v48
    v_mfma_f32_16x16x32_bf16 v[80:83], v[64:67], v[152:155], v[80:83]
    ds_read_b64_tr_b16 v[74:75], v25 offset:8448
    s_add_u32 m0, s50, 0
    s_add_u32 s51, s85, 147456
    buffer_load_dwordx4 v47, s[28:31], s51 offen lds
    v_rcp_f32 v49, v49
    v_rcp_f32 v50, v50
    ds_read_b128 v[112:115], v29 offset:16384
    v_mfma_f32_16x16x32_bf16 v[84:87], v[36:39], v[148:151], v[84:87]
    ds_read_b64_tr_b16 v[76:77], v25 offset:10240
    v_rcp_f32 v51, v51
    v_mul_f32 v96, v96, v48
    v_mul_f32 v97, v97, v49
    v_mul_f32 v98, v98, v50
    v_mfma_f32_16x16x32_bf16 v[84:87], v[64:67], v[156:159], v[84:87]
    ds_read_b64_tr_b16 v[78:79], v25 offset:10496
    v_mul_f32 v99, v99, v51
    v_cvt_pk_bf16_f32 v56, v96, v97
    v_cvt_pk_bf16_f32 v57, v98, v99
    v_mul_f32 v52, v100, v100
    v_mul_f32 v53, v101, v101
    ds_read_b128 v[116:119], v29 offset:17408
    s_waitcnt lgkmcnt(6)
    v_mfma_f32_16x16x32_bf16 v[80:83], v[68:71], v[160:163], v[80:83]
    ds_read_b64_tr_b16 v[36:37], v25 offset:12288
    v_mul_f32 v54, v102, v102
    v_mul_f32 v55, v103, v103
    v_fma_f32 v52, v52, s53, v23
    v_fma_f32 v53, v53, s53, v23
    v_fma_f32 v54, v54, s53, v23
    v_mfma_f32_16x16x32_bf16 v[80:83], v[32:35], v[168:171], v[80:83]
    ds_read_b64_tr_b16 v[38:39], v25 offset:12544
    buffer_load_dwordx4 v46, s[28:31], s51 offen offset:1024 lds
    v_fma_f32 v55, v55, s53, v23
    v_mul_f32 v52, v100, v52
    v_mul_f32 v53, v101, v53
    v_mul_f32 v54, v102, v54
    v_mul_f32 v55, v103, v55
    ds_read_b128 v[120:123], v29 offset:24576
    v_mfma_f32_16x16x32_bf16 v[84:87], v[68:71], v[164:167], v[84:87]
    ds_read_b64_tr_b16 v[64:65], v25 offset:14336
    v_exp_f32 v52, v52
    v_exp_f32 v53, v53
    v_exp_f32 v54, v54
    v_mfma_f32_16x16x32_bf16 v[84:87], v[32:35], v[172:175], v[84:87]
    ds_read_b64_tr_b16 v[66:67], v25 offset:14592
    v_exp_f32 v55, v55
    v_add_f32 v52, 1.0, v52
    v_add_f32 v53, 1.0, v53
    ds_read_b128 v[124:127], v29 offset:25600
    s_waitcnt lgkmcnt(7)
    v_mfma_f32_16x16x32_bf16 v[80:83], v[72:75], v[176:179], v[80:83]
    s_waitcnt vmcnt(4)
    s_barrier
    ds_read_b64_tr_b16 v[68:69], v25 offset:57344
    v_add_f32 v54, 1.0, v54
    v_add_f32 v55, 1.0, v55
    v_rcp_f32 v52, v52
    v_rcp_f32 v53, v53
    v_mfma_f32_16x16x32_bf16 v[80:83], v[76:79], v[184:187], v[80:83]
    ds_read_b64_tr_b16 v[70:71], v25 offset:57600
    v_add_u32 v46, 8192, v5
    s_add_u32 m0, s50, 73728
    s_nop 0
    buffer_load_dwordx4 v5, s[28:31], s57 offen lds
    v_rcp_f32 v54, v54
    v_rcp_f32 v55, v55
    ds_read_b128 v[128:131], v29 offset:32768
    v_mfma_f32_16x16x32_bf16 v[84:87], v[72:75], v[180:183], v[84:87]
    ds_read_b64_tr_b16 v[32:33], v25 offset:59392
    v_mul_f32 v100, v100, v52
    v_mul_f32 v101, v101, v53
    v_mul_f32 v102, v102, v54
    v_mul_f32 v103, v103, v55
    v_cvt_pk_bf16_f32 v58, v100, v101
    v_mfma_f32_16x16x32_bf16 v[84:87], v[76:79], v[188:191], v[84:87]
    ds_read_b64_tr_b16 v[34:35], v25 offset:59648
    v_cvt_pk_bf16_f32 v59, v102, v103
    ds_write_b128 v30, v[56:59] offset:0
    s_add_u32 s52, s82, 49152
    buffer_store_dwordx4 v[56:59], v28, s[32:35], s52 offen sc1
    ds_read_b128 v[132:135], v29 offset:33792
    s_waitcnt lgkmcnt(8)
    v_mfma_f32_16x16x32_bf16 v[80:83], v[36:39], v[192:195], v[80:83]
    ds_read_b64_tr_b16 v[72:73], v25 offset:61440
    v_mul_f32 v48, v104, v104
    v_mul_f32 v49, v105, v105
    v_mul_f32 v50, v106, v106
    v_mul_f32 v51, v107, v107
    v_fma_f32 v48, v48, s53, v23
    v_mfma_f32_16x16x32_bf16 v[80:83], v[64:67], v[200:203], v[80:83]
    ds_read_b64_tr_b16 v[74:75], v25 offset:61696
    buffer_load_dwordx4 v46, s[28:31], s57 offen offset:1024 lds
    v_fma_f32 v49, v49, s53, v23
    v_fma_f32 v50, v50, s53, v23
    v_fma_f32 v51, v51, s53, v23
    v_mul_f32 v48, v104, v48
    v_mul_f32 v49, v105, v49
    ds_read_b128 v[136:139], v29 offset:40960
    v_mfma_f32_16x16x32_bf16 v[84:87], v[36:39], v[196:199], v[84:87]
    ds_read_b64_tr_b16 v[76:77], v25 offset:63488
    v_mul_f32 v50, v106, v50
    v_mul_f32 v51, v107, v51
    v_exp_f32 v48, v48
    v_exp_f32 v49, v49
    v_mfma_f32_16x16x32_bf16 v[84:87], v[64:67], v[204:207], v[84:87]
    ds_read_b64_tr_b16 v[78:79], v25 offset:63744
    v_exp_f32 v50, v50
    v_exp_f32 v51, v51
    ds_read_b128 v[140:143], v29 offset:41984
    s_waitcnt lgkmcnt(8)
    v_mfma_f32_16x16x32_bf16 v[80:83], v[68:71], v[208:211], v[80:83]
    s_barrier
    ds_read_b64_tr_b16 v[36:37], v25 offset:20480
    s_add_u32 m0, s50, 8192
    s_add_u32 s51, s57, 73728
    buffer_load_dwordx4 v5, s[28:31], s51 offen lds
    v_add_f32 v48, 1.0, v48
    v_add_f32 v49, 1.0, v49
    v_add_f32 v50, 1.0, v50
    v_add_f32 v51, 1.0, v51
    v_rcp_f32 v48, v48
    v_mfma_f32_16x16x32_bf16 v[80:83], v[32:35], v[216:219], v[80:83]
    ds_read_b64_tr_b16 v[38:39], v25 offset:20736
    v_rcp_f32 v49, v49
    v_rcp_f32 v50, v50
    ds_read_b128 v[144:147], v29 offset:49152
    v_mfma_f32_16x16x32_bf16 v[84:87], v[68:71], v[212:215], v[84:87]
    ds_read_b64_tr_b16 v[64:65], v25 offset:22528
    buffer_load_dwordx4 v46, s[28:31], s51 offen offset:1024 lds
    v_rcp_f32 v51, v51
    v_mul_f32 v104, v104, v48
    v_mul_f32 v105, v105, v49
    v_mul_f32 v106, v106, v50
    v_mfma_f32_16x16x32_bf16 v[84:87], v[32:35], v[220:223], v[84:87]
    ds_read_b64_tr_b16 v[66:67], v25 offset:22784
    v_mul_f32 v107, v107, v51
    v_cvt_pk_bf16_f32 v60, v104, v105
    v_cvt_pk_bf16_f32 v61, v106, v107
    v_mul_f32 v52, v108, v108
    v_mul_f32 v53, v109, v109
    ds_read_b128 v[148:151], v29 offset:50176
    s_waitcnt lgkmcnt(7)
    v_mfma_f32_16x16x32_bf16 v[80:83], v[72:75], v[224:227], v[80:83]
    s_add_u32 m0, s50, 81920
    s_add_u32 s51, s13, 147456
    buffer_load_dwordx4 v5, s[28:31], s51 offen lds
    v_mul_f32 v54, v110, v110
    v_mul_f32 v55, v111, v111
    v_fma_f32 v52, v52, s53, v23
    v_fma_f32 v53, v53, s53, v23
    v_fma_f32 v54, v54, s53, v23
    v_mfma_f32_16x16x32_bf16 v[80:83], v[76:79], v[232:235], v[80:83]
    v_fma_f32 v55, v55, s53, v23
    v_mul_f32 v52, v108, v52
    v_mul_f32 v53, v109, v53
    v_mul_f32 v54, v110, v54
    v_mul_f32 v55, v111, v55
    ds_read_b128 v[152:155], v29 offset:57344
    v_mfma_f32_16x16x32_bf16 v[84:87], v[72:75], v[228:231], v[84:87]
    buffer_load_dwordx4 v46, s[28:31], s51 offen offset:1024 lds
    v_exp_f32 v52, v52
    v_exp_f32 v53, v53
    v_exp_f32 v54, v54
    v_mfma_f32_16x16x32_bf16 v[84:87], v[76:79], v[236:239], v[84:87]
    v_exp_f32 v55, v55
    v_add_f32 v52, 1.0, v52
    v_add_f32 v53, 1.0, v53
    ds_read_b128 v[156:159], v29 offset:58368
    s_waitcnt lgkmcnt(3)
    v_mfma_f32_16x16x32_bf16 v[80:83], v[36:39], v[240:243], v[80:83]
    s_barrier
    ds_read_b64_tr_b16 v[68:69], v14 offset:24576
    ds_read_b64_tr_b16 v[70:71], v14 offset:26624
    s_add_u32 m0, s50, 57344
    s_add_u32 s51, s13, 221184
    buffer_load_dwordx4 v5, s[28:31], s51 offen lds
    v_add_f32 v54, 1.0, v54
    v_add_f32 v55, 1.0, v55
    v_rcp_f32 v52, v52
    v_rcp_f32 v53, v53
    v_mfma_f32_16x16x32_bf16 v[80:83], v[64:67], v[248:251], v[80:83]
    ds_read_b64_tr_b16 v[32:33], v14 offset:28672
    ds_read_b64_tr_b16 v[34:35], v14 offset:30720
    buffer_load_dwordx4 v46, s[28:31], s51 offen offset:1024 lds
    v_rcp_f32 v54, v54
    v_rcp_f32 v55, v55
    v_mfma_f32_16x16x32_bf16 v[84:87], v[36:39], v[244:247], v[84:87]
    ds_read_b64_tr_b16 v[72:73], v17 offset:24576
    ds_read_b64_tr_b16 v[74:75], v17 offset:26624
    s_add_u32 m0, s50, 90112
    s_nop 0
    buffer_load_dwordx4 v5, s[28:31], s60 offen lds
    v_mul_f32 v108, v108, v52
    v_mul_f32 v109, v109, v53
    v_mul_f32 v110, v110, v54
    v_mul_f32 v111, v111, v55
    v_cvt_pk_bf16_f32 v62, v108, v109
    v_mfma_f32_16x16x32_bf16 v[84:87], v[64:67], v[252:255], v[84:87]
    ds_read_b64_tr_b16 v[76:77], v17 offset:28672
    ds_read_b64_tr_b16 v[78:79], v17 offset:30720
    buffer_load_dwordx4 v46, s[28:31], s60 offen offset:1024 lds
    v_cvt_pk_bf16_f32 v63, v110, v111
    ds_write_b128 v30, v[60:63] offset:1024
    s_add_u32 s52, s82, 50176
    buffer_store_dwordx4 v[60:63], v28, s[32:35], s52 offen sc1
    s_waitcnt lgkmcnt(5)
    v_mfma_f32_16x16x32_bf16 v[96:99], v[68:71], v[112:115], 0
    s_barrier
    ds_read_b64_tr_b16 v[64:65], v14 offset:32768
    s_add_u32 m0, s50, 16384
    s_nop 0
    buffer_load_dwordx4 v5, s[28:31], s61 offen lds
    v_mfma_f32_16x16x32_bf16 v[96:99], v[32:35], v[120:123], v[96:99]
    ds_read_b64_tr_b16 v[66:67], v14 offset:34816
    v_mul_f32 v48, v80, v80
    v_mul_f32 v49, v81, v81
    v_mul_f32 v50, v82, v82
    v_mfma_f32_16x16x32_bf16 v[100:103], v[68:71], v[116:119], 0
    ds_read_b64_tr_b16 v[232:233], v14 offset:36864
    buffer_load_dwordx4 v46, s[28:31], s61 offen offset:1024 lds
    v_mul_f32 v51, v83, v83
    v_fma_f32 v48, v48, s53, v23
    v_fma_f32 v49, v49, s53, v23
    v_fma_f32 v50, v50, s53, v23
    v_mfma_f32_16x16x32_bf16 v[100:103], v[32:35], v[124:127], v[100:103]
    ds_read_b64_tr_b16 v[234:235], v14 offset:38912
    v_fma_f32 v51, v51, s53, v23
    v_mul_f32 v48, v80, v48
    v_mul_f32 v49, v81, v49
    s_waitcnt lgkmcnt(5)
    v_mfma_f32_16x16x32_bf16 v[104:107], v[72:75], v[112:115], 0
    ds_read_b64_tr_b16 v[236:237], v17 offset:32768
    s_add_u32 m0, s50, 98304
    s_add_u32 s51, s60, 73728
    buffer_load_dwordx4 v5, s[28:31], s51 offen lds
    v_mul_f32 v50, v82, v50
    v_mul_f32 v51, v83, v51
    v_exp_f32 v48, v48
    v_mfma_f32_16x16x32_bf16 v[104:107], v[76:79], v[120:123], v[104:107]
    ds_read_b64_tr_b16 v[238:239], v17 offset:34816
    v_exp_f32 v49, v49
    v_exp_f32 v50, v50
    v_mfma_f32_16x16x32_bf16 v[108:111], v[72:75], v[116:119], 0
    ds_read_b64_tr_b16 v[240:241], v17 offset:36864
    buffer_load_dwordx4 v46, s[28:31], s51 offen offset:1024 lds
    v_exp_f32 v51, v51
    v_add_f32 v48, 1.0, v48
    v_mfma_f32_16x16x32_bf16 v[108:111], v[76:79], v[124:127], v[108:111]
    ds_read_b64_tr_b16 v[242:243], v17 offset:38912
    v_add_f32 v49, 1.0, v49
    v_add_f32 v50, 1.0, v50
    v_add_f32 v51, 1.0, v51
    s_waitcnt lgkmcnt(4)
    v_mfma_f32_16x16x32_bf16 v[96:99], v[64:67], v[128:131], v[96:99]
    s_barrier
    ds_read_b64_tr_b16 v[244:245], v15 offset:0
    v_rcp_f32 v48, v48
    v_rcp_f32 v49, v49
    v_mfma_f32_16x16x32_bf16 v[96:99], v[232:235], v[136:139], v[96:99]
    ds_read_b64_tr_b16 v[246:247], v15 offset:2048
    v_rcp_f32 v50, v50
    v_rcp_f32 v51, v51
    ds_read_b128 v[160:163], v30 offset:0
    v_mfma_f32_16x16x32_bf16 v[100:103], v[64:67], v[132:135], v[100:103]
    ds_read_b64_tr_b16 v[68:69], v15 offset:4096
    v_mul_f32 v80, v80, v48
    v_mul_f32 v81, v81, v49
    v_mul_f32 v82, v82, v50
    v_mfma_f32_16x16x32_bf16 v[100:103], v[232:235], v[140:143], v[100:103]
    ds_read_b64_tr_b16 v[70:71], v15 offset:6144
    v_mul_f32 v83, v83, v51
    v_cvt_pk_bf16_f32 v56, v80, v81
    v_cvt_pk_bf16_f32 v57, v82, v83
    ds_read_b128 v[164:167], v30 offset:1024
    s_waitcnt lgkmcnt(6)
    v_mfma_f32_16x16x32_bf16 v[104:107], v[236:239], v[128:131], v[104:107]
    ds_read_b64_tr_b16 v[72:73], v18 offset:0
    v_mul_f32 v52, v84, v84
    v_mul_f32 v53, v85, v85
    v_mul_f32 v54, v86, v86
    v_mul_f32 v55, v87, v87
    v_mfma_f32_16x16x32_bf16 v[104:107], v[240:243], v[136:139], v[104:107]
    ds_read_b64_tr_b16 v[74:75], v18 offset:2048
    v_fma_f32 v52, v52, s53, v23
    v_fma_f32 v53, v53, s53, v23
    v_fma_f32 v54, v54, s53, v23
    ds_read_b128 v[168:171], v30 offset:8192
    v_mfma_f32_16x16x32_bf16 v[108:111], v[236:239], v[132:135], v[108:111]
    ds_read_b64_tr_b16 v[76:77], v18 offset:4096
    v_fma_f32 v55, v55, s53, v23
    v_mul_f32 v52, v84, v52
    v_mul_f32 v53, v85, v53
    v_mul_f32 v54, v86, v54
    v_mfma_f32_16x16x32_bf16 v[108:111], v[240:243], v[140:143], v[108:111]
    ds_read_b64_tr_b16 v[78:79], v18 offset:6144
    v_mul_f32 v55, v87, v55
    v_exp_f32 v52, v52
    ds_read_b128 v[172:175], v30 offset:9216
    s_waitcnt lgkmcnt(7)
    v_mfma_f32_16x16x32_bf16 v[96:99], v[244:247], v[144:147], v[96:99]
    s_barrier
    ds_read_b64_tr_b16 v[64:65], v14 offset:40960
    v_exp_f32 v53, v53
    v_exp_f32 v54, v54
    v_mfma_f32_16x16x32_bf16 v[96:99], v[68:71], v[152:155], v[96:99]
    ds_read_b64_tr_b16 v[66:67], v14 offset:43008
    v_exp_f32 v55, v55
    v_add_f32 v52, 1.0, v52
    v_mfma_f32_16x16x32_bf16 v[100:103], v[244:247], v[148:151], v[100:103]
    ds_read_b64_tr_b16 v[232:233], v14 offset:45056
    v_add_f32 v53, 1.0, v53
    v_add_f32 v54, 1.0, v54
    v_add_f32 v55, 1.0, v55
    v_mfma_f32_16x16x32_bf16 v[100:103], v[68:71], v[156:159], v[100:103]
    ds_read_b64_tr_b16 v[234:235], v14 offset:47104
    v_rcp_f32 v52, v52
    v_rcp_f32 v53, v53
    s_waitcnt lgkmcnt(5)
    v_mfma_f32_16x16x32_bf16 v[104:107], v[72:75], v[144:147], v[104:107]
    ds_read_b64_tr_b16 v[236:237], v17 offset:40960
    v_rcp_f32 v54, v54
    v_rcp_f32 v55, v55
    v_mfma_f32_16x16x32_bf16 v[104:107], v[76:79], v[152:155], v[104:107]
    ds_read_b64_tr_b16 v[238:239], v17 offset:43008
    v_mul_f32 v84, v84, v52
    v_mul_f32 v85, v85, v53
    v_mul_f32 v86, v86, v54
    v_mfma_f32_16x16x32_bf16 v[108:111], v[72:75], v[148:151], v[108:111]
    ds_read_b64_tr_b16 v[240:241], v17 offset:45056
    v_mul_f32 v87, v87, v55
    v_cvt_pk_bf16_f32 v58, v84, v85
    v_cvt_pk_bf16_f32 v59, v86, v87
    s_nop 0
    v_permlane16_swap_b32 v56, v58
    v_mfma_f32_16x16x32_bf16 v[108:111], v[76:79], v[156:159], v[108:111]
    ds_read_b64_tr_b16 v[242:243], v17 offset:47104
    v_permlane16_swap_b32 v57, v59
    ds_write_b128 v22, v[56:59] offset:0
    s_sub_u32 s52, s82, 81920
    buffer_store_dwordx4 v[56:59], v22, s[32:35], s52 offen sc1
    s_waitcnt lgkmcnt(5)
    v_mfma_f32_16x16x32_bf16 v[96:99], v[64:67], v[160:163], v[96:99]
    s_waitcnt vmcnt(19)
    s_barrier
    ds_read_b64_tr_b16 v[244:245], v8 offset:49152
    s_add_u32 m0, s50, 65536
    s_add_u32 s51, s61, 73728
    buffer_load_dwordx4 v5, s[28:31], s51 offen lds
    v_mfma_f32_16x16x32_bf16 v[96:99], v[232:235], v[168:171], v[96:99]
    ds_read_b64_tr_b16 v[246:247], v8 offset:50176
    v_mfma_f32_16x16x32_bf16 v[100:103], v[64:67], v[164:167], v[100:103]
    ds_read_b64_tr_b16 v[68:69], v8 offset:51200
    buffer_load_dwordx4 v46, s[28:31], s51 offen offset:1024 lds
    v_mfma_f32_16x16x32_bf16 v[100:103], v[232:235], v[172:175], v[100:103]
    ds_read_b64_tr_b16 v[70:71], v8 offset:52224
    s_waitcnt lgkmcnt(5)
    v_mfma_f32_16x16x32_bf16 v[104:107], v[236:239], v[160:163], v[104:107]
    ds_read_b64_tr_b16 v[72:73], v8 offset:53248
    v_add_u32 v46, 17408, v47
    s_add_u32 m0, s50, 106496
    s_nop 0
    buffer_load_dwordx4 v47, s[28:31], s69 offen lds
    v_mfma_f32_16x16x32_bf16 v[104:107], v[240:243], v[168:171], v[104:107]
    ds_read_b64_tr_b16 v[74:75], v8 offset:54272
    v_mfma_f32_16x16x32_bf16 v[108:111], v[236:239], v[164:167], v[108:111]
    ds_read_b64_tr_b16 v[76:77], v8 offset:55296
    buffer_load_dwordx4 v46, s[28:31], s69 offen offset:1024 lds
    v_mfma_f32_16x16x32_bf16 v[108:111], v[240:243], v[172:175], v[108:111]
    ds_read_b64_tr_b16 v[78:79], v8 offset:56320
    s_waitcnt lgkmcnt(4)
    v_mfma_f32_16x16x32_bf16 v[32:35], v[244:247], v[112:115], 0
    s_waitcnt vmcnt(9)
    s_barrier
    ds_read_b64_tr_b16 v[64:65], v8 offset:0
    v_mfma_f32_16x16x32_bf16 v[32:35], v[68:71], v[120:123], v[32:35]
    ds_read_b64_tr_b16 v[66:67], v8 offset:1024
    v_mfma_f32_16x16x32_bf16 v[36:39], v[244:247], v[116:119], 0
    ds_read_b64_tr_b16 v[232:233], v8 offset:2048
    v_mfma_f32_16x16x32_bf16 v[36:39], v[68:71], v[124:127], v[36:39]
    ds_read_b64_tr_b16 v[234:235], v8 offset:3072
    s_waitcnt lgkmcnt(4)
    v_mfma_f32_16x16x32_bf16 v[32:35], v[72:75], v[128:131], v[32:35]
    ds_read_b64_tr_b16 v[236:237], v8 offset:4096
    v_mfma_f32_16x16x32_bf16 v[32:35], v[76:79], v[136:139], v[32:35]
    ds_read_b64_tr_b16 v[238:239], v8 offset:5120
    v_mfma_f32_16x16x32_bf16 v[36:39], v[72:75], v[132:135], v[36:39]
    ds_read_b64_tr_b16 v[240:241], v8 offset:6144
    v_mfma_f32_16x16x32_bf16 v[36:39], v[76:79], v[140:143], v[36:39]
    ds_read_b64_tr_b16 v[242:243], v8 offset:7168
    s_waitcnt lgkmcnt(4)
    v_mfma_f32_16x16x32_bf16 v[32:35], v[64:67], v[144:147], v[32:35]
    s_barrier
    ds_read_b64_tr_b16 v[244:245], v15 offset:8192
    v_mfma_f32_16x16x32_bf16 v[32:35], v[232:235], v[152:155], v[32:35]
    ds_read_b64_tr_b16 v[246:247], v15 offset:10240
    v_mfma_f32_16x16x32_bf16 v[36:39], v[64:67], v[148:151], v[36:39]
    ds_read_b64_tr_b16 v[68:69], v15 offset:12288
    v_mfma_f32_16x16x32_bf16 v[36:39], v[232:235], v[156:159], v[36:39]
    ds_read_b64_tr_b16 v[70:71], v15 offset:14336
    s_waitcnt lgkmcnt(4)
    v_mfma_f32_16x16x32_bf16 v[32:35], v[236:239], v[160:163], v[32:35]
    ds_read_b64_tr_b16 v[72:73], v18 offset:8192
    v_mfma_f32_16x16x32_bf16 v[32:35], v[240:243], v[168:171], v[32:35]
    ds_read_b64_tr_b16 v[74:75], v18 offset:10240
    v_mfma_f32_16x16x32_bf16 v[36:39], v[236:239], v[164:167], v[36:39]
    ds_read_b64_tr_b16 v[76:77], v18 offset:12288
    v_mfma_f32_16x16x32_bf16 v[36:39], v[240:243], v[172:175], v[36:39]
    ds_read_b64_tr_b16 v[78:79], v18 offset:14336
    s_waitcnt lgkmcnt(4)
    v_mfma_f32_16x16x32_bf16 v[80:83], v[244:247], v[112:115], 0
    s_barrier
    ds_read_b64_tr_b16 v[64:65], v14 offset:8192
    v_add_u32 v46, 8192, v5
    s_add_u32 m0, s50, 49152
    s_add_u32 s51, s16, 147456
    buffer_load_dwordx4 v5, s[28:31], s51 offen lds
    v_mfma_f32_16x16x32_bf16 v[80:83], v[68:71], v[120:123], v[80:83]
    ds_read_b64_tr_b16 v[66:67], v14 offset:10240
    ds_read_b128 v[176:179], v30 offset:16384
    v_mfma_f32_16x16x32_bf16 v[84:87], v[244:247], v[116:119], 0
    ds_read_b64_tr_b16 v[232:233], v14 offset:12288
    buffer_load_dwordx4 v46, s[28:31], s51 offen offset:1024 lds
    v_mfma_f32_16x16x32_bf16 v[84:87], v[68:71], v[124:127], v[84:87]
    ds_read_b64_tr_b16 v[234:235], v14 offset:14336
    ds_read_b128 v[180:183], v30 offset:17408
    s_waitcnt lgkmcnt(6)
    v_mfma_f32_16x16x32_bf16 v[88:91], v[72:75], v[112:115], 0
    ds_read_b64_tr_b16 v[236:237], v17 offset:8192
    s_add_u32 m0, s50, 114688
    s_add_u32 s51, s17, 147456
    buffer_load_dwordx4 v5, s[28:31], s51 offen lds
    v_mfma_f32_16x16x32_bf16 v[88:91], v[76:79], v[120:123], v[88:91]
    ds_read_b64_tr_b16 v[238:239], v17 offset:10240
    v_mfma_f32_16x16x32_bf16 v[92:95], v[72:75], v[116:119], 0
    ds_read_b64_tr_b16 v[240:241], v17 offset:12288
    buffer_load_dwordx4 v46, s[28:31], s51 offen offset:1024 lds
    v_mfma_f32_16x16x32_bf16 v[92:95], v[76:79], v[124:127], v[92:95]
    ds_read_b64_tr_b16 v[242:243], v17 offset:14336
    s_waitcnt lgkmcnt(5)
    v_mfma_f32_16x16x32_bf16 v[80:83], v[64:67], v[128:131], v[80:83]
    s_barrier
    ds_read_b64_tr_b16 v[244:245], v15 offset:16384
    v_mfma_f32_16x16x32_bf16 v[80:83], v[232:235], v[136:139], v[80:83]
    ds_read_b64_tr_b16 v[246:247], v15 offset:18432
    v_mfma_f32_16x16x32_bf16 v[84:87], v[64:67], v[132:135], v[84:87]
    ds_read_b64_tr_b16 v[68:69], v15 offset:20480
    v_mfma_f32_16x16x32_bf16 v[84:87], v[232:235], v[140:143], v[84:87]
    ds_read_b64_tr_b16 v[70:71], v15 offset:22528
    s_waitcnt lgkmcnt(4)
    v_mfma_f32_16x16x32_bf16 v[88:91], v[236:239], v[128:131], v[88:91]
    ds_read_b64_tr_b16 v[72:73], v18 offset:16384
    v_mfma_f32_16x16x32_bf16 v[88:91], v[240:243], v[136:139], v[88:91]
    ds_read_b64_tr_b16 v[74:75], v18 offset:18432
    v_mfma_f32_16x16x32_bf16 v[92:95], v[236:239], v[132:135], v[92:95]
    ds_read_b64_tr_b16 v[76:77], v18 offset:20480
    v_mfma_f32_16x16x32_bf16 v[92:95], v[240:243], v[140:143], v[92:95]
    ds_read_b64_tr_b16 v[78:79], v18 offset:22528
    s_waitcnt lgkmcnt(4)
    v_mfma_f32_16x16x32_bf16 v[80:83], v[244:247], v[144:147], v[80:83]
    s_waitcnt vmcnt(8)
    s_barrier
    ds_read_b64_tr_b16 v[64:65], v14 offset:57344
    v_mfma_f32_16x16x32_bf16 v[80:83], v[68:71], v[152:155], v[80:83]
    ds_read_b64_tr_b16 v[66:67], v14 offset:59392
    ds_read_b128 v[192:195], v28 offset:32768
    v_mfma_f32_16x16x32_bf16 v[84:87], v[244:247], v[148:151], v[84:87]
    ds_read_b64_tr_b16 v[232:233], v14 offset:61440
    v_mfma_f32_16x16x32_bf16 v[84:87], v[68:71], v[156:159], v[84:87]
    ds_read_b64_tr_b16 v[234:235], v14 offset:63488
    ds_read_b128 v[196:199], v28 offset:33792
    s_waitcnt lgkmcnt(6)
    v_mfma_f32_16x16x32_bf16 v[88:91], v[72:75], v[144:147], v[88:91]
    ds_read_b64_tr_b16 v[236:237], v17 offset:57344
    v_mfma_f32_16x16x32_bf16 v[88:91], v[76:79], v[152:155], v[88:91]
    ds_read_b64_tr_b16 v[238:239], v17 offset:59392
    ds_read_b128 v[184:187], v28 offset:24576
    v_mfma_f32_16x16x32_bf16 v[92:95], v[72:75], v[148:151], v[92:95]
    ds_read_b64_tr_b16 v[240:241], v17 offset:61440
    v_mfma_f32_16x16x32_bf16 v[92:95], v[76:79], v[156:159], v[92:95]
    ds_read_b64_tr_b16 v[242:243], v17 offset:63488
    ds_read_b128 v[188:191], v28 offset:25600
    s_waitcnt lgkmcnt(7)
    v_mfma_f32_16x16x32_bf16 v[80:83], v[64:67], v[160:163], v[80:83]
    s_barrier
    ds_read_b64_tr_b16 v[244:245], v15 offset:24576
    s_add_u32 m0, s50, 81920
    s_nop 0
    buffer_load_dwordx4 v5, s[28:31], s58 offen lds
    v_mfma_f32_16x16x32_bf16 v[80:83], v[232:235], v[168:171], v[80:83]
    ds_read_b64_tr_b16 v[246:247], v15 offset:26624
    v_mfma_f32_16x16x32_bf16 v[84:87], v[64:67], v[164:167], v[84:87]
    ds_read_b64_tr_b16 v[68:69], v15 offset:28672
    buffer_load_dwordx4 v46, s[28:31], s58 offen offset:1024 lds
    v_mfma_f32_16x16x32_bf16 v[84:87], v[232:235], v[172:175], v[84:87]
    ds_read_b64_tr_b16 v[70:71], v15 offset:30720
    s_waitcnt lgkmcnt(5)
    v_mfma_f32_16x16x32_bf16 v[88:91], v[236:239], v[160:163], v[88:91]
    ds_read_b64_tr_b16 v[72:73], v18 offset:24576
    s_add_u32 m0, s50, 122880
    s_add_u32 s51, s58, 73728
    buffer_load_dwordx4 v5, s[28:31], s51 offen lds
    v_mfma_f32_16x16x32_bf16 v[88:91], v[240:243], v[168:171], v[88:91]
    ds_read_b64_tr_b16 v[74:75], v18 offset:26624
    v_mfma_f32_16x16x32_bf16 v[92:95], v[236:239], v[164:167], v[92:95]
    ds_read_b64_tr_b16 v[76:77], v18 offset:28672
    buffer_load_dwordx4 v46, s[28:31], s51 offen offset:1024 lds
    v_mfma_f32_16x16x32_bf16 v[92:95], v[240:243], v[172:175], v[92:95]
    ds_read_b64_tr_b16 v[78:79], v18 offset:30720
    s_waitcnt lgkmcnt(4)
    v_mfma_f32_16x16x32_bf16 v[96:99], v[244:247], v[184:187], v[96:99]
    s_barrier
    ds_read_b64_tr_b16 v[64:65], v14 offset:16384
    v_mfma_f32_16x16x32_bf16 v[96:99], v[68:71], v[192:195], v[96:99]
    ds_read_b64_tr_b16 v[66:67], v14 offset:18432
    ds_read_b128 v[208:211], v28 offset:0
    v_mfma_f32_16x16x32_bf16 v[100:103], v[244:247], v[188:191], v[100:103]
    ds_read_b64_tr_b16 v[232:233], v14 offset:20480
    v_mfma_f32_16x16x32_bf16 v[100:103], v[68:71], v[196:199], v[100:103]
    ds_read_b64_tr_b16 v[234:235], v14 offset:22528
    ds_read_b128 v[212:215], v28 offset:1024
    s_waitcnt lgkmcnt(6)
    v_mfma_f32_16x16x32_bf16 v[104:107], v[72:75], v[184:187], v[104:107]
    ds_read_b64_tr_b16 v[236:237], v17 offset:16384
    v_mfma_f32_16x16x32_bf16 v[104:107], v[76:79], v[192:195], v[104:107]
    ds_read_b64_tr_b16 v[238:239], v17 offset:18432
    ds_read_b128 v[200:203], v28 offset:40960
    v_mfma_f32_16x16x32_bf16 v[108:111], v[72:75], v[188:191], v[108:111]
    ds_read_b64_tr_b16 v[240:241], v17 offset:20480
    v_mfma_f32_16x16x32_bf16 v[108:111], v[76:79], v[196:199], v[108:111]
    ds_read_b64_tr_b16 v[242:243], v17 offset:22528
    ds_read_b128 v[204:207], v28 offset:41984
    s_waitcnt lgkmcnt(7)
    v_mfma_f32_16x16x32_bf16 v[80:83], v[64:67], v[184:187], v[80:83]
    s_barrier
    ds_read_b64_tr_b16 v[244:245], v15 offset:32768
    s_add_u32 m0, s50, 32768
    s_add_u32 s51, s16, 221184
    buffer_load_dwordx4 v5, s[28:31], s51 offen lds
    v_mfma_f32_16x16x32_bf16 v[80:83], v[232:235], v[192:195], v[80:83]
    ds_read_b64_tr_b16 v[246:247], v15 offset:34816
    v_mfma_f32_16x16x32_bf16 v[84:87], v[64:67], v[188:191], v[84:87]
    ds_read_b64_tr_b16 v[68:69], v15 offset:36864
    buffer_load_dwordx4 v46, s[28:31], s51 offen offset:1024 lds
    v_mfma_f32_16x16x32_bf16 v[84:87], v[232:235], v[196:199], v[84:87]
    ds_read_b64_tr_b16 v[70:71], v15 offset:38912
    s_waitcnt lgkmcnt(5)
    v_mfma_f32_16x16x32_bf16 v[88:91], v[236:239], v[184:187], v[88:91]
    ds_read_b64_tr_b16 v[72:73], v18 offset:32768
    s_add_u32 m0, s50, 57344
    s_add_u32 s51, s17, 221184
    buffer_load_dwordx4 v5, s[28:31], s51 offen lds
    v_mfma_f32_16x16x32_bf16 v[88:91], v[240:243], v[192:195], v[88:91]
    ds_read_b64_tr_b16 v[74:75], v18 offset:34816
    v_mfma_f32_16x16x32_bf16 v[92:95], v[236:239], v[188:191], v[92:95]
    ds_read_b64_tr_b16 v[76:77], v18 offset:36864
    buffer_load_dwordx4 v46, s[28:31], s51 offen offset:1024 lds
    v_mfma_f32_16x16x32_bf16 v[92:95], v[240:243], v[196:199], v[92:95]
    ds_read_b64_tr_b16 v[78:79], v18 offset:38912
    s_waitcnt lgkmcnt(4)
    v_mfma_f32_16x16x32_bf16 v[96:99], v[244:247], v[200:203], v[96:99]
    s_waitcnt vmcnt(14)
    s_barrier
    ds_read_b64_tr_b16 v[64:65], v15 offset:0
    v_mfma_f32_16x16x32_bf16 v[96:99], v[68:71], v[208:211], v[96:99]
    ds_read_b64_tr_b16 v[66:67], v15 offset:2048
    v_mfma_f32_16x16x32_bf16 v[100:103], v[244:247], v[204:207], v[100:103]
    ds_read_b64_tr_b16 v[232:233], v15 offset:4096
    v_mfma_f32_16x16x32_bf16 v[100:103], v[68:71], v[212:215], v[100:103]
    ds_read_b64_tr_b16 v[234:235], v15 offset:6144
    s_waitcnt lgkmcnt(4)
    v_mfma_f32_16x16x32_bf16 v[104:107], v[72:75], v[200:203], v[104:107]
    ds_read_b64_tr_b16 v[236:237], v18 offset:0
    v_mfma_f32_16x16x32_bf16 v[104:107], v[76:79], v[208:211], v[104:107]
    ds_read_b64_tr_b16 v[238:239], v18 offset:2048
    v_mfma_f32_16x16x32_bf16 v[108:111], v[72:75], v[204:207], v[108:111]
    ds_read_b64_tr_b16 v[240:241], v18 offset:4096
    v_mfma_f32_16x16x32_bf16 v[108:111], v[76:79], v[212:215], v[108:111]
    ds_read_b64_tr_b16 v[242:243], v18 offset:6144
    s_waitcnt lgkmcnt(4)
    v_mfma_f32_16x16x32_bf16 v[80:83], v[64:67], v[200:203], v[80:83]
    s_waitcnt vmcnt(12)
    s_barrier
    ds_read_b64_tr_b16 v[68:69], v9 offset:40960
    v_add_u32 v46, 17408, v47
    s_add_u32 m0, s50, 16384
    s_add_u32 s51, s86, 147456
    buffer_load_dwordx4 v47, s[28:31], s51 offen lds
    v_mfma_f32_16x16x32_bf16 v[80:83], v[232:235], v[208:211], v[80:83]
    ds_read_b64_tr_b16 v[70:71], v9 offset:41984
    ds_read_b128 v[224:227], v29 offset:8192
    v_mfma_f32_16x16x32_bf16 v[84:87], v[64:67], v[204:207], v[84:87]
    ds_read_b64_tr_b16 v[72:73], v9 offset:43008
    buffer_load_dwordx4 v46, s[28:31], s51 offen offset:1024 lds
    v_mfma_f32_16x16x32_bf16 v[84:87], v[232:235], v[212:215], v[84:87]
    ds_read_b64_tr_b16 v[74:75], v9 offset:44032
    ds_read_b128 v[228:231], v29 offset:9216
    s_waitcnt lgkmcnt(6)
    v_mfma_f32_16x16x32_bf16 v[88:91], v[236:239], v[200:203], v[88:91]
    ds_read_b64_tr_b16 v[76:77], v9 offset:45056
    v_add_u32 v46, 8192, v5
    s_add_u32 m0, s50, 40960
    s_nop 0
    buffer_load_dwordx4 v5, s[28:31], s64 offen lds
    v_mfma_f32_16x16x32_bf16 v[88:91], v[240:243], v[208:211], v[88:91]
    ds_read_b64_tr_b16 v[78:79], v9 offset:46080
    ds_read_b128 v[216:219], v28 offset:8192
    v_mfma_f32_16x16x32_bf16 v[92:95], v[236:239], v[204:207], v[92:95]
    ds_read_b64_tr_b16 v[64:65], v9 offset:47104
    buffer_load_dwordx4 v46, s[28:31], s64 offen offset:1024 lds
    v_mfma_f32_16x16x32_bf16 v[92:95], v[240:243], v[212:215], v[92:95]
    ds_read_b64_tr_b16 v[66:67], v9 offset:48128
    ds_read_b128 v[220:223], v28 offset:9216
    s_waitcnt lgkmcnt(7)
    v_mfma_f32_16x16x32_bf16 v[32:35], v[68:71], v[184:187], v[32:35]
    s_waitcnt vmcnt(14)
    s_barrier
    v_mfma_f32_16x16x32_bf16 v[32:35], v[72:75], v[192:195], v[32:35]
    v_mfma_f32_16x16x32_bf16 v[36:39], v[68:71], v[188:191], v[36:39]
    ds_read_b64_tr_b16 v[68:69], v14 offset:49152
    ds_read_b64_tr_b16 v[70:71], v14 offset:51200
    v_mfma_f32_16x16x32_bf16 v[36:39], v[72:75], v[196:199], v[36:39]
    ds_read_b64_tr_b16 v[72:73], v14 offset:53248
    ds_read_b64_tr_b16 v[74:75], v14 offset:55296
    s_waitcnt lgkmcnt(5)
    v_mfma_f32_16x16x32_bf16 v[32:35], v[76:79], v[200:203], v[32:35]
    v_mfma_f32_16x16x32_bf16 v[32:35], v[64:67], v[208:211], v[32:35]
    v_mfma_f32_16x16x32_bf16 v[36:39], v[76:79], v[204:207], v[36:39]
    ds_read_b64_tr_b16 v[76:77], v17 offset:49152
    ds_read_b64_tr_b16 v[78:79], v17 offset:51200
    v_mfma_f32_16x16x32_bf16 v[36:39], v[64:67], v[212:215], v[36:39]
    ds_read_b64_tr_b16 v[64:65], v17 offset:53248
    ds_read_b64_tr_b16 v[66:67], v17 offset:55296
    s_waitcnt lgkmcnt(4)
    v_mfma_f32_16x16x32_bf16 v[96:99], v[68:71], v[216:219], v[96:99]
    s_waitcnt vmcnt(12)
    s_barrier
    s_add_u32 m0, s50, 65536
    s_nop 0
    buffer_load_dwordx4 v5, s[28:31], s65 offen lds
    v_mfma_f32_16x16x32_bf16 v[96:99], v[72:75], v[224:227], v[96:99]
    v_mfma_f32_16x16x32_bf16 v[100:103], v[68:71], v[220:223], v[100:103]
    ds_read_b64_tr_b16 v[68:69], v15 offset:49152
    ds_read_b64_tr_b16 v[70:71], v15 offset:51200
    buffer_load_dwordx4 v46, s[28:31], s65 offen offset:1024 lds
    v_mfma_f32_16x16x32_bf16 v[100:103], v[72:75], v[228:231], v[100:103]
    ds_read_b64_tr_b16 v[72:73], v15 offset:53248
    ds_read_b64_tr_b16 v[74:75], v15 offset:55296
    s_waitcnt lgkmcnt(4)
    v_mfma_f32_16x16x32_bf16 v[104:107], v[76:79], v[216:219], v[104:107]
    v_add_u32 v46, 17408, v47
    s_add_u32 m0, s50, 73728
    s_nop 0
    buffer_load_dwordx4 v47, s[28:31], s70 offen lds
    v_mfma_f32_16x16x32_bf16 v[104:107], v[64:67], v[224:227], v[104:107]
    v_mfma_f32_16x16x32_bf16 v[108:111], v[76:79], v[220:223], v[108:111]
    ds_read_b64_tr_b16 v[76:77], v18 offset:49152
    ds_read_b64_tr_b16 v[78:79], v18 offset:51200
    buffer_load_dwordx4 v46, s[28:31], s70 offen offset:1024 lds
    v_mfma_f32_16x16x32_bf16 v[108:111], v[64:67], v[228:231], v[108:111]
    ds_read_b64_tr_b16 v[64:65], v18 offset:53248
    ds_read_b64_tr_b16 v[66:67], v18 offset:55296
    s_waitcnt lgkmcnt(4)
    v_mfma_f32_16x16x32_bf16 v[80:83], v[68:71], v[216:219], v[80:83]
    s_waitcnt vmcnt(14)
    s_barrier
    v_add_u32 v46, 8192, v5
    s_add_u32 m0, s50, 49152
    s_add_u32 s51, s14, 147456
    buffer_load_dwordx4 v5, s[28:31], s51 offen lds
    v_mfma_f32_16x16x32_bf16 v[80:83], v[72:75], v[224:227], v[80:83]
    v_mfma_f32_16x16x32_bf16 v[84:87], v[68:71], v[220:223], v[84:87]
    ds_read_b64_tr_b16 v[68:69], v15 offset:16384
    ds_read_b64_tr_b16 v[70:71], v15 offset:18432
    buffer_load_dwordx4 v46, s[28:31], s51 offen offset:1024 lds
    v_mfma_f32_16x16x32_bf16 v[84:87], v[72:75], v[228:231], v[84:87]
    ds_read_b64_tr_b16 v[72:73], v15 offset:20480
    ds_read_b64_tr_b16 v[74:75], v15 offset:22528
    s_waitcnt lgkmcnt(4)
    v_mfma_f32_16x16x32_bf16 v[88:91], v[76:79], v[216:219], v[88:91]
    s_add_u32 m0, s50, 90112
    s_add_u32 s51, s14, 221184
    buffer_load_dwordx4 v5, s[28:31], s51 offen lds
    v_mfma_f32_16x16x32_bf16 v[88:91], v[64:67], v[224:227], v[88:91]
    v_mfma_f32_16x16x32_bf16 v[92:95], v[76:79], v[220:223], v[92:95]
    ds_read_b64_tr_b16 v[76:77], v18 offset:16384
    ds_read_b64_tr_b16 v[78:79], v18 offset:18432
    buffer_load_dwordx4 v46, s[28:31], s51 offen offset:1024 lds
    v_mfma_f32_16x16x32_bf16 v[92:95], v[64:67], v[228:231], v[92:95]
    ds_read_b64_tr_b16 v[64:65], v18 offset:20480
    ds_read_b64_tr_b16 v[66:67], v18 offset:22528
    s_waitcnt lgkmcnt(4)
    v_mfma_f32_16x16x32_bf16 v[48:51], v[68:71], v[112:115], 0
    s_waitcnt vmcnt(16)
    s_barrier
    s_add_u32 m0, s50, 98304
    s_nop 0
    buffer_load_dwordx4 v5, s[28:31], s62 offen lds
    v_mfma_f32_16x16x32_bf16 v[48:51], v[72:75], v[120:123], v[48:51]
    ds_read_b128 v[240:243], v28 offset:0
    v_mfma_f32_16x16x32_bf16 v[52:55], v[68:71], v[116:119], 0
    ds_read_b64_tr_b16 v[68:69], v15 offset:57344
    ds_read_b64_tr_b16 v[70:71], v15 offset:59392
    buffer_load_dwordx4 v46, s[28:31], s62 offen offset:1024 lds
    v_mfma_f32_16x16x32_bf16 v[52:55], v[72:75], v[124:127], v[52:55]
    ds_read_b64_tr_b16 v[72:73], v15 offset:61440
    ds_read_b64_tr_b16 v[74:75], v15 offset:63488
    ds_read_b128 v[244:247], v28 offset:1024
    s_waitcnt lgkmcnt(6)
    v_mfma_f32_16x16x32_bf16 v[20:23], v[76:79], v[112:115], 0
    s_add_u32 m0, s50, 106496
    s_add_u32 s51, s62, 73728
    buffer_load_dwordx4 v5, s[28:31], s51 offen lds
    v_mfma_f32_16x16x32_bf16 v[20:23], v[64:67], v[120:123], v[20:23]
    ds_read_b128 v[232:235], v28 offset:24576
    v_mfma_f32_16x16x32_bf16 v[24:27], v[76:79], v[116:119], 0
    ds_read_b64_tr_b16 v[76:77], v18 offset:57344
    ds_read_b64_tr_b16 v[78:79], v18 offset:59392
    buffer_load_dwordx4 v46, s[28:31], s51 offen offset:1024 lds
    v_mfma_f32_16x16x32_bf16 v[24:27], v[64:67], v[124:127], v[24:27]
    ds_read_b64_tr_b16 v[64:65], v18 offset:61440
    ds_read_b64_tr_b16 v[66:67], v18 offset:63488
    ds_read_b128 v[236:239], v28 offset:25600
    s_waitcnt lgkmcnt(7)
    v_mfma_f32_16x16x32_bf16 v[48:51], v[68:71], v[128:131], v[48:51]
    s_waitcnt vmcnt(18)
    s_barrier
    s_add_u32 m0, s50, 81920
    s_add_u32 s51, s18, 147456
    buffer_load_dwordx4 v5, s[28:31], s51 offen lds
    v_mfma_f32_16x16x32_bf16 v[48:51], v[72:75], v[136:139], v[48:51]
    v_mfma_f32_16x16x32_bf16 v[52:55], v[68:71], v[132:135], v[52:55]
    ds_read_b64_tr_b16 v[68:69], v14 offset:32768
    ds_read_b64_tr_b16 v[70:71], v14 offset:34816
    buffer_load_dwordx4 v46, s[28:31], s51 offen offset:1024 lds
    v_mfma_f32_16x16x32_bf16 v[52:55], v[72:75], v[140:143], v[52:55]
    ds_read_b64_tr_b16 v[72:73], v14 offset:36864
    ds_read_b64_tr_b16 v[74:75], v14 offset:38912
    s_waitcnt lgkmcnt(5)
    v_mfma_f32_16x16x32_bf16 v[20:23], v[76:79], v[128:131], v[20:23]
    s_add_u32 m0, s50, 114688
    s_add_u32 s51, s18, 221184
    buffer_load_dwordx4 v5, s[28:31], s51 offen lds
    v_mfma_f32_16x16x32_bf16 v[20:23], v[64:67], v[136:139], v[20:23]
    v_mfma_f32_16x16x32_bf16 v[24:27], v[76:79], v[132:135], v[24:27]
    ds_read_b64_tr_b16 v[76:77], v17 offset:32768
    ds_read_b64_tr_b16 v[78:79], v17 offset:34816
    buffer_load_dwordx4 v46, s[28:31], s51 offen offset:1024 lds
    v_mfma_f32_16x16x32_bf16 v[24:27], v[64:67], v[140:143], v[24:27]
    ds_read_b64_tr_b16 v[64:65], v17 offset:36864
    ds_read_b64_tr_b16 v[66:67], v17 offset:38912
    s_waitcnt lgkmcnt(4)
    v_mfma_f32_16x16x32_bf16 v[96:99], v[68:71], v[232:235], v[96:99]
    s_waitcnt vmcnt(20)
    s_barrier
    v_mfma_f32_16x16x32_bf16 v[96:99], v[72:75], v[240:243], v[96:99]
    s_add_u32 m0, s50, 0
    s_nop 0
    buffer_load_dwordx4 v5, s[28:31], s66 offen lds
    v_mfma_f32_16x16x32_bf16 v[100:103], v[68:71], v[236:239], v[100:103]
    ds_read_b64_tr_b16 v[68:69], v14 offset:57344
    ds_read_b64_tr_b16 v[70:71], v14 offset:59392
    v_mfma_f32_16x16x32_bf16 v[100:103], v[72:75], v[244:247], v[100:103]
    ds_read_b64_tr_b16 v[72:73], v14 offset:61440
    ds_read_b64_tr_b16 v[74:75], v14 offset:63488
    s_waitcnt lgkmcnt(4)
    v_mfma_f32_16x16x32_bf16 v[104:107], v[76:79], v[232:235], v[104:107]
    v_mfma_f32_16x16x32_bf16 v[104:107], v[64:67], v[240:243], v[104:107]
    buffer_load_dwordx4 v46, s[28:31], s66 offen offset:1024 lds
    v_mfma_f32_16x16x32_bf16 v[108:111], v[76:79], v[236:239], v[108:111]
    ds_read_b64_tr_b16 v[76:77], v17 offset:57344
    ds_read_b64_tr_b16 v[78:79], v17 offset:59392
    v_mfma_f32_16x16x32_bf16 v[108:111], v[64:67], v[244:247], v[108:111]
    ds_read_b64_tr_b16 v[64:65], v17 offset:61440
    ds_read_b64_tr_b16 v[66:67], v17 offset:63488
    s_waitcnt lgkmcnt(4)
    v_mfma_f32_16x16x32_bf16 v[80:83], v[68:71], v[232:235], v[80:83]
    s_waitcnt vmcnt(20)
    s_barrier
    s_add_u32 m0, s50, 24576
    s_nop 0
    buffer_load_dwordx4 v5, s[28:31], s59 offen lds
    v_mfma_f32_16x16x32_bf16 v[80:83], v[72:75], v[240:243], v[80:83]
    v_mfma_f32_16x16x32_bf16 v[84:87], v[68:71], v[236:239], v[84:87]
    ds_read_b64_tr_b16 v[68:69], v8 offset:16384
    ds_read_b64_tr_b16 v[70:71], v8 offset:17408
    buffer_load_dwordx4 v46, s[28:31], s59 offen offset:1024 lds
    v_mfma_f32_16x16x32_bf16 v[84:87], v[72:75], v[244:247], v[84:87]
    ds_read_b64_tr_b16 v[72:73], v8 offset:18432
    ds_read_b64_tr_b16 v[74:75], v8 offset:19456
    s_waitcnt lgkmcnt(4)
    v_mfma_f32_16x16x32_bf16 v[88:91], v[76:79], v[232:235], v[88:91]
    s_add_u32 m0, s50, 32768
    s_add_u32 s51, s59, 73728
    buffer_load_dwordx4 v5, s[28:31], s51 offen lds
    v_mfma_f32_16x16x32_bf16 v[88:91], v[64:67], v[240:243], v[88:91]
    ds_read_b128 v[248:251], v28 offset:8192
    v_mfma_f32_16x16x32_bf16 v[92:95], v[76:79], v[236:239], v[92:95]
    ds_read_b64_tr_b16 v[76:77], v8 offset:20480
    ds_read_b64_tr_b16 v[78:79], v8 offset:21504
    buffer_load_dwordx4 v46, s[28:31], s51 offen offset:1024 lds
    v_mfma_f32_16x16x32_bf16 v[92:95], v[64:67], v[244:247], v[92:95]
    ds_read_b64_tr_b16 v[64:65], v8 offset:22528
    ds_read_b64_tr_b16 v[66:67], v8 offset:23552
    ds_read_b128 v[252:255], v28 offset:9216
    s_waitcnt lgkmcnt(6)
    v_mfma_f32_16x16x32_bf16 v[32:35], v[68:71], v[216:219], v[32:35]
    s_waitcnt vmcnt(22)
    s_barrier
    s_add_u32 m0, s50, 57344
    s_add_u32 s51, s15, 147456
    buffer_load_dwordx4 v5, s[28:31], s51 offen lds
    v_mfma_f32_16x16x32_bf16 v[32:35], v[72:75], v[224:227], v[32:35]
    v_mfma_f32_16x16x32_bf16 v[36:39], v[68:71], v[220:223], v[36:39]
    ds_read_b64_tr_b16 v[68:69], v14 offset:40960
    ds_read_b64_tr_b16 v[70:71], v14 offset:43008
    buffer_load_dwordx4 v46, s[28:31], s51 offen offset:1024 lds
    v_mfma_f32_16x16x32_bf16 v[36:39], v[72:75], v[228:231], v[36:39]
    ds_read_b64_tr_b16 v[72:73], v14 offset:45056
    ds_read_b64_tr_b16 v[74:75], v14 offset:47104
    s_waitcnt lgkmcnt(5)
    v_mfma_f32_16x16x32_bf16 v[32:35], v[76:79], v[232:235], v[32:35]
    s_add_u32 m0, s50, 122880
    s_add_u32 s51, s15, 221184
    buffer_load_dwordx4 v5, s[28:31], s51 offen lds
    v_mfma_f32_16x16x32_bf16 v[32:35], v[64:67], v[240:243], v[32:35]
    v_mfma_f32_16x16x32_bf16 v[36:39], v[76:79], v[236:239], v[36:39]
    ds_read_b64_tr_b16 v[76:77], v17 offset:40960
    ds_read_b64_tr_b16 v[78:79], v17 offset:43008
    buffer_load_dwordx4 v46, s[28:31], s51 offen offset:1024 lds
    v_mfma_f32_16x16x32_bf16 v[36:39], v[64:67], v[244:247], v[36:39]
    ds_read_b64_tr_b16 v[64:65], v17 offset:45056
    ds_read_b64_tr_b16 v[66:67], v17 offset:47104
    s_waitcnt lgkmcnt(4)
    v_mfma_f32_16x16x32_bf16 v[96:99], v[68:71], v[176:179], v[96:99]
    s_waitcnt vmcnt(24)
    s_barrier
    s_add_u32 m0, s50, 8192
    s_nop 0
    buffer_load_dwordx4 v5, s[28:31], s63 offen lds
    v_mfma_f32_16x16x32_bf16 v[96:99], v[72:75], v[248:251], v[96:99]
    v_mfma_f32_16x16x32_bf16 v[100:103], v[68:71], v[180:183], v[100:103]
    ds_read_b64_tr_b16 v[68:69], v15 offset:0
    ds_read_b64_tr_b16 v[70:71], v15 offset:2048
    buffer_load_dwordx4 v46, s[28:31], s63 offen offset:1024 lds
    v_mfma_f32_16x16x32_bf16 v[100:103], v[72:75], v[252:255], v[100:103]
    ds_read_b64_tr_b16 v[72:73], v15 offset:4096
    ds_read_b64_tr_b16 v[74:75], v15 offset:6144
    s_waitcnt lgkmcnt(4)
    v_mfma_f32_16x16x32_bf16 v[104:107], v[76:79], v[176:179], v[104:107]
    s_add_u32 m0, s50, 16384
    s_add_u32 s51, s63, 73728
    buffer_load_dwordx4 v5, s[28:31], s51 offen lds
    v_mfma_f32_16x16x32_bf16 v[104:107], v[64:67], v[248:251], v[104:107]
    v_mfma_f32_16x16x32_bf16 v[108:111], v[76:79], v[180:183], v[108:111]
    ds_read_b64_tr_b16 v[76:77], v18 offset:0
    ds_read_b64_tr_b16 v[78:79], v18 offset:2048
    buffer_load_dwordx4 v46, s[28:31], s51 offen offset:1024 lds
    v_mfma_f32_16x16x32_bf16 v[108:111], v[64:67], v[252:255], v[108:111]
    ds_read_b64_tr_b16 v[64:65], v18 offset:4096
    ds_read_b64_tr_b16 v[66:67], v18 offset:6144
    s_waitcnt lgkmcnt(4)
    v_mfma_f32_16x16x32_bf16 v[80:83], v[68:71], v[176:179], v[80:83]
    s_waitcnt vmcnt(26)
    s_barrier
    s_add_u32 m0, s50, 40960
    s_add_u32 s51, s19, 147456
    buffer_load_dwordx4 v5, s[28:31], s51 offen lds
    v_mfma_f32_16x16x32_bf16 v[80:83], v[72:75], v[248:251], v[80:83]
    v_cvt_pk_bf16_f32 v56, v96, v97
    v_mfma_f32_16x16x32_bf16 v[84:87], v[68:71], v[180:183], v[84:87]
    ds_read_b64_tr_b16 v[68:69], v9 offset:8192
    ds_read_b64_tr_b16 v[70:71], v9 offset:9216
    buffer_load_dwordx4 v46, s[28:31], s51 offen offset:1024 lds
    v_cvt_pk_bf16_f32 v57, v98, v99
    v_mfma_f32_16x16x32_bf16 v[84:87], v[72:75], v[252:255], v[84:87]
    ds_read_b64_tr_b16 v[72:73], v9 offset:10240
    ds_read_b64_tr_b16 v[74:75], v9 offset:11264
    v_cvt_pk_bf16_f32 v58, v100, v101
    s_waitcnt lgkmcnt(4)
    v_mfma_f32_16x16x32_bf16 v[88:91], v[76:79], v[176:179], v[88:91]
    s_add_u32 m0, s50, 131072
    s_add_u32 s51, s19, 221184
    buffer_load_dwordx4 v5, s[28:31], s51 offen lds
    v_cvt_pk_bf16_f32 v59, v102, v103
    v_mfma_f32_16x16x32_bf16 v[88:91], v[64:67], v[248:251], v[88:91]
    s_add_u32 s52, s72, s80
    buffer_store_dwordx4 v[56:59], v2, s[32:35], s52 offen sc1
    v_mfma_f32_16x16x32_bf16 v[92:95], v[76:79], v[180:183], v[92:95]
    buffer_load_dwordx4 v46, s[28:31], s51 offen offset:1024 lds
    v_mfma_f32_16x16x32_bf16 v[92:95], v[64:67], v[252:255], v[92:95]
    s_waitcnt lgkmcnt(0)
    v_mfma_f32_16x16x32_bf16 v[32:35], v[68:71], v[176:179], v[32:35]
    s_waitcnt vmcnt(29)
    s_barrier
    ds_read_b64_tr_b16 v[76:77], v14 offset:49152
    ds_read_b64_tr_b16 v[78:79], v14 offset:51200
    s_add_u32 m0, s50, 65536
    s_nop 0
    buffer_load_dwordx4 v5, s[28:31], s67 offen lds
    v_mfma_f32_16x16x32_bf16 v[32:35], v[72:75], v[248:251], v[32:35]
    ds_read_b64_tr_b16 v[64:65], v14 offset:53248
    ds_read_b64_tr_b16 v[66:67], v14 offset:55296
    v_cvt_pk_bf16_f32 v60, v104, v105
    v_cvt_pk_bf16_f32 v61, v106, v107
    v_mfma_f32_16x16x32_bf16 v[36:39], v[68:71], v[180:183], v[36:39]
    ds_read_b64_tr_b16 v[68:69], v17 offset:49152
    ds_read_b64_tr_b16 v[70:71], v17 offset:51200
    buffer_load_dwordx4 v46, s[28:31], s67 offen offset:1024 lds
    v_cvt_pk_bf16_f32 v62, v108, v109
    v_mfma_f32_16x16x32_bf16 v[36:39], v[72:75], v[252:255], v[36:39]
    ds_read_b64_tr_b16 v[72:73], v17 offset:53248
    ds_read_b64_tr_b16 v[74:75], v17 offset:55296
    v_cvt_pk_bf16_f32 v63, v110, v111
    s_add_u32 s52, s72, s81
    buffer_store_dwordx4 v[60:63], v2, s[32:35], s52 offen sc1
    s_waitcnt lgkmcnt(4)
    v_mfma_f32_16x16x32_bf16 v[48:51], v[76:79], v[144:147], v[48:51]
    s_waitcnt vmcnt(30)
    s_barrier
    ds_read_b64_tr_b16 v[96:97], v15 offset:24576
    v_mfma_f32_16x16x32_bf16 v[48:51], v[64:67], v[152:155], v[48:51]
    ds_read_b64_tr_b16 v[98:99], v15 offset:26624
    v_cvt_pk_bf16_f32 v56, v80, v81
    v_mfma_f32_16x16x32_bf16 v[52:55], v[76:79], v[148:151], v[52:55]
    ds_read_b64_tr_b16 v[100:101], v15 offset:28672
    v_cvt_pk_bf16_f32 v57, v82, v83
    v_mfma_f32_16x16x32_bf16 v[52:55], v[64:67], v[156:159], v[52:55]
    ds_read_b64_tr_b16 v[102:103], v15 offset:30720
    v_cvt_pk_bf16_f32 v58, v84, v85
    s_waitcnt lgkmcnt(4)
    v_mfma_f32_16x16x32_bf16 v[20:23], v[68:71], v[144:147], v[20:23]
    ds_read_b64_tr_b16 v[76:77], v18 offset:24576
    v_cvt_pk_bf16_f32 v59, v86, v87
    v_mfma_f32_16x16x32_bf16 v[20:23], v[72:75], v[152:155], v[20:23]
    ds_read_b64_tr_b16 v[78:79], v18 offset:26624
    s_add_u32 s52, s73, s80
    buffer_store_dwordx4 v[56:59], v2, s[32:35], s52 offen sc1
    v_mfma_f32_16x16x32_bf16 v[24:27], v[68:71], v[148:151], v[24:27]
    ds_read_b64_tr_b16 v[64:65], v18 offset:28672
    v_mfma_f32_16x16x32_bf16 v[24:27], v[72:75], v[156:159], v[24:27]
    ds_read_b64_tr_b16 v[66:67], v18 offset:30720
    s_waitcnt lgkmcnt(4)
    v_mfma_f32_16x16x32_bf16 v[48:51], v[96:99], v[160:163], v[48:51]
    s_waitcnt vmcnt(29)
    s_barrier
    ds_read_b64_tr_b16 v[68:69], v15 offset:32768
    v_mfma_f32_16x16x32_bf16 v[48:51], v[100:103], v[168:171], v[48:51]
    ds_read_b64_tr_b16 v[70:71], v15 offset:34816
    v_cvt_pk_bf16_f32 v60, v88, v89
    v_mfma_f32_16x16x32_bf16 v[52:55], v[96:99], v[164:167], v[52:55]
    ds_read_b64_tr_b16 v[72:73], v15 offset:36864
    v_cvt_pk_bf16_f32 v61, v90, v91
    v_mfma_f32_16x16x32_bf16 v[52:55], v[100:103], v[172:175], v[52:55]
    ds_read_b64_tr_b16 v[74:75], v15 offset:38912
    v_cvt_pk_bf16_f32 v62, v92, v93
    s_waitcnt lgkmcnt(4)
    v_mfma_f32_16x16x32_bf16 v[20:23], v[76:79], v[160:163], v[20:23]
    ds_read_b64_tr_b16 v[96:97], v18 offset:32768
    v_cvt_pk_bf16_f32 v63, v94, v95
    v_mfma_f32_16x16x32_bf16 v[20:23], v[64:67], v[168:171], v[20:23]
    ds_read_b64_tr_b16 v[98:99], v18 offset:34816
    s_add_u32 s52, s73, s81
    buffer_store_dwordx4 v[60:63], v2, s[32:35], s52 offen sc1
    v_mfma_f32_16x16x32_bf16 v[24:27], v[76:79], v[164:167], v[24:27]
    ds_read_b64_tr_b16 v[100:101], v18 offset:36864
    v_mfma_f32_16x16x32_bf16 v[24:27], v[64:67], v[172:175], v[24:27]
    ds_read_b64_tr_b16 v[102:103], v18 offset:38912
    s_waitcnt lgkmcnt(4)
    v_mfma_f32_16x16x32_bf16 v[48:51], v[68:71], v[184:187], v[48:51]
    s_waitcnt vmcnt(28)
    s_barrier
    ds_read_b64_tr_b16 v[76:77], v15 offset:40960
    v_mfma_f32_16x16x32_bf16 v[48:51], v[72:75], v[192:195], v[48:51]
    ds_read_b64_tr_b16 v[78:79], v15 offset:43008
    v_cvt_pk_bf16_f32 v56, v32, v33
    v_mfma_f32_16x16x32_bf16 v[52:55], v[68:71], v[188:191], v[52:55]
    ds_read_b64_tr_b16 v[64:65], v15 offset:45056
    v_cvt_pk_bf16_f32 v57, v34, v35
    v_mfma_f32_16x16x32_bf16 v[52:55], v[72:75], v[196:199], v[52:55]
    ds_read_b64_tr_b16 v[66:67], v15 offset:47104
    v_cvt_pk_bf16_f32 v58, v36, v37
    s_waitcnt lgkmcnt(4)
    v_mfma_f32_16x16x32_bf16 v[20:23], v[96:99], v[184:187], v[20:23]
    ds_read_b64_tr_b16 v[68:69], v18 offset:40960
    v_cvt_pk_bf16_f32 v59, v38, v39
    v_mfma_f32_16x16x32_bf16 v[20:23], v[100:103], v[192:195], v[20:23]
    ds_read_b64_tr_b16 v[70:71], v18 offset:43008
    s_mov_b32 s52, s71
    buffer_store_dwordx4 v[56:59], v2, s[32:35], s52 offen sc1
    v_mfma_f32_16x16x32_bf16 v[24:27], v[96:99], v[188:191], v[24:27]
    ds_read_b64_tr_b16 v[72:73], v18 offset:45056
    v_mfma_f32_16x16x32_bf16 v[24:27], v[100:103], v[196:199], v[24:27]
    ds_read_b64_tr_b16 v[74:75], v18 offset:47104
    s_waitcnt lgkmcnt(4)
    v_mfma_f32_16x16x32_bf16 v[48:51], v[76:79], v[200:203], v[48:51]
    s_waitcnt vmcnt(27)
    s_barrier
    ds_read_b64_tr_b16 v[96:97], v15 offset:16384
    v_mfma_f32_16x16x32_bf16 v[48:51], v[64:67], v[208:211], v[48:51]
    ds_read_b64_tr_b16 v[98:99], v15 offset:18432
    v_mfma_f32_16x16x32_bf16 v[52:55], v[76:79], v[204:207], v[52:55]
    ds_read_b64_tr_b16 v[100:101], v15 offset:20480
    v_mfma_f32_16x16x32_bf16 v[52:55], v[64:67], v[212:215], v[52:55]
    ds_read_b64_tr_b16 v[102:103], v15 offset:22528
    s_waitcnt lgkmcnt(4)
    v_mfma_f32_16x16x32_bf16 v[20:23], v[68:71], v[200:203], v[20:23]
    ds_read_b64_tr_b16 v[76:77], v18 offset:16384
    v_mfma_f32_16x16x32_bf16 v[20:23], v[72:75], v[208:211], v[20:23]
    ds_read_b64_tr_b16 v[78:79], v18 offset:18432
    v_mfma_f32_16x16x32_bf16 v[24:27], v[68:71], v[204:207], v[24:27]
    ds_read_b64_tr_b16 v[64:65], v18 offset:20480
    v_mfma_f32_16x16x32_bf16 v[24:27], v[72:75], v[212:215], v[24:27]
    ds_read_b64_tr_b16 v[66:67], v18 offset:22528
    s_waitcnt lgkmcnt(4)
    v_mfma_f32_16x16x32_bf16 v[48:51], v[96:99], v[216:219], v[48:51]
    s_waitcnt vmcnt(25)
    s_barrier
    ds_read_b64_tr_b16 v[68:69], v15 offset:49152
    v_mfma_f32_16x16x32_bf16 v[48:51], v[100:103], v[224:227], v[48:51]
    ds_read_b64_tr_b16 v[70:71], v15 offset:51200
    v_mfma_f32_16x16x32_bf16 v[52:55], v[96:99], v[220:223], v[52:55]
    ds_read_b64_tr_b16 v[72:73], v15 offset:53248
    v_mfma_f32_16x16x32_bf16 v[52:55], v[100:103], v[228:231], v[52:55]
    ds_read_b64_tr_b16 v[74:75], v15 offset:55296
    s_waitcnt lgkmcnt(4)
    v_mfma_f32_16x16x32_bf16 v[20:23], v[76:79], v[216:219], v[20:23]
    ds_read_b64_tr_b16 v[96:97], v18 offset:49152
    v_mfma_f32_16x16x32_bf16 v[20:23], v[64:67], v[224:227], v[20:23]
    ds_read_b64_tr_b16 v[98:99], v18 offset:51200
    v_mfma_f32_16x16x32_bf16 v[24:27], v[76:79], v[220:223], v[24:27]
    ds_read_b64_tr_b16 v[100:101], v18 offset:53248
    v_mfma_f32_16x16x32_bf16 v[24:27], v[64:67], v[228:231], v[24:27]
    ds_read_b64_tr_b16 v[102:103], v18 offset:55296
    s_waitcnt lgkmcnt(4)
    v_mfma_f32_16x16x32_bf16 v[48:51], v[68:71], v[232:235], v[48:51]
    s_waitcnt vmcnt(23)
    s_barrier
    ds_read_b64_tr_b16 v[76:77], v14 offset:0
    v_mfma_f32_16x16x32_bf16 v[48:51], v[72:75], v[240:243], v[48:51]
    ds_read_b64_tr_b16 v[78:79], v14 offset:2048
    v_mfma_f32_16x16x32_bf16 v[52:55], v[68:71], v[236:239], v[52:55]
    ds_read_b64_tr_b16 v[64:65], v14 offset:4096
    v_mfma_f32_16x16x32_bf16 v[52:55], v[72:75], v[244:247], v[52:55]
    ds_read_b64_tr_b16 v[66:67], v14 offset:6144
    s_waitcnt lgkmcnt(4)
    v_mfma_f32_16x16x32_bf16 v[20:23], v[96:99], v[232:235], v[20:23]
    ds_read_b64_tr_b16 v[68:69], v17 offset:0
    v_mfma_f32_16x16x32_bf16 v[20:23], v[100:103], v[240:243], v[20:23]
    ds_read_b64_tr_b16 v[70:71], v17 offset:2048
    v_mfma_f32_16x16x32_bf16 v[24:27], v[96:99], v[236:239], v[24:27]
    ds_read_b64_tr_b16 v[72:73], v17 offset:4096
    v_mfma_f32_16x16x32_bf16 v[24:27], v[100:103], v[244:247], v[24:27]
    ds_read_b64_tr_b16 v[74:75], v17 offset:6144
    s_waitcnt lgkmcnt(4)
    v_mfma_f32_16x16x32_bf16 v[48:51], v[76:79], v[176:179], v[48:51]
    s_waitcnt vmcnt(0)
    s_barrier
    ds_read_b64_tr_b16 v[96:97], v14 offset:24576
    v_mfma_f32_16x16x32_bf16 v[48:51], v[64:67], v[248:251], v[48:51]
    ds_read_b64_tr_b16 v[98:99], v14 offset:26624
    v_mfma_f32_16x16x32_bf16 v[52:55], v[76:79], v[180:183], v[52:55]
    ds_read_b64_tr_b16 v[100:101], v14 offset:28672
    v_mfma_f32_16x16x32_bf16 v[52:55], v[64:67], v[252:255], v[52:55]
    ds_read_b64_tr_b16 v[102:103], v14 offset:30720
    s_waitcnt lgkmcnt(4)
    v_mfma_f32_16x16x32_bf16 v[20:23], v[68:71], v[176:179], v[20:23]
    ds_read_b64_tr_b16 v[76:77], v14 offset:32768
    v_mfma_f32_16x16x32_bf16 v[20:23], v[72:75], v[248:251], v[20:23]
    ds_read_b64_tr_b16 v[78:79], v14 offset:34816
    v_mfma_f32_16x16x32_bf16 v[24:27], v[68:71], v[180:183], v[24:27]
    ds_read_b64_tr_b16 v[64:65], v14 offset:36864
    v_mfma_f32_16x16x32_bf16 v[24:27], v[72:75], v[252:255], v[24:27]
    ds_read_b64_tr_b16 v[66:67], v14 offset:38912
    s_waitcnt lgkmcnt(4)
    v_mfma_f32_16x16x32_bf16 v[80:83], v[96:99], v[112:115], 0
    ds_read_b64_tr_b16 v[68:69], v14 offset:57344
    v_mfma_f32_16x16x32_bf16 v[80:83], v[100:103], v[120:123], v[80:83]
    ds_read_b64_tr_b16 v[70:71], v14 offset:59392
    v_cvt_pk_bf16_f32 v56, v48, v49
    v_mfma_f32_16x16x32_bf16 v[84:87], v[96:99], v[116:119], 0
    ds_read_b64_tr_b16 v[72:73], v14 offset:61440
    v_cvt_pk_bf16_f32 v57, v50, v51
    v_mfma_f32_16x16x32_bf16 v[84:87], v[100:103], v[124:127], v[84:87]
    ds_read_b64_tr_b16 v[74:75], v14 offset:63488
    v_cvt_pk_bf16_f32 v58, v52, v53
    s_waitcnt lgkmcnt(4)
    v_mfma_f32_16x16x32_bf16 v[80:83], v[76:79], v[128:131], v[80:83]
    ds_read_b64_tr_b16 v[96:97], v15 offset:57344
    v_cvt_pk_bf16_f32 v59, v54, v55
    v_mfma_f32_16x16x32_bf16 v[80:83], v[64:67], v[136:139], v[80:83]
    ds_read_b64_tr_b16 v[98:99], v15 offset:59392
    s_add_u32 s52, s74, s80
    buffer_store_dwordx4 v[56:59], v2, s[32:35], s52 offen sc1
    v_mfma_f32_16x16x32_bf16 v[84:87], v[76:79], v[132:135], v[84:87]
    ds_read_b64_tr_b16 v[100:101], v15 offset:61440
    v_mfma_f32_16x16x32_bf16 v[84:87], v[64:67], v[140:143], v[84:87]
    ds_read_b64_tr_b16 v[102:103], v15 offset:63488
    s_waitcnt lgkmcnt(4)
    v_mfma_f32_16x16x32_bf16 v[80:83], v[68:71], v[144:147], v[80:83]
    ds_read_b64_tr_b16 v[76:77], v14 offset:8192
    v_mfma_f32_16x16x32_bf16 v[80:83], v[72:75], v[152:155], v[80:83]
    ds_read_b64_tr_b16 v[78:79], v14 offset:10240
    v_cvt_pk_bf16_f32 v60, v20, v21
    v_mfma_f32_16x16x32_bf16 v[84:87], v[68:71], v[148:151], v[84:87]
    ds_read_b64_tr_b16 v[64:65], v14 offset:12288
    v_cvt_pk_bf16_f32 v61, v22, v23
    v_mfma_f32_16x16x32_bf16 v[84:87], v[72:75], v[156:159], v[84:87]
    ds_read_b64_tr_b16 v[66:67], v14 offset:14336
    v_cvt_pk_bf16_f32 v62, v24, v25
    s_waitcnt lgkmcnt(4)
    v_mfma_f32_16x16x32_bf16 v[80:83], v[96:99], v[160:163], v[80:83]
    ds_read_b64_tr_b16 v[68:69], v14 offset:16384
    v_cvt_pk_bf16_f32 v63, v26, v27
    v_mfma_f32_16x16x32_bf16 v[80:83], v[100:103], v[168:171], v[80:83]
    ds_read_b64_tr_b16 v[70:71], v14 offset:18432
    s_add_u32 s52, s74, s81
    buffer_store_dwordx4 v[60:63], v2, s[32:35], s52 offen sc1
    v_mfma_f32_16x16x32_bf16 v[84:87], v[96:99], v[164:167], v[84:87]
    ds_read_b64_tr_b16 v[72:73], v14 offset:20480
    v_mfma_f32_16x16x32_bf16 v[84:87], v[100:103], v[172:175], v[84:87]
    ds_read_b64_tr_b16 v[74:75], v14 offset:22528
    s_waitcnt lgkmcnt(4)
    v_mfma_f32_16x16x32_bf16 v[80:83], v[76:79], v[184:187], v[80:83]
    ds_read_b64_tr_b16 v[96:97], v14 offset:40960
    v_mfma_f32_16x16x32_bf16 v[80:83], v[64:67], v[192:195], v[80:83]
    ds_read_b64_tr_b16 v[98:99], v14 offset:43008
    v_mfma_f32_16x16x32_bf16 v[84:87], v[76:79], v[188:191], v[84:87]
    ds_read_b64_tr_b16 v[100:101], v14 offset:45056
    v_mfma_f32_16x16x32_bf16 v[84:87], v[64:67], v[196:199], v[84:87]
    ds_read_b64_tr_b16 v[102:103], v14 offset:47104
    s_waitcnt lgkmcnt(4)
    v_mfma_f32_16x16x32_bf16 v[80:83], v[68:71], v[200:203], v[80:83]
    ds_read_b64_tr_b16 v[76:77], v16 offset:0
    v_mfma_f32_16x16x32_bf16 v[80:83], v[72:75], v[208:211], v[80:83]
    ds_read_b64_tr_b16 v[78:79], v16 offset:2048
    v_mfma_f32_16x16x32_bf16 v[84:87], v[68:71], v[204:207], v[84:87]
    ds_read_b64_tr_b16 v[64:65], v16 offset:4096
    v_mfma_f32_16x16x32_bf16 v[84:87], v[72:75], v[212:215], v[84:87]
    ds_read_b64_tr_b16 v[66:67], v16 offset:6144
    s_waitcnt lgkmcnt(4)
    v_mfma_f32_16x16x32_bf16 v[80:83], v[96:99], v[216:219], v[80:83]
    ds_read_b64_tr_b16 v[68:69], v15 offset:0
    v_mfma_f32_16x16x32_bf16 v[80:83], v[100:103], v[224:227], v[80:83]
    ds_read_b64_tr_b16 v[70:71], v15 offset:2048
    v_mfma_f32_16x16x32_bf16 v[84:87], v[96:99], v[220:223], v[84:87]
    ds_read_b64_tr_b16 v[72:73], v15 offset:4096
    v_mfma_f32_16x16x32_bf16 v[84:87], v[100:103], v[228:231], v[84:87]
    ds_read_b64_tr_b16 v[74:75], v15 offset:6144
    s_waitcnt lgkmcnt(4)
    v_mfma_f32_16x16x32_bf16 v[80:83], v[76:79], v[232:235], v[80:83]
    ds_read_b64_tr_b16 v[96:97], v17 offset:24576
    v_mfma_f32_16x16x32_bf16 v[80:83], v[64:67], v[240:243], v[80:83]
    ds_read_b64_tr_b16 v[98:99], v17 offset:26624
    v_mfma_f32_16x16x32_bf16 v[84:87], v[76:79], v[236:239], v[84:87]
    ds_read_b64_tr_b16 v[100:101], v17 offset:28672
    v_mfma_f32_16x16x32_bf16 v[84:87], v[64:67], v[244:247], v[84:87]
    ds_read_b64_tr_b16 v[102:103], v17 offset:30720
    s_waitcnt lgkmcnt(4)
    v_mfma_f32_16x16x32_bf16 v[80:83], v[68:71], v[176:179], v[80:83]
    ds_read_b64_tr_b16 v[76:77], v17 offset:32768
    v_mfma_f32_16x16x32_bf16 v[80:83], v[72:75], v[248:251], v[80:83]
    ds_read_b64_tr_b16 v[78:79], v17 offset:34816
    v_mfma_f32_16x16x32_bf16 v[84:87], v[68:71], v[180:183], v[84:87]
    ds_read_b64_tr_b16 v[64:65], v17 offset:36864
    v_mfma_f32_16x16x32_bf16 v[84:87], v[72:75], v[252:255], v[84:87]
    ds_read_b64_tr_b16 v[66:67], v17 offset:38912
    s_waitcnt lgkmcnt(4)
    v_mfma_f32_16x16x32_bf16 v[88:91], v[96:99], v[112:115], 0
    ds_read_b64_tr_b16 v[68:69], v17 offset:57344
    v_mfma_f32_16x16x32_bf16 v[88:91], v[100:103], v[120:123], v[88:91]
    ds_read_b64_tr_b16 v[70:71], v17 offset:59392
    v_cvt_pk_bf16_f32 v56, v80, v81
    v_cvt_pk_bf16_f32 v57, v82, v83
    v_mfma_f32_16x16x32_bf16 v[92:95], v[96:99], v[116:119], 0
    ds_read_b64_tr_b16 v[72:73], v17 offset:61440
    v_cvt_pk_bf16_f32 v58, v84, v85
    v_mfma_f32_16x16x32_bf16 v[92:95], v[100:103], v[124:127], v[92:95]
    ds_read_b64_tr_b16 v[74:75], v17 offset:63488
    v_cvt_pk_bf16_f32 v59, v86, v87
    s_add_u32 s52, s75, s80
    buffer_store_dwordx4 v[56:59], v2, s[32:35], s52 offen sc1
    s_waitcnt lgkmcnt(4)
    v_mfma_f32_16x16x32_bf16 v[88:91], v[76:79], v[128:131], v[88:91]
    ds_read_b64_tr_b16 v[96:97], v18 offset:57344
    v_mfma_f32_16x16x32_bf16 v[88:91], v[64:67], v[136:139], v[88:91]
    ds_read_b64_tr_b16 v[98:99], v18 offset:59392
    v_mfma_f32_16x16x32_bf16 v[92:95], v[76:79], v[132:135], v[92:95]
    ds_read_b64_tr_b16 v[100:101], v18 offset:61440
    v_mfma_f32_16x16x32_bf16 v[92:95], v[64:67], v[140:143], v[92:95]
    ds_read_b64_tr_b16 v[102:103], v18 offset:63488
    s_waitcnt lgkmcnt(4)
    v_mfma_f32_16x16x32_bf16 v[88:91], v[68:71], v[144:147], v[88:91]
    ds_read_b64_tr_b16 v[76:77], v17 offset:8192
    v_mfma_f32_16x16x32_bf16 v[88:91], v[72:75], v[152:155], v[88:91]
    ds_read_b64_tr_b16 v[78:79], v17 offset:10240
    v_mfma_f32_16x16x32_bf16 v[92:95], v[68:71], v[148:151], v[92:95]
    ds_read_b64_tr_b16 v[64:65], v17 offset:12288
    v_mfma_f32_16x16x32_bf16 v[92:95], v[72:75], v[156:159], v[92:95]
    ds_read_b64_tr_b16 v[66:67], v17 offset:14336
    s_waitcnt lgkmcnt(4)
    v_mfma_f32_16x16x32_bf16 v[88:91], v[96:99], v[160:163], v[88:91]
    s_waitcnt vmcnt(0)
    s_barrier
    ds_read_b64_tr_b16 v[68:69], v17 offset:16384
    v_mfma_f32_16x16x32_bf16 v[88:91], v[100:103], v[168:171], v[88:91]
    ds_read_b64_tr_b16 v[70:71], v17 offset:18432
    buffer_load_dwordx4 v[32:35], v40, s[32:35], s92 offen sc1
    v_mfma_f32_16x16x32_bf16 v[92:95], v[96:99], v[164:167], v[92:95]
    ds_read_b64_tr_b16 v[72:73], v17 offset:20480
    buffer_load_dwordx4 v[112:115], v2, s[32:35], s77 offen sc1
    v_mfma_f32_16x16x32_bf16 v[92:95], v[100:103], v[172:175], v[92:95]
    ds_read_b64_tr_b16 v[74:75], v17 offset:22528
    s_waitcnt lgkmcnt(4)
    v_mfma_f32_16x16x32_bf16 v[88:91], v[76:79], v[184:187], v[88:91]
    ds_read_b64_tr_b16 v[96:97], v17 offset:40960
    v_mfma_f32_16x16x32_bf16 v[88:91], v[64:67], v[192:195], v[88:91]
    ds_read_b64_tr_b16 v[98:99], v17 offset:43008
    v_mfma_f32_16x16x32_bf16 v[92:95], v[76:79], v[188:191], v[92:95]
    ds_read_b64_tr_b16 v[100:101], v17 offset:45056
    v_mfma_f32_16x16x32_bf16 v[92:95], v[64:67], v[196:199], v[92:95]
    ds_read_b64_tr_b16 v[102:103], v17 offset:47104
    s_waitcnt lgkmcnt(4)
    v_mfma_f32_16x16x32_bf16 v[88:91], v[68:71], v[200:203], v[88:91]
    ds_read_b64_tr_b16 v[76:77], v19 offset:0
    v_mfma_f32_16x16x32_bf16 v[88:91], v[72:75], v[208:211], v[88:91]
    ds_read_b64_tr_b16 v[78:79], v19 offset:2048
    v_mfma_f32_16x16x32_bf16 v[92:95], v[68:71], v[204:207], v[92:95]
    ds_read_b64_tr_b16 v[64:65], v19 offset:4096
    v_mfma_f32_16x16x32_bf16 v[92:95], v[72:75], v[212:215], v[92:95]
    ds_read_b64_tr_b16 v[66:67], v19 offset:6144
    buffer_load_dwordx4 v[116:119], v2, s[32:35], s77 offen offset:1024 sc1
    s_waitcnt lgkmcnt(4)
    v_mfma_f32_16x16x32_bf16 v[88:91], v[96:99], v[216:219], v[88:91]
    ds_read_b64_tr_b16 v[68:69], v18 offset:0
    buffer_load_dwordx4 v[120:123], v2, s[32:35], s78 offen sc1
    v_mfma_f32_16x16x32_bf16 v[88:91], v[100:103], v[224:227], v[88:91]
    ds_read_b64_tr_b16 v[70:71], v18 offset:2048
    v_mfma_f32_16x16x32_bf16 v[92:95], v[96:99], v[220:223], v[92:95]
    ds_read_b64_tr_b16 v[72:73], v18 offset:4096
    v_mfma_f32_16x16x32_bf16 v[92:95], v[100:103], v[228:231], v[92:95]
    ds_read_b64_tr_b16 v[74:75], v18 offset:6144
    s_waitcnt lgkmcnt(4)
    v_mfma_f32_16x16x32_bf16 v[88:91], v[76:79], v[232:235], v[88:91]
    v_mfma_f32_16x16x32_bf16 v[88:91], v[64:67], v[240:243], v[88:91]
    v_mfma_f32_16x16x32_bf16 v[92:95], v[76:79], v[236:239], v[92:95]
    v_mfma_f32_16x16x32_bf16 v[92:95], v[64:67], v[244:247], v[92:95]
    s_waitcnt lgkmcnt(0)
    v_mfma_f32_16x16x32_bf16 v[88:91], v[68:71], v[176:179], v[88:91]
    v_mfma_f32_16x16x32_bf16 v[88:91], v[72:75], v[248:251], v[88:91]
    buffer_load_dwordx4 v[124:127], v2, s[32:35], s78 offen offset:1024 sc1
    v_mfma_f32_16x16x32_bf16 v[92:95], v[68:71], v[180:183], v[92:95]
    v_mfma_f32_16x16x32_bf16 v[92:95], v[72:75], v[252:255], v[92:95]
    v_lshlrev_b32 v60, 16, v42
    v_and_b32 v61, s3, v42
    v_lshlrev_b32 v62, 16, v43
    v_and_b32 v63, s3, v43
    s_nop 0
    v_add_f32 v88, v88, v60
    v_add_f32 v89, v89, v61
    v_add_f32 v90, v90, v62
    v_add_f32 v91, v91, v63
    v_add_f32 v92, v92, v60
    v_add_f32 v93, v93, v61
    v_add_f32 v94, v94, v62
    v_add_f32 v95, v95, v63
    s_waitcnt vmcnt(4)
    v_lshlrev_b32 v64, 16, v32
    v_and_b32 v65, s3, v32
    v_lshlrev_b32 v66, 16, v33
    v_and_b32 v67, s3, v33
    v_lshlrev_b32 v68, 16, v34
    v_and_b32 v69, s3, v34
    v_lshlrev_b32 v70, 16, v35
    v_and_b32 v71, s3, v35
    v_permlane32_swap_b32 v64, v68
    v_permlane32_swap_b32 v65, v69
    v_permlane32_swap_b32 v66, v70
    v_permlane32_swap_b32 v67, v71
    v_add_f32 v64, v64, v68
    v_add_f32 v65, v65, v69
    v_add_f32 v66, v66, v70
    v_add_f32 v67, v67, v71
    s_nop 0
    v_permlane16_swap_b32 v64, v66
    v_permlane16_swap_b32 v65, v67
    v_add_f32 v64, v64, v66
    v_add_f32 v65, v65, v67
    s_nop 0
    v_add_f32_dpp v66, v64, v64 row_ror:8 row_mask:0xf bank_mask:0xf
    v_add_f32_dpp v67, v65, v65 row_ror:8 row_mask:0xf bank_mask:0xf
    v_lshlrev_b32 v64, 16, v45
    v_and_b32 v65, s3, v45
    v_add_f32 v64, v64, v66
    v_add_f32 v65, v65, v67
    v_cvt_pk_bf16_f32 v64, v64, v65
    buffer_store_dword v64, v44, s[8:11], s95 offen
    s_barrier
    buffer_load_dwordx4 v[128:131], v2, s[32:35], s79 offen sc1
    buffer_load_dwordx4 v[132:135], v2, s[32:35], s79 offen offset:1024 sc1
    buffer_load_dwordx4 v[36:39], v2, s[32:35], s76 offen sc1
    s_waitcnt vmcnt(6)
    v_lshlrev_b32 v6, 16, v112
    v_and_b32 v112, s3, v112
    v_add_f32 v88, v88, v6
    v_add_f32 v89, v89, v112
    v_lshlrev_b32 v6, 16, v113
    v_and_b32 v113, s3, v113
    v_add_f32 v90, v90, v6
    v_add_f32 v91, v91, v113
    v_lshlrev_b32 v6, 16, v114
    v_and_b32 v114, s3, v114
    v_add_f32 v92, v92, v6
    v_add_f32 v93, v93, v114
    v_lshlrev_b32 v6, 16, v115
    v_and_b32 v115, s3, v115
    v_add_f32 v94, v94, v6
    v_add_f32 v95, v95, v115
    v_lshlrev_b32 v6, 16, v116
    v_and_b32 v116, s3, v116
    v_add_f32 v88, v88, v6
    v_add_f32 v89, v89, v116
    v_lshlrev_b32 v6, 16, v117
    v_and_b32 v117, s3, v117
    v_add_f32 v90, v90, v6
    v_add_f32 v91, v91, v117
    v_lshlrev_b32 v6, 16, v118
    v_and_b32 v118, s3, v118
    v_add_f32 v92, v92, v6
    v_add_f32 v93, v93, v118
    v_lshlrev_b32 v6, 16, v119
    v_and_b32 v119, s3, v119
    v_add_f32 v94, v94, v6
    v_add_f32 v95, v95, v119
    s_waitcnt vmcnt(4)
    v_lshlrev_b32 v6, 16, v120
    v_and_b32 v120, s3, v120
    v_add_f32 v88, v88, v6
    v_add_f32 v89, v89, v120
    v_lshlrev_b32 v6, 16, v121
    v_and_b32 v121, s3, v121
    v_add_f32 v90, v90, v6
    v_add_f32 v91, v91, v121
    v_lshlrev_b32 v6, 16, v122
    v_and_b32 v122, s3, v122
    v_add_f32 v92, v92, v6
    v_add_f32 v93, v93, v122
    v_lshlrev_b32 v6, 16, v123
    v_and_b32 v123, s3, v123
    v_add_f32 v94, v94, v6
    v_add_f32 v95, v95, v123
    v_lshlrev_b32 v6, 16, v124
    v_and_b32 v124, s3, v124
    v_add_f32 v88, v88, v6
    v_add_f32 v89, v89, v124
    v_lshlrev_b32 v6, 16, v125
    v_and_b32 v125, s3, v125
    v_add_f32 v90, v90, v6
    v_add_f32 v91, v91, v125
    v_lshlrev_b32 v6, 16, v126
    v_and_b32 v126, s3, v126
    v_add_f32 v92, v92, v6
    v_add_f32 v93, v93, v126
    v_lshlrev_b32 v6, 16, v127
    v_and_b32 v127, s3, v127
    v_add_f32 v94, v94, v6
    v_add_f32 v95, v95, v127
    s_waitcnt vmcnt(1)
    v_lshlrev_b32 v6, 16, v128
    v_and_b32 v128, s3, v128
    v_add_f32 v88, v88, v6
    v_add_f32 v89, v89, v128
    v_lshlrev_b32 v6, 16, v129
    v_and_b32 v129, s3, v129
    v_add_f32 v90, v90, v6
    v_add_f32 v91, v91, v129
    v_lshlrev_b32 v6, 16, v130
    v_and_b32 v130, s3, v130
    v_add_f32 v92, v92, v6
    v_add_f32 v93, v93, v130
    v_lshlrev_b32 v6, 16, v131
    v_and_b32 v131, s3, v131
    v_add_f32 v94, v94, v6
    v_add_f32 v95, v95, v131
    v_lshlrev_b32 v6, 16, v132
    v_and_b32 v132, s3, v132
    v_add_f32 v88, v88, v6
    v_add_f32 v89, v89, v132
    v_lshlrev_b32 v6, 16, v133
    v_and_b32 v133, s3, v133
    v_add_f32 v90, v90, v6
    v_add_f32 v91, v91, v133
    v_lshlrev_b32 v6, 16, v134
    v_and_b32 v134, s3, v134
    v_add_f32 v92, v92, v6
    v_add_f32 v93, v93, v134
    v_lshlrev_b32 v6, 16, v135
    v_and_b32 v135, s3, v135
    v_add_f32 v94, v94, v6
    v_add_f32 v95, v95, v135
    s_waitcnt vmcnt(0)
    v_lshlrev_b32 v6, 16, v36
    v_and_b32 v36, s3, v36
    v_add_f32 v88, v88, v6
    v_add_f32 v89, v89, v36
    v_lshlrev_b32 v6, 16, v37
    v_and_b32 v37, s3, v37
    v_add_f32 v90, v90, v6
    v_add_f32 v91, v91, v37
    v_lshlrev_b32 v6, 16, v38
    v_and_b32 v38, s3, v38
    v_add_f32 v92, v92, v6
    v_add_f32 v93, v93, v38
    v_lshlrev_b32 v6, 16, v39
    v_and_b32 v39, s3, v39
    v_add_f32 v94, v94, v6
    v_add_f32 v95, v95, v39
    v_cvt_pk_bf16_f32 v56, v88, v89
    v_cvt_pk_bf16_f32 v57, v90, v91
    v_cvt_pk_bf16_f32 v58, v92, v93
    v_cvt_pk_bf16_f32 v59, v94, v95
    s_nop 0
    v_permlane16_swap_b32 v56, v58
    v_permlane16_swap_b32 v57, v59
    buffer_store_dwordx4 v[56:59], v41, s[8:11], s94 offen
    s_endpgm

.p2align 6
L_half1:
    v_xor_b32 v20, 64, v20
    s_add_u32 m0, s49, 59392
    s_add_u32 s51, s46, 18432
    buffer_load_dwordx4 v3, s[20:23], s51 offen lds
    buffer_load_dwordx4 v4, s[20:23], s51 offen offset:1024 lds
    s_add_u32 m0, s50, 1024
    s_add_u32 s51, s47, 73728
    buffer_load_dwordx4 v20, s[24:27], s51 offen lds
    s_add_u32 m0, s49, 75776
    s_add_u32 s51, s46, 18560
    buffer_load_dwordx4 v3, s[20:23], s51 offen lds
    buffer_load_dwordx4 v4, s[20:23], s51 offen offset:1024 lds
    s_add_u32 m0, s50, 9216
    s_add_u32 s51, s47, 663552
    buffer_load_dwordx4 v20, s[24:27], s51 offen lds
    s_add_u32 m0, s49, 92160
    s_add_u32 s51, s46, 18688
    buffer_load_dwordx4 v3, s[20:23], s51 offen lds
    buffer_load_dwordx4 v4, s[20:23], s51 offen offset:1024 lds
    s_add_u32 m0, s50, 17408
    s_add_u32 s51, s47, 1253376
    buffer_load_dwordx4 v20, s[24:27], s51 offen lds
    s_mov_b32 s99, s53
    s_mov_b32 s36, s8
    s_mov_b32 s37, s9
    s_mov_b32 s38, 9216
    s_mov_b32 s39, 0x20000
    buffer_load_ushort v31, v24, s[36:39], s96 offen
    v_bfe_u32 v48, v1, 2, 2
    v_and_b32 v49, 3, v1
    v_lshrrev_b32 v50, 4, v1
    v_and_b32 v52, 15, v1
    v_lshl_add_u32 v51, v50, 3, v48
    v_lshlrev_b32 v6, 3, v49
    v_lshl_add_u32 v8, v51, 7, v6
    v_and_b32 v6, 1, v50
    v_lshrrev_b32 v7, 1, v48
    v_lshl_add_u32 v7, v6, 1, v7
    v_xor_b32 v7, 2, v7
    v_lshl_add_u32 v8, v7, 5, v8
    v_xor_b32 v11, 32, v8
    v_and_b32 v7, 1, v49
    v_lshl_add_u32 v7, v7, 1, v6
    v_xor_b32 v7, 1, v7
    v_lshlrev_b32 v7, 4, v7
    v_lshl_add_u32 v25, v51, 6, v7
    v_lshrrev_b32 v7, 1, v49
    v_lshl_add_u32 v25, v7, 3, v25
    v_add_u32 v9, 65536, v8
    v_add_u32 v12, 65536, v11
    v_add_u32 v26, 65536, v25
    v_add_u32 v10, 131072, v8
    v_add_u32 v13, 131072, v11
    v_add_u32 v27, 131072, v25
    v_lshrrev_b32 v7, 1, v52
    v_xor_b32 v7, v7, v50
    v_lshlrev_b32 v7, 4, v7
    v_lshl_add_u32 v7, v52, 7, v7
    v_add_u32 v7, s49, v7
    v_xor_b32 v51, 64, v7
    v_add_u32 v32, 57344, v7
    v_add_u32 v34, 122880, v7
    v_add_u32 v33, 57344, v51
    v_add_u32 v35, 122880, v51
    s_xor_b32 s52, s55, 1
    s_lshl_b32 s45, s52, 8
    v_lshlrev_b32 v2, 4, v1
    v_mov_b32 v23, 0xc0135761
    s_mov_b32 s53, 0xbdd2d3e8
    s_lshr_b32 s54, s43, 2
    s_bfe_u32 s90, s43, 0x10001
    v_add_u32 v28, s50, v2
    v_add_u32 v29, 65536, v28
    v_add_u32 v30, 131072, v28
    v_lshlrev_b32 v22, 4, v52
    v_lshl_add_u32 v22, v6, 10, v22
    v_lshrrev_b32 v7, 1, v50
    v_lshl_add_u32 v22, v7, 8, v22
    v_add_u32 v22, s50, v22
    v_add_u32 v22, 147968, v22
    v_lshrrev_b32 v51, 2, v1
    v_lshlrev_b32 v7, 3, v49
    v_lshl_add_u32 v14, v51, 7, v7
    v_bfe_u32 v7, v1, 3, 2
    v_xor_b32 v7, 3, v7
    s_lshl_b32 s97, s90, 1
    v_xor_b32 v7, s97, v7
    v_lshl_add_u32 v14, v7, 5, v14
    v_xor_b32 v17, 64, v14
    v_add_u32 v15, 65536, v14
    v_add_u32 v16, 131072, v14
    v_add_u32 v18, 65536, v17
    v_add_u32 v19, 131072, v17
    s_mov_b32 s28, s10
    s_mov_b32 s29, s11
    s_mov_b32 s30, 5308416
    s_mov_b32 s31, 0x20000
    s_mov_b32 s32, s18
    s_mov_b32 s33, s19
    s_mov_b32 s34, 38010880
    s_mov_b32 s35, 0x20000
    s_mov_b32 s4, s12
    s_mov_b32 s5, s13
    s_mov_b32 s6, 1152
    s_mov_b32 s7, 0x20000
    s_mov_b32 s8, s14
    s_mov_b32 s9, s15
    s_mov_b32 s10, 2359296
    s_mov_b32 s11, 0x20000
    s_add_u32 s72, s54, 1
    s_and_b32 s72, s72, 3
    s_add_u32 s73, s54, 2
    s_and_b32 s73, s73, 3
    s_add_u32 s74, s54, 3
    s_and_b32 s74, s74, 3
    s_mov_b32 s75, s54
    s_lshr_b32 s89, s43, 1
    s_lshl_b32 s96, s42, 1
    s_add_u32 s96, s96, s55
    s_mul_i32 s96, s96, 72
    s_lshl_b32 s92, s89, 10
    s_add_u32 s97, s96, s40
    s_add_u32 s93, s97, 64
    s_lshl_b32 s93, s93, 13
    s_add_u32 s71, s93, s92
    s_add_u32 s97, s97, s40
    s_lshl_b32 s93, s97, 13
    s_add_u32 s93, s93, s92
    s_lshl_b32 s72, s72, 17
    s_add_u32 s72, s72, s93
    s_lshl_b32 s73, s73, 17
    s_add_u32 s73, s73, s93
    s_lshl_b32 s74, s74, 17
    s_add_u32 s74, s74, s93
    s_lshl_b32 s75, s75, 17
    s_add_u32 s75, s75, s93
    s_lshl_b32 s81, s90, 13
    s_xor_b32 s80, s81, 8192
    s_lshl_b32 s93, s54, 4
    s_add_u32 s97, s97, s93
    s_add_u32 s97, s97, s90
    s_lshl_b32 s97, s97, 13
    s_sub_u32 s93, s54, 1
    s_and_b32 s93, s93, 3
    s_lshl_b32 s93, s93, 11
    s_add_u32 s77, s97, s93
    s_sub_u32 s93, s54, 2
    s_and_b32 s93, s93, 3
    s_lshl_b32 s93, s93, 11
    s_add_u32 s78, s97, s93
    s_sub_u32 s93, s54, 3
    s_and_b32 s93, s93, 3
    s_lshl_b32 s93, s93, 11
    s_add_u32 s79, s97, s93
    s_xor_b32 s93, s92, 1024
    s_add_u32 s76, s97, s93
    s_add_u32 s96, s96, s89
    s_add_u32 s96, s96, 64
    s_lshl_b32 s92, s96, 13
    s_lshl_b32 s96, s42, 4
    s_add_u32 s96, s96, s43
    s_xor_b32 s97, s96, 1
    s_mul_i32 s96, s96, 73728
    s_add_u32 s82, s96, 18874368
    s_mul_i32 s97, s97, 73728
    s_add_u32 s97, s97, 18874368
    s_add_u32 s83, s97, s50
    s_mov_b32 s3, 0xffff0000
    s_lshl_b32 s96, s42, 14
    s_add_u32 s96, s96, 37748736
    s_cmp_eq_u32 s40, 4
    s_cselect_b32 s96, s96, 1073741824
    s_cselect_b32 s87, 8, 0
    s_cselect_b32 s88, 1, 0
    s_lshl_b32 s97, s55, 10
    s_add_u32 s84, s96, s97
    s_mul_i32 s97, s43, 768
    s_add_u32 s97, s97, 4096
    s_add_u32 s86, s96, s97
    s_xor_b32 s97, s43, 1
    s_mul_i32 s97, s97, 768
    s_add_u32 s97, s97, 4096
    s_add_u32 s85, s96, s97
    s_cmp_eq_u32 s43, 0
    s_cselect_b32 s52, s96, 1073741824
    s_lshl_b32 s96, s42, 2
    s_add_u32 s96, s96, s41
    s_mul_i32 s96, s96, 5248
    s_mul_i32 s97, s43, 331776
    s_add_u32 s91, s96, s97
    s_lshl_b32 s96, s41, 8
    s_add_u32 s96, s96, s2
    s_mul_i32 s48, s96, 9216
    v_mul_u32_u24 v51, 13108, v1
    v_lshrrev_b32 v51, 16, v51
    v_mul_u32_u24 v7, 5, v51
    v_sub_u32 v7, v1, v7
    v_mul_u32_u24 v51, 9, v51
    v_cmp_lt_u32 vcc, 2, v7
    v_add_u32 v48, 5, v51
    v_add_u32 v21, 2, v7
    v_cndmask_b32 v48, v51, v48, vcc
    v_add_u32 v51, v51, v21
    v_add_u32 v21, 2, v51
    v_cndmask_b32 v51, v51, v21, vcc
    v_sub_u32 v48, 3, v48
    v_and_b32 v48, 7, v48
    v_cmp_gt_u32 vcc, 2, v48
    v_cmp_ne_u32 s[96:97], 2, v7
    s_nop 3
    s_and_b64 vcc, vcc, s[96:97]
    v_subrev_u32 v48, 2, v51
    s_nop 0
    v_cndmask_b32 v51, v51, v48, vcc
    v_lshlrev_b32 v51, 7, v51
    v_cmp_gt_u32 vcc, 40, v1
    v_mov_b32 v7, 1073741824
    s_nop 0
    v_cndmask_b32 v21, v7, v51, vcc
    v_lshlrev_b32 v51, 7, v1
    v_cmp_gt_u32 vcc, 41, v1
    v_mov_b32 v7, 1073741824
    s_nop 0
    v_cndmask_b32 v47, v7, v51, vcc
    v_lshrrev_b32 v7, 3, v1
    v_and_b32 v51, 7, v1
    s_lshl_b32 s96, s40, 7
    v_lshl_add_u32 v7, v7, 10, s96
    v_lshl_add_u32 v40, v51, 4, v7
    v_lshl_add_u32 v7, v6, 4, v52
    v_mul_u32_u24 v41, 1152, v7
    v_lshrrev_b32 v7, 1, v50
    v_lshl_add_u32 v41, v7, 4, v41
    v_lshlrev_b32 v7, 3, v50
    s_lshl_b32 s96, s54, 7
    s_lshl_b32 s97, s90, 6
    s_add_u32 s96, s96, s97
    s_add_u32 s96, s96, 32
    s_mul_i32 s97, s55, 640
    s_add_u32 s96, s96, s97
    s_add_u32 s94, s46, s96
    buffer_load_dwordx2 v[42:43], v7, s[4:7], s96 offen
    s_and_b32 s96, s40, 1
    s_lshl_b32 s96, s96, 3
    v_add_u32 v51, s96, v51
    v_lshrrev_b32 v7, 5, v1
    v_lshl_add_u32 v51, v7, 4, v51
    v_mul_u32_u24 v51, 1152, v51
    v_lshlrev_b32 v7, 2, v6
    v_add_u32 v44, v51, v7
    s_lshr_b32 s96, s89, 2
    s_lshl_b32 s96, s96, 5
    s_lshl_b32 s97, s55, 6
    s_add_u32 s96, s96, s97
    s_lshr_b32 s97, s40, 1
    s_lshl_b32 s97, s97, 3
    s_add_u32 s96, s96, s97
    s_add_u32 s96, s96, 512
    buffer_load_dword v45, v7, s[4:7], s96 offen
    s_and_b32 s97, s89, 3
    s_lshl_b32 s97, s97, 5
    s_lshl_b32 s95, s42, 7
    s_add_u32 s97, s97, s95
    s_mul_i32 s97, s97, 1152
    s_add_u32 s95, s97, s96
    v_and_b32 v51, 8, v1
    v_cmp_eq_u32 vcc, 0, v51
    v_mov_b32 v7, 1073741824
    s_nop 0
    v_cndmask_b32 v44, v7, v44, vcc
    s_mov_b32 s89, s52
    s_lshl_b32 s96, s44, 2
    s_add_u32 s96, s96, 155776
    s_lshl_b32 s38, s99, 8
    s_add_u32 s96, s96, s38
    s_lshl_b32 s38, s38, 1
    s_lshl_b32 s97, s45, 2
    s_add_u32 s97, s97, 155680
    v_lshl_add_u32 v24, v50, 4, s96
    v_lshrrev_b32 v53, 1, v50
    v_lshl_add_u32 v53, v53, 4, s97
    v_lshlrev_b32 v54, 2, v0
    v_add_u32 v54, 155648, v54
    s_waitcnt vmcnt(2)
    v_lshlrev_b32 v55, 16, v31
    ds_write_b32 v54, v55 offset:0
    v_lshl_add_u32 v31, v6, 6, v53
    s_add_u32 m0, s49, 108544
    s_add_u32 s51, s46, 18816
    buffer_load_dwordx4 v3, s[20:23], s51 offen lds
    buffer_load_dwordx4 v4, s[20:23], s51 offen offset:1024 lds
    s_add_u32 m0, s50, 25600
    s_add_u32 s51, s47, 1843200
    buffer_load_dwordx4 v20, s[24:27], s51 offen lds
    s_add_u32 m0, s49, 124928
    s_add_u32 s51, s46, 18944
    buffer_load_dwordx4 v3, s[20:23], s51 offen lds
    buffer_load_dwordx4 v4, s[20:23], s51 offen offset:1024 lds
    s_add_u32 m0, s50, 33792
    s_add_u32 s51, s47, 2433024
    buffer_load_dwordx4 v20, s[24:27], s51 offen lds
    buffer_load_dword v46, v21, s[24:27], s48 offen
    s_waitcnt lgkmcnt(0)
    s_barrier
    ds_read_b128 v[80:83], v24 offset:0
    ds_read_b128 v[84:87], v24 offset:64
    ds_read_b128 v[88:91], v24 offset:0
    ds_read_b128 v[92:95], v24 offset:64
    ds_read_b128 v[112:115], v32 offset:0
    ds_read_b64_tr_b16 v[64:65], v8 offset:0
    ds_read_b64_tr_b16 v[66:67], v8 offset:512
    ds_read_b128 v[120:123], v33 offset:0
    ds_read_b64_tr_b16 v[68:69], v8 offset:4096
    ds_read_b64_tr_b16 v[70:71], v8 offset:4608
    ds_read_b128 v[116:119], v32 offset:2048
    ds_read_b64_tr_b16 v[72:73], v11 offset:0
    ds_read_b64_tr_b16 v[74:75], v11 offset:512
    ds_read_b128 v[124:127], v33 offset:2048
    ds_read_b64_tr_b16 v[76:77], v11 offset:4096
    ds_read_b64_tr_b16 v[78:79], v11 offset:4608
    s_waitcnt lgkmcnt(9)
    v_mfma_f32_16x16x32_bf16 v[80:83], v[64:67], v[112:115], v[80:83]
    s_barrier
    ds_read_b64_tr_b16 v[36:37], v8 offset:8192
    ds_read_b128 v[128:131], v32 offset:16384
    s_add_u32 m0, s49, 141312
    s_add_u32 s51, s46, 19072
    buffer_load_dwordx4 v3, s[20:23], s51 offen lds
    s_waitcnt lgkmcnt(8)
    v_mfma_f32_16x16x32_bf16 v[80:83], v[68:71], v[120:123], v[80:83]
    ds_read_b64_tr_b16 v[38:39], v8 offset:8704
    s_waitcnt lgkmcnt(8)
    v_mfma_f32_16x16x32_bf16 v[88:91], v[64:67], v[116:119], v[88:91]
    ds_read_b64_tr_b16 v[64:65], v8 offset:12288
    ds_read_b128 v[136:139], v33 offset:16384
    buffer_load_dwordx4 v4, s[20:23], s51 offen offset:1024 lds
    s_waitcnt lgkmcnt(7)
    v_mfma_f32_16x16x32_bf16 v[88:91], v[68:71], v[124:127], v[88:91]
    ds_read_b64_tr_b16 v[66:67], v8 offset:12800
    v_mfma_f32_16x16x32_bf16 v[84:87], v[72:75], v[112:115], v[84:87]
    ds_read_b64_tr_b16 v[68:69], v11 offset:8192
    ds_read_b128 v[132:135], v32 offset:18432
    s_waitcnt lgkmcnt(8)
    v_mfma_f32_16x16x32_bf16 v[84:87], v[76:79], v[120:123], v[84:87]
    ds_read_b64_tr_b16 v[70:71], v11 offset:8704
    s_add_u32 m0, s50, 41984
    s_add_u32 s51, s47, 3022848
    buffer_load_dwordx4 v20, s[24:27], s51 offen lds
    v_mfma_f32_16x16x32_bf16 v[92:95], v[72:75], v[116:119], v[92:95]
    ds_read_b64_tr_b16 v[72:73], v11 offset:12288
    ds_read_b128 v[140:143], v33 offset:18432
    v_mfma_f32_16x16x32_bf16 v[92:95], v[76:79], v[124:127], v[92:95]
    ds_read_b64_tr_b16 v[74:75], v11 offset:12800
    s_waitcnt lgkmcnt(6)
    v_mfma_f32_16x16x32_bf16 v[80:83], v[36:39], v[128:131], v[80:83]
    s_barrier
    ds_read_b64_tr_b16 v[76:77], v8 offset:16384
    ds_read_b128 v[144:147], v32 offset:32768
    s_add_u32 m0, s49, 59392
    s_add_u32 s51, s46, 19200
    buffer_load_dwordx4 v3, s[20:23], s51 offen lds
    v_mfma_f32_16x16x32_bf16 v[80:83], v[64:67], v[136:139], v[80:83]
    ds_read_b64_tr_b16 v[78:79], v8 offset:16896
    s_waitcnt lgkmcnt(4)
    v_mfma_f32_16x16x32_bf16 v[88:91], v[36:39], v[132:135], v[88:91]
    ds_read_b64_tr_b16 v[36:37], v8 offset:20480
    ds_read_b128 v[152:155], v33 offset:32768
    buffer_load_dwordx4 v4, s[20:23], s51 offen offset:1024 lds
    v_mfma_f32_16x16x32_bf16 v[88:91], v[64:67], v[140:143], v[88:91]
    ds_read_b64_tr_b16 v[38:39], v8 offset:20992
    s_waitcnt lgkmcnt(6)
    v_mfma_f32_16x16x32_bf16 v[84:87], v[68:71], v[128:131], v[84:87]
    ds_read_b64_tr_b16 v[64:65], v11 offset:16384
    ds_read_b128 v[148:151], v32 offset:34816
    v_mfma_f32_16x16x32_bf16 v[84:87], v[72:75], v[136:139], v[84:87]
    ds_read_b64_tr_b16 v[66:67], v11 offset:16896
    s_add_u32 m0, s50, 1024
    s_add_u32 s51, s47, 3612672
    buffer_load_dwordx4 v20, s[24:27], s51 offen lds
    v_mfma_f32_16x16x32_bf16 v[92:95], v[68:71], v[132:135], v[92:95]
    ds_read_b64_tr_b16 v[68:69], v11 offset:20480
    ds_read_b128 v[156:159], v33 offset:34816
    v_mfma_f32_16x16x32_bf16 v[92:95], v[72:75], v[140:143], v[92:95]
    ds_read_b64_tr_b16 v[70:71], v11 offset:20992
    s_waitcnt lgkmcnt(6)
    v_mfma_f32_16x16x32_bf16 v[80:83], v[76:79], v[144:147], v[80:83]
    s_waitcnt vmcnt(10)
    s_barrier
    ds_read_b64_tr_b16 v[72:73], v8 offset:24576
    ds_read_b128 v[160:163], v32 offset:49152
    s_add_u32 m0, s49, 75776
    s_add_u32 s51, s46, 19328
    buffer_load_dwordx4 v3, s[20:23], s51 offen lds
    v_mfma_f32_16x16x32_bf16 v[80:83], v[36:39], v[152:155], v[80:83]
    ds_read_b64_tr_b16 v[74:75], v8 offset:25088
    s_waitcnt lgkmcnt(4)
    v_mfma_f32_16x16x32_bf16 v[88:91], v[76:79], v[148:151], v[88:91]
    ds_read_b64_tr_b16 v[76:77], v8 offset:28672
    ds_read_b128 v[168:171], v33 offset:49152
    buffer_load_dwordx4 v4, s[20:23], s51 offen offset:1024 lds
    v_mfma_f32_16x16x32_bf16 v[88:91], v[36:39], v[156:159], v[88:91]
    ds_read_b64_tr_b16 v[78:79], v8 offset:29184
    s_waitcnt lgkmcnt(6)
    v_mfma_f32_16x16x32_bf16 v[84:87], v[64:67], v[144:147], v[84:87]
    ds_read_b64_tr_b16 v[36:37], v11 offset:24576
    ds_read_b128 v[164:167], v32 offset:51200
    v_mfma_f32_16x16x32_bf16 v[84:87], v[68:71], v[152:155], v[84:87]
    ds_read_b64_tr_b16 v[38:39], v11 offset:25088
    s_add_u32 m0, s50, 9216
    s_add_u32 s51, s47, 4202496
    buffer_load_dwordx4 v20, s[24:27], s51 offen lds
    v_mfma_f32_16x16x32_bf16 v[92:95], v[64:67], v[148:151], v[92:95]
    ds_read_b64_tr_b16 v[64:65], v11 offset:28672
    ds_read_b128 v[172:175], v33 offset:51200
    v_mfma_f32_16x16x32_bf16 v[92:95], v[68:71], v[156:159], v[92:95]
    ds_read_b64_tr_b16 v[66:67], v11 offset:29184
    s_waitcnt lgkmcnt(6)
    v_mfma_f32_16x16x32_bf16 v[80:83], v[72:75], v[160:163], v[80:83]
    s_waitcnt vmcnt(10)
    s_barrier
    ds_read_b64_tr_b16 v[68:69], v8 offset:32768
    ds_read_b128 v[176:179], v34 offset:0
    s_add_u32 m0, s49, 92160
    s_add_u32 s51, s46, 19456
    buffer_load_dwordx4 v3, s[20:23], s51 offen lds
    v_mfma_f32_16x16x32_bf16 v[80:83], v[76:79], v[168:171], v[80:83]
    ds_read_b64_tr_b16 v[70:71], v8 offset:33280
    s_waitcnt lgkmcnt(4)
    v_mfma_f32_16x16x32_bf16 v[88:91], v[72:75], v[164:167], v[88:91]
    ds_read_b64_tr_b16 v[72:73], v8 offset:36864
    ds_read_b128 v[184:187], v35 offset:0
    buffer_load_dwordx4 v4, s[20:23], s51 offen offset:1024 lds
    v_mfma_f32_16x16x32_bf16 v[88:91], v[76:79], v[172:175], v[88:91]
    ds_read_b64_tr_b16 v[74:75], v8 offset:37376
    s_waitcnt lgkmcnt(6)
    v_mfma_f32_16x16x32_bf16 v[84:87], v[36:39], v[160:163], v[84:87]
    ds_read_b64_tr_b16 v[76:77], v11 offset:32768
    ds_read_b128 v[180:183], v34 offset:2048
    v_mfma_f32_16x16x32_bf16 v[84:87], v[64:67], v[168:171], v[84:87]
    ds_read_b64_tr_b16 v[78:79], v11 offset:33280
    s_add_u32 m0, s50, 17408
    s_add_u32 s51, s47, 4792320
    buffer_load_dwordx4 v20, s[24:27], s51 offen lds
    v_mfma_f32_16x16x32_bf16 v[92:95], v[36:39], v[164:167], v[92:95]
    ds_read_b64_tr_b16 v[36:37], v11 offset:36864
    ds_read_b128 v[188:191], v35 offset:2048
    v_mfma_f32_16x16x32_bf16 v[92:95], v[64:67], v[172:175], v[92:95]
    ds_read_b64_tr_b16 v[38:39], v11 offset:37376
    s_waitcnt lgkmcnt(6)
    v_mfma_f32_16x16x32_bf16 v[80:83], v[68:71], v[176:179], v[80:83]
    s_waitcnt vmcnt(9)
    s_barrier
    ds_read_b64_tr_b16 v[64:65], v8 offset:40960
    ds_read_b128 v[192:195], v34 offset:16384
    v_mfma_f32_16x16x32_bf16 v[80:83], v[72:75], v[184:187], v[80:83]
    ds_read_b64_tr_b16 v[66:67], v8 offset:41472
    s_waitcnt lgkmcnt(4)
    v_mfma_f32_16x16x32_bf16 v[88:91], v[68:71], v[180:183], v[88:91]
    ds_read_b64_tr_b16 v[68:69], v8 offset:45056
    ds_read_b128 v[200:203], v35 offset:16384
    v_mfma_f32_16x16x32_bf16 v[88:91], v[72:75], v[188:191], v[88:91]
    ds_read_b64_tr_b16 v[70:71], v8 offset:45568
    s_waitcnt lgkmcnt(6)
    v_mfma_f32_16x16x32_bf16 v[84:87], v[76:79], v[176:179], v[84:87]
    ds_read_b64_tr_b16 v[72:73], v11 offset:40960
    ds_read_b128 v[196:199], v34 offset:18432
    v_mfma_f32_16x16x32_bf16 v[84:87], v[36:39], v[184:187], v[84:87]
    ds_read_b64_tr_b16 v[74:75], v11 offset:41472
    v_mfma_f32_16x16x32_bf16 v[92:95], v[76:79], v[180:183], v[92:95]
    ds_read_b64_tr_b16 v[76:77], v11 offset:45056
    ds_read_b128 v[204:207], v35 offset:18432
    v_mfma_f32_16x16x32_bf16 v[92:95], v[36:39], v[188:191], v[92:95]
    ds_read_b64_tr_b16 v[78:79], v11 offset:45568
    s_waitcnt lgkmcnt(6)
    v_mfma_f32_16x16x32_bf16 v[80:83], v[64:67], v[192:195], v[80:83]
    s_waitcnt vmcnt(6)
    s_barrier
    ds_read_b64_tr_b16 v[36:37], v8 offset:0
    ds_read_b128 v[208:211], v32 offset:0
    v_mfma_f32_16x16x32_bf16 v[80:83], v[68:71], v[200:203], v[80:83]
    ds_read_b64_tr_b16 v[38:39], v8 offset:512
    s_waitcnt lgkmcnt(4)
    v_mfma_f32_16x16x32_bf16 v[88:91], v[64:67], v[196:199], v[88:91]
    ds_read_b64_tr_b16 v[64:65], v8 offset:4096
    ds_read_b128 v[216:219], v33 offset:0
    v_mfma_f32_16x16x32_bf16 v[88:91], v[68:71], v[204:207], v[88:91]
    ds_read_b64_tr_b16 v[66:67], v8 offset:4608
    s_waitcnt lgkmcnt(6)
    v_mfma_f32_16x16x32_bf16 v[84:87], v[72:75], v[192:195], v[84:87]
    ds_read_b64_tr_b16 v[68:69], v11 offset:0
    ds_read_b128 v[212:215], v32 offset:2048
    v_mfma_f32_16x16x32_bf16 v[84:87], v[76:79], v[200:203], v[84:87]
    ds_read_b64_tr_b16 v[70:71], v11 offset:512
    v_mfma_f32_16x16x32_bf16 v[92:95], v[72:75], v[196:199], v[92:95]
    ds_read_b64_tr_b16 v[72:73], v11 offset:4096
    ds_read_b128 v[220:223], v33 offset:2048
    v_mfma_f32_16x16x32_bf16 v[92:95], v[76:79], v[204:207], v[92:95]
    ds_read_b64_tr_b16 v[74:75], v11 offset:4608
    v_lshlrev_b32 v6, 8, v1
    v_mov_b32 v7, 1073741824
    v_mov_b32 v4, 0
    buffer_store_dword v4, v6, s[32:35], s89 offen sc1
    v_cmp_eq_u32 vcc, 0, v1
    s_nop 1
    v_cndmask_b32 v3, v7, v4, vcc
    s_waitcnt lgkmcnt(6)
    v_mfma_f32_16x16x32_bf16 v[80:83], v[36:39], v[208:211], v[80:83]
    s_waitcnt vmcnt(4)
    s_barrier
    ds_read_b64_tr_b16 v[76:77], v8 offset:8192
    ds_read_b128 v[224:227], v32 offset:16384
    buffer_load_dword v46, v47, s[28:31], s91 offen
    v_mfma_f32_16x16x32_bf16 v[80:83], v[64:67], v[216:219], v[80:83]
    ds_read_b64_tr_b16 v[78:79], v8 offset:8704
    s_waitcnt lgkmcnt(4)
    v_mfma_f32_16x16x32_bf16 v[88:91], v[36:39], v[212:215], v[88:91]
    ds_read_b64_tr_b16 v[36:37], v8 offset:12288
    ds_read_b128 v[232:235], v33 offset:16384
    v_mfma_f32_16x16x32_bf16 v[88:91], v[64:67], v[220:223], v[88:91]
    ds_read_b64_tr_b16 v[38:39], v8 offset:12800
    s_waitcnt lgkmcnt(6)
    v_mfma_f32_16x16x32_bf16 v[84:87], v[68:71], v[208:211], v[84:87]
    ds_read_b64_tr_b16 v[64:65], v11 offset:8192
    ds_read_b128 v[228:231], v32 offset:18432
    v_mfma_f32_16x16x32_bf16 v[84:87], v[72:75], v[216:219], v[84:87]
    ds_read_b64_tr_b16 v[66:67], v11 offset:8704
    v_mfma_f32_16x16x32_bf16 v[92:95], v[68:71], v[212:215], v[92:95]
    ds_read_b64_tr_b16 v[68:69], v11 offset:12288
    ds_read_b128 v[236:239], v33 offset:18432
    v_mfma_f32_16x16x32_bf16 v[92:95], v[72:75], v[220:223], v[92:95]
    ds_read_b64_tr_b16 v[70:71], v11 offset:12800
    s_waitcnt lgkmcnt(6)
    v_mfma_f32_16x16x32_bf16 v[80:83], v[76:79], v[224:227], v[80:83]
    s_waitcnt vmcnt(2)
    s_barrier
    ds_read_b64_tr_b16 v[72:73], v8 offset:16384
    ds_read_b128 v[240:243], v32 offset:32768
    v_mfma_f32_16x16x32_bf16 v[80:83], v[36:39], v[232:235], v[80:83]
    ds_read_b64_tr_b16 v[74:75], v8 offset:16896
    s_waitcnt lgkmcnt(4)
    v_mfma_f32_16x16x32_bf16 v[88:91], v[76:79], v[228:231], v[88:91]
    ds_read_b64_tr_b16 v[76:77], v8 offset:20480
    ds_read_b128 v[248:251], v33 offset:32768
    v_mfma_f32_16x16x32_bf16 v[88:91], v[36:39], v[236:239], v[88:91]
    ds_read_b64_tr_b16 v[78:79], v8 offset:20992
    s_waitcnt lgkmcnt(6)
    v_mfma_f32_16x16x32_bf16 v[84:87], v[64:67], v[224:227], v[84:87]
    ds_read_b64_tr_b16 v[36:37], v11 offset:16384
    ds_read_b128 v[244:247], v32 offset:34816
    v_mfma_f32_16x16x32_bf16 v[84:87], v[68:71], v[232:235], v[84:87]
    ds_read_b64_tr_b16 v[38:39], v11 offset:16896
    v_mfma_f32_16x16x32_bf16 v[92:95], v[64:67], v[228:231], v[92:95]
    ds_read_b64_tr_b16 v[64:65], v11 offset:20480
    ds_read_b128 v[252:255], v33 offset:34816
    v_mfma_f32_16x16x32_bf16 v[92:95], v[68:71], v[236:239], v[92:95]
    ds_read_b64_tr_b16 v[66:67], v11 offset:20992
    s_waitcnt lgkmcnt(6)
    v_mfma_f32_16x16x32_bf16 v[80:83], v[72:75], v[240:243], v[80:83]
    s_barrier
    ds_read_b64_tr_b16 v[68:69], v8 offset:24576
    ds_read_b128 v[96:99], v24 offset:256
    v_mfma_f32_16x16x32_bf16 v[80:83], v[76:79], v[248:251], v[80:83]
    ds_read_b64_tr_b16 v[70:71], v8 offset:25088
    s_waitcnt lgkmcnt(4)
    v_mfma_f32_16x16x32_bf16 v[88:91], v[72:75], v[244:247], v[88:91]
    ds_read_b64_tr_b16 v[32:33], v8 offset:28672
    ds_read_b128 v[100:103], v24 offset:320
    v_mfma_f32_16x16x32_bf16 v[88:91], v[76:79], v[252:255], v[88:91]
    ds_read_b64_tr_b16 v[34:35], v8 offset:29184
    s_waitcnt lgkmcnt(6)
    v_mfma_f32_16x16x32_bf16 v[84:87], v[36:39], v[240:243], v[84:87]
    ds_read_b64_tr_b16 v[72:73], v11 offset:24576
    ds_read_b128 v[104:107], v24 offset:256
    v_mfma_f32_16x16x32_bf16 v[84:87], v[64:67], v[248:251], v[84:87]
    ds_read_b64_tr_b16 v[74:75], v11 offset:25088
    v_mfma_f32_16x16x32_bf16 v[92:95], v[36:39], v[244:247], v[92:95]
    ds_read_b64_tr_b16 v[76:77], v11 offset:28672
    ds_read_b128 v[108:111], v24 offset:320
    v_mfma_f32_16x16x32_bf16 v[92:95], v[64:67], v[252:255], v[92:95]
    ds_read_b64_tr_b16 v[78:79], v11 offset:29184
    s_waitcnt lgkmcnt(1)
    v_mfma_f32_16x16x32_bf16 v[96:99], v[68:71], v[112:115], v[96:99]
    s_barrier
    ds_read_b64_tr_b16 v[36:37], v8 offset:49152
    v_subrev_u32 v24, s38, v24
    v_mfma_f32_16x16x32_bf16 v[96:99], v[32:35], v[120:123], v[96:99]
    ds_read_b64_tr_b16 v[38:39], v8 offset:49664
    v_mfma_f32_16x16x32_bf16 v[104:107], v[68:71], v[116:119], v[104:107]
    ds_read_b64_tr_b16 v[64:65], v8 offset:53248
    v_mfma_f32_16x16x32_bf16 v[104:107], v[32:35], v[124:127], v[104:107]
    ds_read_b64_tr_b16 v[66:67], v8 offset:53760
    s_waitcnt lgkmcnt(4)
    v_mfma_f32_16x16x32_bf16 v[100:103], v[72:75], v[112:115], v[100:103]
    ds_read_b64_tr_b16 v[68:69], v11 offset:49152
    v_mul_f32 v48, v80, v80
    v_mul_f32 v49, v81, v81
    v_mfma_f32_16x16x32_bf16 v[100:103], v[76:79], v[120:123], v[100:103]
    ds_read_b64_tr_b16 v[70:71], v11 offset:49664
    v_mul_f32 v50, v82, v82
    v_mul_f32 v51, v83, v83
    v_fma_f32 v48, v48, s53, v23
    v_mfma_f32_16x16x32_bf16 v[108:111], v[72:75], v[116:119], v[108:111]
    ds_read_b64_tr_b16 v[32:33], v11 offset:53248
    v_fma_f32 v49, v49, s53, v23
    v_fma_f32 v50, v50, s53, v23
    v_mfma_f32_16x16x32_bf16 v[108:111], v[76:79], v[124:127], v[108:111]
    ds_read_b64_tr_b16 v[34:35], v11 offset:53760
    v_fma_f32 v51, v51, s53, v23
    v_mul_f32 v48, v80, v48
    v_mul_f32 v49, v81, v49
    s_waitcnt lgkmcnt(4)
    v_mfma_f32_16x16x32_bf16 v[96:99], v[36:39], v[128:131], v[96:99]
    ds_read_b64_tr_b16 v[72:73], v8 offset:32768
    v_mul_f32 v50, v82, v50
    v_mul_f32 v51, v83, v51
    v_mfma_f32_16x16x32_bf16 v[96:99], v[64:67], v[136:139], v[96:99]
    ds_read_b64_tr_b16 v[74:75], v8 offset:33280
    v_exp_f32 v48, v48
    v_mfma_f32_16x16x32_bf16 v[104:107], v[36:39], v[132:135], v[104:107]
    ds_read_b64_tr_b16 v[76:77], v8 offset:36864
    v_exp_f32 v49, v49
    v_exp_f32 v50, v50
    v_mfma_f32_16x16x32_bf16 v[104:107], v[64:67], v[140:143], v[104:107]
    ds_read_b64_tr_b16 v[78:79], v8 offset:37376
    v_exp_f32 v51, v51
    s_waitcnt lgkmcnt(4)
    v_mfma_f32_16x16x32_bf16 v[100:103], v[68:71], v[128:131], v[100:103]
    ds_read_b64_tr_b16 v[36:37], v11 offset:32768
    v_add_f32 v48, 1.0, v48
    v_add_f32 v49, 1.0, v49
    v_mfma_f32_16x16x32_bf16 v[100:103], v[32:35], v[136:139], v[100:103]
    ds_read_b64_tr_b16 v[38:39], v11 offset:33280
    v_add_f32 v50, 1.0, v50
    v_add_f32 v51, 1.0, v51
    v_mfma_f32_16x16x32_bf16 v[108:111], v[68:71], v[132:135], v[108:111]
    ds_read_b64_tr_b16 v[64:65], v11 offset:36864
    v_rcp_f32 v48, v48
    v_rcp_f32 v49, v49
    v_mfma_f32_16x16x32_bf16 v[108:111], v[32:35], v[140:143], v[108:111]
    ds_read_b64_tr_b16 v[66:67], v11 offset:37376
    v_rcp_f32 v50, v50
    s_waitcnt lgkmcnt(4)
    v_mfma_f32_16x16x32_bf16 v[96:99], v[72:75], v[144:147], v[96:99]
    s_barrier
    ds_read_b64_tr_b16 v[68:69], v9 offset:40960
    v_rcp_f32 v51, v51
    v_mfma_f32_16x16x32_bf16 v[96:99], v[76:79], v[152:155], v[96:99]
    ds_read_b64_tr_b16 v[70:71], v9 offset:41472
    v_mul_f32 v80, v80, v48
    v_mul_f32 v81, v81, v49
    v_mul_f32 v82, v82, v50
    v_mfma_f32_16x16x32_bf16 v[104:107], v[72:75], v[148:151], v[104:107]
    ds_read_b64_tr_b16 v[32:33], v9 offset:45056
    v_mul_f32 v83, v83, v51
    v_cvt_pk_bf16_f32 v56, v80, v81
    v_mfma_f32_16x16x32_bf16 v[104:107], v[76:79], v[156:159], v[104:107]
    ds_read_b64_tr_b16 v[34:35], v9 offset:45568
    v_cvt_pk_bf16_f32 v57, v82, v83
    ds_read_b128 v[80:83], v24 offset:512
    v_mul_f32 v52, v84, v84
    s_waitcnt lgkmcnt(5)
    v_mfma_f32_16x16x32_bf16 v[100:103], v[36:39], v[144:147], v[100:103]
    ds_read_b64_tr_b16 v[72:73], v12 offset:40960
    v_mul_f32 v53, v85, v85
    v_mul_f32 v54, v86, v86
    v_mfma_f32_16x16x32_bf16 v[100:103], v[64:67], v[152:155], v[100:103]
    ds_read_b64_tr_b16 v[74:75], v12 offset:41472
    v_mul_f32 v55, v87, v87
    v_fma_f32 v52, v52, s53, v23
    v_fma_f32 v53, v53, s53, v23
    v_mfma_f32_16x16x32_bf16 v[108:111], v[36:39], v[148:151], v[108:111]
    ds_read_b64_tr_b16 v[76:77], v12 offset:45056
    v_fma_f32 v54, v54, s53, v23
    v_fma_f32 v55, v55, s53, v23
    v_mfma_f32_16x16x32_bf16 v[108:111], v[64:67], v[156:159], v[108:111]
    ds_read_b64_tr_b16 v[78:79], v12 offset:45568
    v_mul_f32 v52, v84, v52
    v_mul_f32 v53, v85, v53
    v_mul_f32 v54, v86, v54
    s_waitcnt lgkmcnt(5)
    v_mfma_f32_16x16x32_bf16 v[96:99], v[68:71], v[160:163], v[96:99]
    ds_read_b64_tr_b16 v[36:37], v8 offset:40960
    v_mul_f32 v55, v87, v55
    v_exp_f32 v52, v52
    v_mfma_f32_16x16x32_bf16 v[96:99], v[32:35], v[168:171], v[96:99]
    ds_read_b64_tr_b16 v[38:39], v8 offset:41472
    v_exp_f32 v53, v53
    v_mfma_f32_16x16x32_bf16 v[104:107], v[68:71], v[164:167], v[104:107]
    ds_read_b64_tr_b16 v[64:65], v8 offset:45056
    s_mov_b32 s36, s16
    s_mov_b32 s37, s17
    s_mov_b32 s38, 256
    s_mov_b32 s39, 0x20000
    s_lshl_b32 s96, s42, 2
    s_cmp_lg_u32 s40, 4
    s_cselect_b32 s96, 1024, s96
    s_cmp_lg_u32 s43, 0
    s_cselect_b32 s96, 1024, s96
    s_waitcnt vmcnt(1)
    v_mov_b32 v4, 1
    buffer_atomic_add v4, v3, s[36:39], s96 offen
    v_exp_f32 v54, v54
    v_mfma_f32_16x16x32_bf16 v[104:107], v[32:35], v[172:175], v[104:107]
    ds_read_b64_tr_b16 v[66:67], v8 offset:45568
    v_exp_f32 v55, v55
    v_add_f32 v52, 1.0, v52
    s_waitcnt lgkmcnt(4)
    v_mfma_f32_16x16x32_bf16 v[100:103], v[72:75], v[160:163], v[100:103]
    ds_read_b64_tr_b16 v[68:69], v11 offset:40960
    v_add_f32 v53, 1.0, v53
    v_add_f32 v54, 1.0, v54
    v_mfma_f32_16x16x32_bf16 v[100:103], v[76:79], v[168:171], v[100:103]
    ds_read_b64_tr_b16 v[70:71], v11 offset:41472
    v_add_f32 v55, 1.0, v55
    v_rcp_f32 v52, v52
    v_mfma_f32_16x16x32_bf16 v[108:111], v[72:75], v[164:167], v[108:111]
    ds_read_b64_tr_b16 v[32:33], v11 offset:45056
    v_rcp_f32 v53, v53
    v_mfma_f32_16x16x32_bf16 v[108:111], v[76:79], v[172:175], v[108:111]
    ds_read_b64_tr_b16 v[34:35], v11 offset:45568
    v_rcp_f32 v54, v54
    s_waitcnt lgkmcnt(4)
    v_mfma_f32_16x16x32_bf16 v[96:99], v[36:39], v[176:179], v[96:99]
    s_barrier
    ds_read_b64_tr_b16 v[72:73], v9 offset:49152
    v_rcp_f32 v55, v55
    v_mul_f32 v84, v84, v52
    v_mfma_f32_16x16x32_bf16 v[96:99], v[64:67], v[184:187], v[96:99]
    ds_read_b64_tr_b16 v[74:75], v9 offset:49664
    v_mul_f32 v85, v85, v53
    v_mul_f32 v86, v86, v54
    v_mul_f32 v87, v87, v55
    v_mfma_f32_16x16x32_bf16 v[104:107], v[36:39], v[180:183], v[104:107]
    ds_read_b64_tr_b16 v[76:77], v9 offset:53248
    v_cvt_pk_bf16_f32 v58, v84, v85
    v_cvt_pk_bf16_f32 v59, v86, v87
    v_mfma_f32_16x16x32_bf16 v[104:107], v[64:67], v[188:191], v[104:107]
    ds_read_b64_tr_b16 v[78:79], v9 offset:53760
    ds_read_b128 v[84:87], v24 offset:576
    ds_write_b128 v29, v[56:59] offset:24576
    s_waitcnt lgkmcnt(6)
    v_mfma_f32_16x16x32_bf16 v[100:103], v[68:71], v[176:179], v[100:103]
    ds_read_b64_tr_b16 v[36:37], v12 offset:49152
    s_add_u32 s52, s82, 8192
    buffer_store_dwordx4 v[56:59], v28, s[32:35], s52 offen sc1
    v_mfma_f32_16x16x32_bf16 v[100:103], v[32:35], v[184:187], v[100:103]
    ds_read_b64_tr_b16 v[38:39], v12 offset:49664
    v_mul_f32 v48, v88, v88
    v_mul_f32 v49, v89, v89
    v_mfma_f32_16x16x32_bf16 v[108:111], v[68:71], v[180:183], v[108:111]
    ds_read_b64_tr_b16 v[64:65], v12 offset:53248
    v_mul_f32 v50, v90, v90
    v_mul_f32 v51, v91, v91
    v_fma_f32 v48, v48, s53, v23
    v_mfma_f32_16x16x32_bf16 v[108:111], v[32:35], v[188:191], v[108:111]
    ds_read_b64_tr_b16 v[66:67], v12 offset:53760
    v_fma_f32 v49, v49, s53, v23
    v_fma_f32 v50, v50, s53, v23
    s_waitcnt lgkmcnt(6)
    v_mfma_f32_16x16x32_bf16 v[96:99], v[72:75], v[192:195], v[96:99]
    ds_read_b64_tr_b16 v[68:69], v8 offset:0
    v_fma_f32 v51, v51, s53, v23
    v_mul_f32 v48, v88, v48
    v_mul_f32 v49, v89, v49
    v_mfma_f32_16x16x32_bf16 v[96:99], v[76:79], v[200:203], v[96:99]
    ds_read_b64_tr_b16 v[70:71], v8 offset:512
    v_mul_f32 v50, v90, v50
    v_mul_f32 v51, v91, v51
    v_mfma_f32_16x16x32_bf16 v[104:107], v[72:75], v[196:199], v[104:107]
    ds_read_b64_tr_b16 v[32:33], v8 offset:4096
    v_exp_f32 v48, v48
    v_mfma_f32_16x16x32_bf16 v[104:107], v[76:79], v[204:207], v[104:107]
    ds_read_b64_tr_b16 v[34:35], v8 offset:4608
    v_exp_f32 v49, v49
    v_exp_f32 v50, v50
    s_waitcnt lgkmcnt(4)
    v_mfma_f32_16x16x32_bf16 v[100:103], v[36:39], v[192:195], v[100:103]
    ds_read_b64_tr_b16 v[72:73], v11 offset:0
    v_exp_f32 v51, v51
    v_mfma_f32_16x16x32_bf16 v[100:103], v[64:67], v[200:203], v[100:103]
    ds_read_b64_tr_b16 v[74:75], v11 offset:512
    v_add_f32 v48, 1.0, v48
    v_add_f32 v49, 1.0, v49
    v_mfma_f32_16x16x32_bf16 v[108:111], v[36:39], v[196:199], v[108:111]
    ds_read_b64_tr_b16 v[76:77], v11 offset:4096
    v_add_f32 v50, 1.0, v50
    v_add_f32 v51, 1.0, v51
    v_mfma_f32_16x16x32_bf16 v[108:111], v[64:67], v[204:207], v[108:111]
    ds_read_b64_tr_b16 v[78:79], v11 offset:4608
    v_rcp_f32 v48, v48
    v_rcp_f32 v49, v49
    s_waitcnt lgkmcnt(4)
    v_mfma_f32_16x16x32_bf16 v[96:99], v[68:71], v[208:211], v[96:99]
    s_barrier
    ds_read_b64_tr_b16 v[36:37], v8 offset:57344
    v_rcp_f32 v50, v50
    v_mfma_f32_16x16x32_bf16 v[96:99], v[32:35], v[216:219], v[96:99]
    ds_read_b64_tr_b16 v[38:39], v8 offset:57856
    v_rcp_f32 v51, v51
    v_mfma_f32_16x16x32_bf16 v[104:107], v[68:71], v[212:215], v[104:107]
    ds_read_b64_tr_b16 v[64:65], v8 offset:61440
    v_mul_f32 v88, v88, v48
    v_mul_f32 v89, v89, v49
    v_mul_f32 v90, v90, v50
    v_mfma_f32_16x16x32_bf16 v[104:107], v[32:35], v[220:223], v[104:107]
    ds_read_b64_tr_b16 v[66:67], v8 offset:61952
    v_mul_f32 v91, v91, v51
    v_cvt_pk_bf16_f32 v60, v88, v89
    s_waitcnt lgkmcnt(4)
    v_mfma_f32_16x16x32_bf16 v[100:103], v[72:75], v[208:211], v[100:103]
    ds_read_b64_tr_b16 v[68:69], v11 offset:57344
    v_cvt_pk_bf16_f32 v61, v90, v91
    ds_read_b128 v[88:91], v24 offset:512
    v_mul_f32 v52, v92, v92
    v_mfma_f32_16x16x32_bf16 v[100:103], v[76:79], v[216:219], v[100:103]
    ds_read_b64_tr_b16 v[70:71], v11 offset:57856
    v_mul_f32 v53, v93, v93
    v_mul_f32 v54, v94, v94
    v_mfma_f32_16x16x32_bf16 v[108:111], v[72:75], v[212:215], v[108:111]
    ds_read_b64_tr_b16 v[32:33], v11 offset:61440
    v_mul_f32 v55, v95, v95
    v_fma_f32 v52, v52, s53, v23
    v_fma_f32 v53, v53, s53, v23
    v_mfma_f32_16x16x32_bf16 v[108:111], v[76:79], v[220:223], v[108:111]
    ds_read_b64_tr_b16 v[34:35], v11 offset:61952
    v_fma_f32 v54, v54, s53, v23
    v_fma_f32 v55, v55, s53, v23
    s_waitcnt lgkmcnt(5)
    v_mfma_f32_16x16x32_bf16 v[96:99], v[36:39], v[224:227], v[96:99]
    ds_read_b64_tr_b16 v[72:73], v8 offset:8192
    v_mul_f32 v52, v92, v52
    v_mul_f32 v53, v93, v53
    v_mul_f32 v54, v94, v54
    v_mfma_f32_16x16x32_bf16 v[96:99], v[64:67], v[232:235], v[96:99]
    ds_read_b64_tr_b16 v[74:75], v8 offset:8704
    v_mul_f32 v55, v95, v55
    v_exp_f32 v52, v52
    v_mfma_f32_16x16x32_bf16 v[104:107], v[36:39], v[228:231], v[104:107]
    ds_read_b64_tr_b16 v[76:77], v8 offset:12288
    v_exp_f32 v53, v53
    v_mfma_f32_16x16x32_bf16 v[104:107], v[64:67], v[236:239], v[104:107]
    ds_read_b64_tr_b16 v[78:79], v8 offset:12800
    v_exp_f32 v54, v54
    s_waitcnt lgkmcnt(4)
    v_mfma_f32_16x16x32_bf16 v[100:103], v[68:71], v[224:227], v[100:103]
    ds_read_b64_tr_b16 v[36:37], v11 offset:8192
    v_exp_f32 v55, v55
    v_add_f32 v52, 1.0, v52
    v_mfma_f32_16x16x32_bf16 v[100:103], v[32:35], v[232:235], v[100:103]
    ds_read_b64_tr_b16 v[38:39], v11 offset:8704
    v_add_f32 v53, 1.0, v53
    v_add_f32 v54, 1.0, v54
    v_mfma_f32_16x16x32_bf16 v[108:111], v[68:71], v[228:231], v[108:111]
    ds_read_b64_tr_b16 v[64:65], v11 offset:12288
    v_add_f32 v55, 1.0, v55
    v_rcp_f32 v52, v52
    v_mfma_f32_16x16x32_bf16 v[108:111], v[32:35], v[236:239], v[108:111]
    ds_read_b64_tr_b16 v[66:67], v11 offset:12800
    v_rcp_f32 v53, v53
    s_waitcnt lgkmcnt(4)
    v_mfma_f32_16x16x32_bf16 v[96:99], v[72:75], v[240:243], v[96:99]
    s_barrier
    ds_read_b64_tr_b16 v[68:69], v8 offset:16384
    v_rcp_f32 v54, v54
    v_mfma_f32_16x16x32_bf16 v[96:99], v[76:79], v[248:251], v[96:99]
    ds_read_b64_tr_b16 v[70:71], v8 offset:16896
    v_rcp_f32 v55, v55
    v_mul_f32 v92, v92, v52
    v_mfma_f32_16x16x32_bf16 v[104:107], v[72:75], v[244:247], v[104:107]
    ds_read_b64_tr_b16 v[32:33], v8 offset:20480
    v_mul_f32 v93, v93, v53
    v_mul_f32 v94, v94, v54
    v_mul_f32 v95, v95, v55
    v_mfma_f32_16x16x32_bf16 v[104:107], v[76:79], v[252:255], v[104:107]
    ds_read_b64_tr_b16 v[34:35], v8 offset:20992
    v_cvt_pk_bf16_f32 v62, v92, v93
    v_cvt_pk_bf16_f32 v63, v94, v95
    s_waitcnt lgkmcnt(4)
    v_mfma_f32_16x16x32_bf16 v[100:103], v[36:39], v[240:243], v[100:103]
    ds_read_b64_tr_b16 v[72:73], v11 offset:16384
    ds_read_b128 v[92:95], v24 offset:576
    ds_write_b128 v29, v[60:63] offset:25600
    v_mfma_f32_16x16x32_bf16 v[100:103], v[64:67], v[248:251], v[100:103]
    ds_read_b64_tr_b16 v[74:75], v11 offset:16896
    s_add_u32 s52, s82, 9216
    buffer_store_dwordx4 v[60:63], v28, s[32:35], s52 offen sc1
    v_mfma_f32_16x16x32_bf16 v[108:111], v[36:39], v[244:247], v[108:111]
    ds_read_b64_tr_b16 v[76:77], v11 offset:20480
    v_mfma_f32_16x16x32_bf16 v[108:111], v[64:67], v[252:255], v[108:111]
    ds_read_b64_tr_b16 v[78:79], v11 offset:20992
    s_waitcnt lgkmcnt(4)
    v_mfma_f32_16x16x32_bf16 v[80:83], v[68:71], v[112:115], v[80:83]
    ds_read_b64_tr_b16 v[36:37], v9 offset:0
    v_mfma_f32_16x16x32_bf16 v[80:83], v[32:35], v[120:123], v[80:83]
    ds_read_b64_tr_b16 v[38:39], v9 offset:512
    v_mfma_f32_16x16x32_bf16 v[88:91], v[68:71], v[116:119], v[88:91]
    ds_read_b64_tr_b16 v[64:65], v9 offset:4096
    v_mfma_f32_16x16x32_bf16 v[88:91], v[32:35], v[124:127], v[88:91]
    ds_read_b64_tr_b16 v[66:67], v9 offset:4608
    s_waitcnt lgkmcnt(4)
    v_mfma_f32_16x16x32_bf16 v[84:87], v[72:75], v[112:115], v[84:87]
    ds_read_b64_tr_b16 v[68:69], v12 offset:0
    v_mul_f32 v48, v96, v96
    v_mul_f32 v49, v97, v97
    v_mfma_f32_16x16x32_bf16 v[84:87], v[76:79], v[120:123], v[84:87]
    ds_read_b64_tr_b16 v[70:71], v12 offset:512
    v_mul_f32 v50, v98, v98
    v_mul_f32 v51, v99, v99
    v_fma_f32 v48, v48, s53, v23
    v_mfma_f32_16x16x32_bf16 v[92:95], v[72:75], v[116:119], v[92:95]
    ds_read_b64_tr_b16 v[32:33], v12 offset:4096
    v_fma_f32 v49, v49, s53, v23
    v_fma_f32 v50, v50, s53, v23
    v_mfma_f32_16x16x32_bf16 v[92:95], v[76:79], v[124:127], v[92:95]
    ds_read_b64_tr_b16 v[34:35], v12 offset:4608
    v_fma_f32 v51, v51, s53, v23
    v_mul_f32 v48, v96, v48
    v_mul_f32 v49, v97, v49
    s_waitcnt lgkmcnt(4)
    v_mfma_f32_16x16x32_bf16 v[80:83], v[36:39], v[128:131], v[80:83]
    s_barrier
    ds_read_b64_tr_b16 v[72:73], v8 offset:24576
    v_mul_f32 v50, v98, v50
    v_mul_f32 v51, v99, v51
    v_mfma_f32_16x16x32_bf16 v[80:83], v[64:67], v[136:139], v[80:83]
    ds_read_b64_tr_b16 v[74:75], v8 offset:25088
    v_exp_f32 v48, v48
    v_mfma_f32_16x16x32_bf16 v[88:91], v[36:39], v[132:135], v[88:91]
    ds_read_b64_tr_b16 v[76:77], v8 offset:28672
    v_exp_f32 v49, v49
    v_exp_f32 v50, v50
    v_mfma_f32_16x16x32_bf16 v[88:91], v[64:67], v[140:143], v[88:91]
    ds_read_b64_tr_b16 v[78:79], v8 offset:29184
    v_exp_f32 v51, v51
    s_waitcnt lgkmcnt(4)
    v_mfma_f32_16x16x32_bf16 v[84:87], v[68:71], v[128:131], v[84:87]
    ds_read_b64_tr_b16 v[36:37], v11 offset:24576
    v_add_f32 v48, 1.0, v48
    v_add_f32 v49, 1.0, v49
    v_mfma_f32_16x16x32_bf16 v[84:87], v[32:35], v[136:139], v[84:87]
    ds_read_b64_tr_b16 v[38:39], v11 offset:25088
    v_add_f32 v50, 1.0, v50
    v_add_f32 v51, 1.0, v51
    v_mfma_f32_16x16x32_bf16 v[92:95], v[68:71], v[132:135], v[92:95]
    ds_read_b64_tr_b16 v[64:65], v11 offset:28672
    v_rcp_f32 v48, v48
    v_rcp_f32 v49, v49
    v_mfma_f32_16x16x32_bf16 v[92:95], v[32:35], v[140:143], v[92:95]
    ds_read_b64_tr_b16 v[66:67], v11 offset:29184
    v_rcp_f32 v50, v50
    s_waitcnt lgkmcnt(4)
    v_mfma_f32_16x16x32_bf16 v[80:83], v[72:75], v[144:147], v[80:83]
    ds_read_b64_tr_b16 v[68:69], v8 offset:49152
    v_rcp_f32 v51, v51
    v_mfma_f32_16x16x32_bf16 v[80:83], v[76:79], v[152:155], v[80:83]
    ds_read_b64_tr_b16 v[70:71], v8 offset:49664
    v_mul_f32 v96, v96, v48
    v_mul_f32 v97, v97, v49
    v_mul_f32 v98, v98, v50
    v_mfma_f32_16x16x32_bf16 v[88:91], v[72:75], v[148:151], v[88:91]
    ds_read_b64_tr_b16 v[32:33], v8 offset:53248
    v_mul_f32 v99, v99, v51
    v_cvt_pk_bf16_f32 v56, v96, v97
    v_mfma_f32_16x16x32_bf16 v[88:91], v[76:79], v[156:159], v[88:91]
    ds_read_b64_tr_b16 v[34:35], v8 offset:53760
    v_cvt_pk_bf16_f32 v57, v98, v99
    ds_read_b128 v[96:99], v24 offset:768
    v_mul_f32 v52, v100, v100
    s_waitcnt lgkmcnt(5)
    v_mfma_f32_16x16x32_bf16 v[84:87], v[36:39], v[144:147], v[84:87]
    ds_read_b64_tr_b16 v[72:73], v11 offset:49152
    v_mul_f32 v53, v101, v101
    v_mul_f32 v54, v102, v102
    v_mfma_f32_16x16x32_bf16 v[84:87], v[64:67], v[152:155], v[84:87]
    ds_read_b64_tr_b16 v[74:75], v11 offset:49664
    v_mul_f32 v55, v103, v103
    v_fma_f32 v52, v52, s53, v23
    v_fma_f32 v53, v53, s53, v23
    v_mfma_f32_16x16x32_bf16 v[92:95], v[36:39], v[148:151], v[92:95]
    ds_read_b64_tr_b16 v[76:77], v11 offset:53248
    v_fma_f32 v54, v54, s53, v23
    v_fma_f32 v55, v55, s53, v23
    v_mfma_f32_16x16x32_bf16 v[92:95], v[64:67], v[156:159], v[92:95]
    ds_read_b64_tr_b16 v[78:79], v11 offset:53760
    v_mul_f32 v52, v100, v52
    v_mul_f32 v53, v101, v53
    v_mul_f32 v54, v102, v54
    s_waitcnt lgkmcnt(5)
    v_mfma_f32_16x16x32_bf16 v[80:83], v[68:71], v[160:163], v[80:83]
    s_barrier
    ds_read_b64_tr_b16 v[36:37], v8 offset:32768
    v_mul_f32 v55, v103, v55
    v_exp_f32 v52, v52
    v_mfma_f32_16x16x32_bf16 v[80:83], v[32:35], v[168:171], v[80:83]
    ds_read_b64_tr_b16 v[38:39], v8 offset:33280
    v_exp_f32 v53, v53
    v_mfma_f32_16x16x32_bf16 v[88:91], v[68:71], v[164:167], v[88:91]
    ds_read_b64_tr_b16 v[64:65], v8 offset:36864
    v_exp_f32 v54, v54
    v_mfma_f32_16x16x32_bf16 v[88:91], v[32:35], v[172:175], v[88:91]
    ds_read_b64_tr_b16 v[66:67], v8 offset:37376
    v_exp_f32 v55, v55
    v_add_f32 v52, 1.0, v52
    s_waitcnt lgkmcnt(4)
    v_mfma_f32_16x16x32_bf16 v[84:87], v[72:75], v[160:163], v[84:87]
    ds_read_b64_tr_b16 v[68:69], v11 offset:32768
    v_add_f32 v53, 1.0, v53
    v_add_f32 v54, 1.0, v54
    v_mfma_f32_16x16x32_bf16 v[84:87], v[76:79], v[168:171], v[84:87]
    ds_read_b64_tr_b16 v[70:71], v11 offset:33280
    v_add_f32 v55, 1.0, v55
    v_rcp_f32 v52, v52
    v_mfma_f32_16x16x32_bf16 v[92:95], v[72:75], v[164:167], v[92:95]
    ds_read_b64_tr_b16 v[32:33], v11 offset:36864
    v_rcp_f32 v53, v53
    v_mfma_f32_16x16x32_bf16 v[92:95], v[76:79], v[172:175], v[92:95]
    ds_read_b64_tr_b16 v[34:35], v11 offset:37376
    v_rcp_f32 v54, v54
    s_waitcnt lgkmcnt(4)
    v_mfma_f32_16x16x32_bf16 v[80:83], v[36:39], v[176:179], v[80:83]
    ds_read_b64_tr_b16 v[72:73], v9 offset:8192
    v_rcp_f32 v55, v55
    v_mul_f32 v100, v100, v52
    v_mfma_f32_16x16x32_bf16 v[80:83], v[64:67], v[184:187], v[80:83]
    ds_read_b64_tr_b16 v[74:75], v9 offset:8704
    v_mul_f32 v101, v101, v53
    v_mul_f32 v102, v102, v54
    v_mul_f32 v103, v103, v55
    v_mfma_f32_16x16x32_bf16 v[88:91], v[36:39], v[180:183], v[88:91]
    ds_read_b64_tr_b16 v[76:77], v9 offset:12288
    v_cvt_pk_bf16_f32 v58, v100, v101
    v_cvt_pk_bf16_f32 v59, v102, v103
    v_mfma_f32_16x16x32_bf16 v[88:91], v[64:67], v[188:191], v[88:91]
    ds_read_b64_tr_b16 v[78:79], v9 offset:12800
    ds_read_b128 v[100:103], v24 offset:832
    ds_write_b128 v29, v[56:59] offset:40960
    s_waitcnt lgkmcnt(6)
    v_mfma_f32_16x16x32_bf16 v[84:87], v[68:71], v[176:179], v[84:87]
    ds_read_b64_tr_b16 v[36:37], v12 offset:8192
    s_add_u32 s52, s82, 24576
    buffer_store_dwordx4 v[56:59], v28, s[32:35], s52 offen sc1
    v_mfma_f32_16x16x32_bf16 v[84:87], v[32:35], v[184:187], v[84:87]
    ds_read_b64_tr_b16 v[38:39], v12 offset:8704
    v_mul_f32 v48, v104, v104
    v_mul_f32 v49, v105, v105
    v_mfma_f32_16x16x32_bf16 v[92:95], v[68:71], v[180:183], v[92:95]
    ds_read_b64_tr_b16 v[64:65], v12 offset:12288
    v_mul_f32 v50, v106, v106
    v_mul_f32 v51, v107, v107
    v_fma_f32 v48, v48, s53, v23
    v_mfma_f32_16x16x32_bf16 v[92:95], v[32:35], v[188:191], v[92:95]
    ds_read_b64_tr_b16 v[66:67], v12 offset:12800
    v_fma_f32 v49, v49, s53, v23
    v_fma_f32 v50, v50, s53, v23
    s_waitcnt lgkmcnt(6)
    v_mfma_f32_16x16x32_bf16 v[80:83], v[72:75], v[192:195], v[80:83]
    s_barrier
    ds_read_b64_tr_b16 v[68:69], v8 offset:40960
    v_fma_f32 v51, v51, s53, v23
    v_mul_f32 v48, v104, v48
    v_mul_f32 v49, v105, v49
    v_mfma_f32_16x16x32_bf16 v[80:83], v[76:79], v[200:203], v[80:83]
    ds_read_b64_tr_b16 v[70:71], v8 offset:41472
    v_mul_f32 v50, v106, v50
    v_mul_f32 v51, v107, v51
    v_mfma_f32_16x16x32_bf16 v[88:91], v[72:75], v[196:199], v[88:91]
    ds_read_b64_tr_b16 v[32:33], v8 offset:45056
    v_exp_f32 v48, v48
    v_mfma_f32_16x16x32_bf16 v[88:91], v[76:79], v[204:207], v[88:91]
    ds_read_b64_tr_b16 v[34:35], v8 offset:45568
    v_exp_f32 v49, v49
    v_exp_f32 v50, v50
    s_waitcnt lgkmcnt(4)
    v_mfma_f32_16x16x32_bf16 v[84:87], v[36:39], v[192:195], v[84:87]
    ds_read_b64_tr_b16 v[72:73], v11 offset:40960
    v_exp_f32 v51, v51
    v_mfma_f32_16x16x32_bf16 v[84:87], v[64:67], v[200:203], v[84:87]
    ds_read_b64_tr_b16 v[74:75], v11 offset:41472
    v_add_f32 v48, 1.0, v48
    v_add_f32 v49, 1.0, v49
    v_mfma_f32_16x16x32_bf16 v[92:95], v[36:39], v[196:199], v[92:95]
    ds_read_b64_tr_b16 v[76:77], v11 offset:45056
    v_add_f32 v50, 1.0, v50
    v_add_f32 v51, 1.0, v51
    v_mfma_f32_16x16x32_bf16 v[92:95], v[64:67], v[204:207], v[92:95]
    ds_read_b64_tr_b16 v[78:79], v11 offset:45568
    v_rcp_f32 v48, v48
    v_rcp_f32 v49, v49
    s_waitcnt lgkmcnt(4)
    v_mfma_f32_16x16x32_bf16 v[80:83], v[68:71], v[208:211], v[80:83]
    ds_read_b64_tr_b16 v[36:37], v9 offset:49152
    v_rcp_f32 v50, v50
    v_mfma_f32_16x16x32_bf16 v[80:83], v[32:35], v[216:219], v[80:83]
    ds_read_b64_tr_b16 v[38:39], v9 offset:49664
    v_rcp_f32 v51, v51
    v_mfma_f32_16x16x32_bf16 v[88:91], v[68:71], v[212:215], v[88:91]
    ds_read_b64_tr_b16 v[64:65], v9 offset:53248
    v_mul_f32 v104, v104, v48
    v_mul_f32 v105, v105, v49
    v_mul_f32 v106, v106, v50
    v_mfma_f32_16x16x32_bf16 v[88:91], v[32:35], v[220:223], v[88:91]
    ds_read_b64_tr_b16 v[66:67], v9 offset:53760
    v_mul_f32 v107, v107, v51
    v_cvt_pk_bf16_f32 v60, v104, v105
    s_waitcnt lgkmcnt(4)
    v_mfma_f32_16x16x32_bf16 v[84:87], v[72:75], v[208:211], v[84:87]
    ds_read_b64_tr_b16 v[68:69], v12 offset:49152
    v_cvt_pk_bf16_f32 v61, v106, v107
    ds_read_b128 v[104:107], v24 offset:768
    v_mul_f32 v52, v108, v108
    v_mfma_f32_16x16x32_bf16 v[84:87], v[76:79], v[216:219], v[84:87]
    ds_read_b64_tr_b16 v[70:71], v12 offset:49664
    v_mul_f32 v53, v109, v109
    v_mul_f32 v54, v110, v110
    v_mfma_f32_16x16x32_bf16 v[92:95], v[72:75], v[212:215], v[92:95]
    ds_read_b64_tr_b16 v[32:33], v12 offset:53248
    v_mul_f32 v55, v111, v111
    v_fma_f32 v52, v52, s53, v23
    v_fma_f32 v53, v53, s53, v23
    v_mfma_f32_16x16x32_bf16 v[92:95], v[76:79], v[220:223], v[92:95]
    ds_read_b64_tr_b16 v[34:35], v12 offset:53760
    v_fma_f32 v54, v54, s53, v23
    v_fma_f32 v55, v55, s53, v23
    s_waitcnt lgkmcnt(5)
    v_mfma_f32_16x16x32_bf16 v[80:83], v[36:39], v[224:227], v[80:83]
    s_barrier
    ds_read_b64_tr_b16 v[72:73], v8 offset:0
    v_mul_f32 v52, v108, v52
    v_mul_f32 v53, v109, v53
    v_mul_f32 v54, v110, v54
    v_mfma_f32_16x16x32_bf16 v[80:83], v[64:67], v[232:235], v[80:83]
    ds_read_b64_tr_b16 v[74:75], v8 offset:512
    v_mul_f32 v55, v111, v55
    v_exp_f32 v52, v52
    v_mfma_f32_16x16x32_bf16 v[88:91], v[36:39], v[228:231], v[88:91]
    ds_read_b64_tr_b16 v[76:77], v8 offset:4096
    v_exp_f32 v53, v53
    v_mfma_f32_16x16x32_bf16 v[88:91], v[64:67], v[236:239], v[88:91]
    ds_read_b64_tr_b16 v[78:79], v8 offset:4608
    v_exp_f32 v54, v54
    s_waitcnt lgkmcnt(4)
    v_mfma_f32_16x16x32_bf16 v[84:87], v[68:71], v[224:227], v[84:87]
    ds_read_b64_tr_b16 v[36:37], v11 offset:0
    v_exp_f32 v55, v55
    v_add_f32 v52, 1.0, v52
    v_mfma_f32_16x16x32_bf16 v[84:87], v[32:35], v[232:235], v[84:87]
    ds_read_b64_tr_b16 v[38:39], v11 offset:512
    v_add_f32 v53, 1.0, v53
    v_add_f32 v54, 1.0, v54
    v_mfma_f32_16x16x32_bf16 v[92:95], v[68:71], v[228:231], v[92:95]
    ds_read_b64_tr_b16 v[64:65], v11 offset:4096
    v_add_f32 v55, 1.0, v55
    v_rcp_f32 v52, v52
    v_mfma_f32_16x16x32_bf16 v[92:95], v[32:35], v[236:239], v[92:95]
    ds_read_b64_tr_b16 v[66:67], v11 offset:4608
    v_rcp_f32 v53, v53
    s_waitcnt lgkmcnt(4)
    v_mfma_f32_16x16x32_bf16 v[80:83], v[72:75], v[240:243], v[80:83]
    ds_read_b64_tr_b16 v[68:69], v8 offset:57344
    v_rcp_f32 v54, v54
    v_mfma_f32_16x16x32_bf16 v[80:83], v[76:79], v[248:251], v[80:83]
    ds_read_b64_tr_b16 v[70:71], v8 offset:57856
    v_rcp_f32 v55, v55
    v_mul_f32 v108, v108, v52
    v_mfma_f32_16x16x32_bf16 v[88:91], v[72:75], v[244:247], v[88:91]
    ds_read_b64_tr_b16 v[32:33], v8 offset:61440
    v_mul_f32 v109, v109, v53
    v_mul_f32 v110, v110, v54
    v_mul_f32 v111, v111, v55
    v_mfma_f32_16x16x32_bf16 v[88:91], v[76:79], v[252:255], v[88:91]
    ds_read_b64_tr_b16 v[34:35], v8 offset:61952
    v_cvt_pk_bf16_f32 v62, v108, v109
    v_cvt_pk_bf16_f32 v63, v110, v111
    s_waitcnt lgkmcnt(4)
    v_mfma_f32_16x16x32_bf16 v[84:87], v[36:39], v[240:243], v[84:87]
    ds_read_b64_tr_b16 v[72:73], v11 offset:57344
    ds_read_b128 v[108:111], v24 offset:832
    ds_write_b128 v29, v[60:63] offset:41984
    v_mfma_f32_16x16x32_bf16 v[84:87], v[64:67], v[248:251], v[84:87]
    ds_read_b64_tr_b16 v[74:75], v11 offset:57856
    s_add_u32 s52, s82, 25600
    buffer_store_dwordx4 v[60:63], v28, s[32:35], s52 offen sc1
    v_mfma_f32_16x16x32_bf16 v[92:95], v[36:39], v[244:247], v[92:95]
    ds_read_b64_tr_b16 v[76:77], v11 offset:61440
    v_mfma_f32_16x16x32_bf16 v[92:95], v[64:67], v[252:255], v[92:95]
    ds_read_b64_tr_b16 v[78:79], v11 offset:61952
    s_waitcnt lgkmcnt(4)
    v_mfma_f32_16x16x32_bf16 v[96:99], v[68:71], v[112:115], v[96:99]
    s_waitcnt lgkmcnt(3)
    s_barrier
    ds_read_b64_tr_b16 v[36:37], v8 offset:8192
    v_mfma_f32_16x16x32_bf16 v[96:99], v[32:35], v[120:123], v[96:99]
    ds_read_b64_tr_b16 v[38:39], v8 offset:8704
    v_mfma_f32_16x16x32_bf16 v[104:107], v[68:71], v[116:119], v[104:107]
    ds_read_b64_tr_b16 v[64:65], v8 offset:12288
    v_mfma_f32_16x16x32_bf16 v[104:107], v[32:35], v[124:127], v[104:107]
    ds_read_b64_tr_b16 v[66:67], v8 offset:12800
    s_waitcnt lgkmcnt(4)
    v_mfma_f32_16x16x32_bf16 v[100:103], v[72:75], v[112:115], v[100:103]
    ds_read_b64_tr_b16 v[68:69], v11 offset:8192
    v_mul_f32 v48, v80, v80
    v_mul_f32 v49, v81, v81
    v_mfma_f32_16x16x32_bf16 v[100:103], v[76:79], v[120:123], v[100:103]
    ds_read_b64_tr_b16 v[70:71], v11 offset:8704
    v_mul_f32 v50, v82, v82
    v_mul_f32 v51, v83, v83
    v_fma_f32 v48, v48, s53, v23
    v_mfma_f32_16x16x32_bf16 v[108:111], v[72:75], v[116:119], v[108:111]
    ds_read_b64_tr_b16 v[32:33], v11 offset:12288
    v_fma_f32 v49, v49, s53, v23
    v_fma_f32 v50, v50, s53, v23
    v_mfma_f32_16x16x32_bf16 v[108:111], v[76:79], v[124:127], v[108:111]
    ds_read_b64_tr_b16 v[34:35], v11 offset:12800
    v_fma_f32 v51, v51, s53, v23
    v_mul_f32 v48, v80, v48
    v_mul_f32 v49, v81, v49
    s_waitcnt lgkmcnt(4)
    v_mfma_f32_16x16x32_bf16 v[96:99], v[36:39], v[128:131], v[96:99]
    ds_read_b64_tr_b16 v[72:73], v8 offset:16384
    v_mul_f32 v50, v82, v50
    v_mul_f32 v51, v83, v51
    v_mfma_f32_16x16x32_bf16 v[96:99], v[64:67], v[136:139], v[96:99]
    ds_read_b64_tr_b16 v[74:75], v8 offset:16896
    v_exp_f32 v48, v48
    v_mfma_f32_16x16x32_bf16 v[104:107], v[36:39], v[132:135], v[104:107]
    ds_read_b64_tr_b16 v[76:77], v8 offset:20480
    v_exp_f32 v49, v49
    v_exp_f32 v50, v50
    v_mfma_f32_16x16x32_bf16 v[104:107], v[64:67], v[140:143], v[104:107]
    ds_read_b64_tr_b16 v[78:79], v8 offset:20992
    v_exp_f32 v51, v51
    s_waitcnt lgkmcnt(4)
    v_mfma_f32_16x16x32_bf16 v[100:103], v[68:71], v[128:131], v[100:103]
    ds_read_b64_tr_b16 v[36:37], v11 offset:16384
    v_add_f32 v48, 1.0, v48
    v_add_f32 v49, 1.0, v49
    v_mfma_f32_16x16x32_bf16 v[100:103], v[32:35], v[136:139], v[100:103]
    ds_read_b64_tr_b16 v[38:39], v11 offset:16896
    v_add_f32 v50, 1.0, v50
    v_add_f32 v51, 1.0, v51
    v_mfma_f32_16x16x32_bf16 v[108:111], v[68:71], v[132:135], v[108:111]
    ds_read_b64_tr_b16 v[64:65], v11 offset:20480
    v_rcp_f32 v48, v48
    v_rcp_f32 v49, v49
    v_mfma_f32_16x16x32_bf16 v[108:111], v[32:35], v[140:143], v[108:111]
    ds_read_b64_tr_b16 v[66:67], v11 offset:20992
    v_rcp_f32 v50, v50
    s_waitcnt lgkmcnt(4)
    v_mfma_f32_16x16x32_bf16 v[96:99], v[72:75], v[144:147], v[96:99]
    s_barrier
    ds_read_b64_tr_b16 v[68:69], v8 offset:24576
    v_rcp_f32 v51, v51
    v_mfma_f32_16x16x32_bf16 v[96:99], v[76:79], v[152:155], v[96:99]
    ds_read_b64_tr_b16 v[70:71], v8 offset:25088
    v_mul_f32 v80, v80, v48
    v_mul_f32 v81, v81, v49
    v_mfma_f32_16x16x32_bf16 v[104:107], v[72:75], v[148:151], v[104:107]
    ds_read_b64_tr_b16 v[32:33], v8 offset:28672
    v_mul_f32 v82, v82, v50
    v_mul_f32 v83, v83, v51
    v_cvt_pk_bf16_f32 v56, v80, v81
    v_mfma_f32_16x16x32_bf16 v[104:107], v[76:79], v[156:159], v[104:107]
    ds_read_b64_tr_b16 v[34:35], v8 offset:29184
    v_cvt_pk_bf16_f32 v57, v82, v83
    ds_read_b128 v[80:83], v31 offset:0
    s_waitcnt lgkmcnt(5)
    v_mfma_f32_16x16x32_bf16 v[100:103], v[36:39], v[144:147], v[100:103]
    ds_read_b64_tr_b16 v[72:73], v11 offset:24576
    v_mul_f32 v52, v84, v84
    v_mul_f32 v53, v85, v85
    v_mul_f32 v54, v86, v86
    v_mfma_f32_16x16x32_bf16 v[100:103], v[64:67], v[152:155], v[100:103]
    ds_read_b64_tr_b16 v[74:75], v11 offset:25088
    v_mul_f32 v55, v87, v87
    v_fma_f32 v52, v52, s53, v23
    v_mfma_f32_16x16x32_bf16 v[108:111], v[36:39], v[148:151], v[108:111]
    ds_read_b64_tr_b16 v[76:77], v11 offset:28672
    v_fma_f32 v53, v53, s53, v23
    v_fma_f32 v54, v54, s53, v23
    v_fma_f32 v55, v55, s53, v23
    v_mfma_f32_16x16x32_bf16 v[108:111], v[64:67], v[156:159], v[108:111]
    ds_read_b64_tr_b16 v[78:79], v11 offset:29184
    v_mul_f32 v52, v84, v52
    v_mul_f32 v53, v85, v53
    s_waitcnt lgkmcnt(5)
    v_mfma_f32_16x16x32_bf16 v[96:99], v[68:71], v[160:163], v[96:99]
    ds_read_b64_tr_b16 v[36:37], v9 offset:0
    v_mul_f32 v54, v86, v54
    v_mul_f32 v55, v87, v55
    v_mfma_f32_16x16x32_bf16 v[96:99], v[32:35], v[168:171], v[96:99]
    ds_read_b64_tr_b16 v[38:39], v9 offset:512
    v_exp_f32 v52, v52
    v_exp_f32 v53, v53
    v_mfma_f32_16x16x32_bf16 v[104:107], v[68:71], v[164:167], v[104:107]
    ds_read_b64_tr_b16 v[64:65], v9 offset:4096
    v_exp_f32 v54, v54
    v_mfma_f32_16x16x32_bf16 v[104:107], v[32:35], v[172:175], v[104:107]
    ds_read_b64_tr_b16 v[66:67], v9 offset:4608
    v_exp_f32 v55, v55
    s_waitcnt lgkmcnt(4)
    v_mfma_f32_16x16x32_bf16 v[100:103], v[72:75], v[160:163], v[100:103]
    ds_read_b64_tr_b16 v[68:69], v12 offset:0
    v_add_f32 v52, 1.0, v52
    v_add_f32 v53, 1.0, v53
    v_mfma_f32_16x16x32_bf16 v[100:103], v[76:79], v[168:171], v[100:103]
    ds_read_b64_tr_b16 v[70:71], v12 offset:512
    v_add_f32 v54, 1.0, v54
    v_add_f32 v55, 1.0, v55
    v_mfma_f32_16x16x32_bf16 v[108:111], v[72:75], v[164:167], v[108:111]
    ds_read_b64_tr_b16 v[32:33], v12 offset:4096
    v_rcp_f32 v52, v52
    v_rcp_f32 v53, v53
    v_mfma_f32_16x16x32_bf16 v[108:111], v[76:79], v[172:175], v[108:111]
    ds_read_b64_tr_b16 v[34:35], v12 offset:4608
    v_rcp_f32 v54, v54
    s_waitcnt lgkmcnt(4)
    v_mfma_f32_16x16x32_bf16 v[96:99], v[36:39], v[176:179], v[96:99]
    s_barrier
    ds_read_b64_tr_b16 v[72:73], v8 offset:32768
    v_rcp_f32 v55, v55
    v_mfma_f32_16x16x32_bf16 v[96:99], v[64:67], v[184:187], v[96:99]
    ds_read_b64_tr_b16 v[74:75], v8 offset:33280
    v_mul_f32 v84, v84, v52
    v_mul_f32 v85, v85, v53
    v_mul_f32 v86, v86, v54
    v_mfma_f32_16x16x32_bf16 v[104:107], v[36:39], v[180:183], v[104:107]
    ds_read_b64_tr_b16 v[76:77], v8 offset:36864
    v_mul_f32 v87, v87, v55
    v_cvt_pk_bf16_f32 v58, v84, v85
    v_mfma_f32_16x16x32_bf16 v[104:107], v[64:67], v[188:191], v[104:107]
    ds_read_b64_tr_b16 v[78:79], v8 offset:37376
    v_cvt_pk_bf16_f32 v59, v86, v87
    ds_read_b128 v[84:87], v31 offset:0
    s_waitcnt lgkmcnt(5)
    v_mfma_f32_16x16x32_bf16 v[100:103], v[68:71], v[176:179], v[100:103]
    ds_read_b64_tr_b16 v[36:37], v11 offset:32768
    ds_write_b128 v29, v[56:59] offset:57344
    s_add_u32 s52, s82, 40960
    buffer_store_dwordx4 v[56:59], v28, s[32:35], s52 offen sc1
    v_mfma_f32_16x16x32_bf16 v[100:103], v[32:35], v[184:187], v[100:103]
    ds_read_b64_tr_b16 v[38:39], v11 offset:33280
    v_mul_f32 v48, v88, v88
    v_mfma_f32_16x16x32_bf16 v[108:111], v[68:71], v[180:183], v[108:111]
    ds_read_b64_tr_b16 v[64:65], v11 offset:36864
    v_mul_f32 v49, v89, v89
    v_mul_f32 v50, v90, v90
    v_mul_f32 v51, v91, v91
    v_mfma_f32_16x16x32_bf16 v[108:111], v[32:35], v[188:191], v[108:111]
    ds_read_b64_tr_b16 v[66:67], v11 offset:37376
    v_fma_f32 v48, v48, s53, v23
    v_fma_f32 v49, v49, s53, v23
    s_waitcnt lgkmcnt(6)
    v_mfma_f32_16x16x32_bf16 v[96:99], v[72:75], v[192:195], v[96:99]
    ds_read_b64_tr_b16 v[68:69], v8 offset:49152
    v_fma_f32 v50, v50, s53, v23
    v_fma_f32 v51, v51, s53, v23
    v_mul_f32 v48, v88, v48
    v_mfma_f32_16x16x32_bf16 v[96:99], v[76:79], v[200:203], v[96:99]
    ds_read_b64_tr_b16 v[70:71], v8 offset:49664
    v_mul_f32 v49, v89, v49
    v_mul_f32 v50, v90, v50
    v_mfma_f32_16x16x32_bf16 v[104:107], v[72:75], v[196:199], v[104:107]
    ds_read_b64_tr_b16 v[32:33], v8 offset:53248
    v_mul_f32 v51, v91, v51
    v_exp_f32 v48, v48
    s_lshl_b32 s96, s42, 2
    buffer_load_dword v46, v3, s[36:39], s96 offen sc1
    v_mfma_f32_16x16x32_bf16 v[104:107], v[76:79], v[204:207], v[104:107]
    ds_read_b64_tr_b16 v[34:35], v8 offset:53760
    v_exp_f32 v49, v49
    s_waitcnt lgkmcnt(4)
    v_mfma_f32_16x16x32_bf16 v[100:103], v[36:39], v[192:195], v[100:103]
    ds_read_b64_tr_b16 v[72:73], v11 offset:49152
    v_exp_f32 v50, v50
    v_mfma_f32_16x16x32_bf16 v[100:103], v[64:67], v[200:203], v[100:103]
    ds_read_b64_tr_b16 v[74:75], v11 offset:49664
    v_exp_f32 v51, v51
    v_add_f32 v48, 1.0, v48
    v_mfma_f32_16x16x32_bf16 v[108:111], v[36:39], v[196:199], v[108:111]
    ds_read_b64_tr_b16 v[76:77], v11 offset:53248
    v_add_f32 v49, 1.0, v49
    v_add_f32 v50, 1.0, v50
    v_add_f32 v51, 1.0, v51
    v_mfma_f32_16x16x32_bf16 v[108:111], v[64:67], v[204:207], v[108:111]
    ds_read_b64_tr_b16 v[78:79], v11 offset:53760
    v_rcp_f32 v48, v48
    s_waitcnt lgkmcnt(4)
    v_mfma_f32_16x16x32_bf16 v[96:99], v[68:71], v[208:211], v[96:99]
    s_barrier
    ds_read_b64_tr_b16 v[36:37], v8 offset:40960
    v_rcp_f32 v49, v49
    v_mfma_f32_16x16x32_bf16 v[96:99], v[32:35], v[216:219], v[96:99]
    ds_read_b64_tr_b16 v[38:39], v8 offset:41472
    v_rcp_f32 v50, v50
    v_mfma_f32_16x16x32_bf16 v[104:107], v[68:71], v[212:215], v[104:107]
    ds_read_b64_tr_b16 v[64:65], v8 offset:45056
    v_rcp_f32 v51, v51
    v_mul_f32 v88, v88, v48
    v_mfma_f32_16x16x32_bf16 v[104:107], v[32:35], v[220:223], v[104:107]
    ds_read_b64_tr_b16 v[66:67], v8 offset:45568
    v_mul_f32 v89, v89, v49
    v_mul_f32 v90, v90, v50
    v_mul_f32 v91, v91, v51
    s_waitcnt lgkmcnt(4)
    v_mfma_f32_16x16x32_bf16 v[100:103], v[72:75], v[208:211], v[100:103]
    ds_read_b64_tr_b16 v[68:69], v11 offset:40960
    v_cvt_pk_bf16_f32 v60, v88, v89
    v_cvt_pk_bf16_f32 v61, v90, v91
    v_mfma_f32_16x16x32_bf16 v[100:103], v[76:79], v[216:219], v[100:103]
    ds_read_b64_tr_b16 v[70:71], v11 offset:41472
    v_mul_f32 v52, v92, v92
    v_mul_f32 v53, v93, v93
    v_mul_f32 v54, v94, v94
    v_mfma_f32_16x16x32_bf16 v[108:111], v[72:75], v[212:215], v[108:111]
    ds_read_b64_tr_b16 v[32:33], v11 offset:45056
    v_mul_f32 v55, v95, v95
    v_fma_f32 v52, v52, s53, v23
    v_mfma_f32_16x16x32_bf16 v[108:111], v[76:79], v[220:223], v[108:111]
    ds_read_b64_tr_b16 v[34:35], v11 offset:45568
    v_fma_f32 v53, v53, s53, v23
    v_fma_f32 v54, v54, s53, v23
    v_fma_f32 v55, v55, s53, v23
    s_waitcnt lgkmcnt(4)
    v_mfma_f32_16x16x32_bf16 v[96:99], v[36:39], v[224:227], v[96:99]
    ds_read_b64_tr_b16 v[72:73], v9 offset:8192
    v_mul_f32 v52, v92, v52
    v_mul_f32 v53, v93, v53
    v_mfma_f32_16x16x32_bf16 v[96:99], v[64:67], v[232:235], v[96:99]
    ds_read_b64_tr_b16 v[74:75], v9 offset:8704
    v_mul_f32 v54, v94, v54
    v_mul_f32 v55, v95, v55
    v_mfma_f32_16x16x32_bf16 v[104:107], v[36:39], v[228:231], v[104:107]
    ds_read_b64_tr_b16 v[76:77], v9 offset:12288
    v_exp_f32 v52, v52
    v_exp_f32 v53, v53
    v_mfma_f32_16x16x32_bf16 v[104:107], v[64:67], v[236:239], v[104:107]
    ds_read_b64_tr_b16 v[78:79], v9 offset:12800
    v_exp_f32 v54, v54
    s_waitcnt lgkmcnt(4)
    v_mfma_f32_16x16x32_bf16 v[100:103], v[68:71], v[224:227], v[100:103]
    ds_read_b64_tr_b16 v[36:37], v12 offset:8192
    v_exp_f32 v55, v55
    v_mfma_f32_16x16x32_bf16 v[100:103], v[32:35], v[232:235], v[100:103]
    ds_read_b64_tr_b16 v[38:39], v12 offset:8704
    v_add_f32 v52, 1.0, v52
    v_add_f32 v53, 1.0, v53
    v_mfma_f32_16x16x32_bf16 v[108:111], v[68:71], v[228:231], v[108:111]
    ds_read_b64_tr_b16 v[64:65], v12 offset:12288
    v_add_f32 v54, 1.0, v54
    v_add_f32 v55, 1.0, v55
    v_mfma_f32_16x16x32_bf16 v[108:111], v[32:35], v[236:239], v[108:111]
    ds_read_b64_tr_b16 v[66:67], v12 offset:12800
    v_rcp_f32 v52, v52
    v_rcp_f32 v53, v53
    s_waitcnt lgkmcnt(4)
    v_mfma_f32_16x16x32_bf16 v[96:99], v[72:75], v[240:243], v[96:99]
    s_barrier
    ds_read_b64_tr_b16 v[68:69], v25 offset:0
    v_rcp_f32 v54, v54
    v_mfma_f32_16x16x32_bf16 v[96:99], v[76:79], v[248:251], v[96:99]
    ds_read_b64_tr_b16 v[70:71], v25 offset:256
    v_rcp_f32 v55, v55
    v_mfma_f32_16x16x32_bf16 v[104:107], v[72:75], v[244:247], v[104:107]
    ds_read_b64_tr_b16 v[32:33], v25 offset:2048
    v_mul_f32 v92, v92, v52
    v_mul_f32 v93, v93, v53
    v_mul_f32 v94, v94, v54
    v_mfma_f32_16x16x32_bf16 v[104:107], v[76:79], v[252:255], v[104:107]
    ds_read_b64_tr_b16 v[34:35], v25 offset:2304
    v_mul_f32 v95, v95, v55
    v_cvt_pk_bf16_f32 v62, v92, v93
    s_waitcnt lgkmcnt(4)
    v_mfma_f32_16x16x32_bf16 v[100:103], v[36:39], v[240:243], v[100:103]
    ds_read_b64_tr_b16 v[72:73], v25 offset:4096
    v_cvt_pk_bf16_f32 v63, v94, v95
    ds_write_b128 v29, v[60:63] offset:58368
    v_mfma_f32_16x16x32_bf16 v[100:103], v[64:67], v[248:251], v[100:103]
    ds_read_b64_tr_b16 v[74:75], v25 offset:4352
    s_add_u32 s52, s82, 41984
    buffer_store_dwordx4 v[60:63], v28, s[32:35], s52 offen sc1
    v_mfma_f32_16x16x32_bf16 v[108:111], v[36:39], v[244:247], v[108:111]
    ds_read_b64_tr_b16 v[76:77], v25 offset:6144
    v_mfma_f32_16x16x32_bf16 v[108:111], v[64:67], v[252:255], v[108:111]
    ds_read_b64_tr_b16 v[78:79], v25 offset:6400
    v_lshrrev_b32 v6, 2, v1
    v_and_b32 v7, 3, v1
    v_lshlrev_b32 v7, 3, v7
    v_lshl_add_u32 v6, v6, 6, v7
    v_bfe_u32 v7, v1, 4, 1
    v_xor_b32 v7, 1, v7
    v_lshl_add_u32 v8, v7, 5, v6
    v_add_u32 v9, 65536, v8
    v_add_u32 v10, 131072, v8
    s_waitcnt lgkmcnt(5)
    v_mfma_f32_16x16x32_bf16 v[80:83], v[68:71], v[112:115], v[80:83]
    s_waitcnt vmcnt(1)
    v_readfirstlane_b32 s97, v46
    s_nop 3
    s_cmp_lt_u32 s97, 1
    s_cbranch_scc1 L_slow_1_1
L_back_1_1:
    s_waitcnt lgkmcnt(3)
    s_barrier
    ds_read_b64_tr_b16 v[36:37], v27 offset:16384
    v_mfma_f32_16x16x32_bf16 v[80:83], v[32:35], v[120:123], v[80:83]
    ds_read_b64_tr_b16 v[38:39], v27 offset:16640
    v_mfma_f32_16x16x32_bf16 v[84:87], v[68:71], v[116:119], v[84:87]
    ds_read_b64_tr_b16 v[64:65], v27 offset:18432
    v_mfma_f32_16x16x32_bf16 v[84:87], v[32:35], v[124:127], v[84:87]
    ds_read_b64_tr_b16 v[66:67], v27 offset:18688
    s_waitcnt lgkmcnt(4)
    v_mfma_f32_16x16x32_bf16 v[80:83], v[72:75], v[128:131], v[80:83]
    ds_read_b64_tr_b16 v[68:69], v27 offset:20480
    v_mul_f32 v48, v96, v96
    v_mul_f32 v49, v97, v97
    v_mul_f32 v50, v98, v98
    v_mul_f32 v51, v99, v99
    v_fma_f32 v48, v48, s53, v23
    v_mfma_f32_16x16x32_bf16 v[80:83], v[76:79], v[136:139], v[80:83]
    ds_read_b64_tr_b16 v[70:71], v27 offset:20736
    v_fma_f32 v49, v49, s53, v23
    v_fma_f32 v50, v50, s53, v23
    v_fma_f32 v51, v51, s53, v23
    v_mul_f32 v48, v96, v48
    v_mul_f32 v49, v97, v49
    v_mfma_f32_16x16x32_bf16 v[84:87], v[72:75], v[132:135], v[84:87]
    ds_read_b64_tr_b16 v[32:33], v27 offset:22528
    v_mul_f32 v50, v98, v50
    v_mul_f32 v51, v99, v51
    v_exp_f32 v48, v48
    v_exp_f32 v49, v49
    v_mfma_f32_16x16x32_bf16 v[84:87], v[76:79], v[140:143], v[84:87]
    ds_read_b64_tr_b16 v[34:35], v27 offset:22784
    v_exp_f32 v50, v50
    v_exp_f32 v51, v51
    s_waitcnt lgkmcnt(4)
    v_mfma_f32_16x16x32_bf16 v[80:83], v[36:39], v[144:147], v[80:83]
    s_barrier
    ds_read_b64_tr_b16 v[72:73], v25 offset:8192
    v_add_f32 v48, 1.0, v48
    v_add_f32 v49, 1.0, v49
    v_add_f32 v50, 1.0, v50
    v_add_f32 v51, 1.0, v51
    v_rcp_f32 v48, v48
    v_mfma_f32_16x16x32_bf16 v[80:83], v[64:67], v[152:155], v[80:83]
    ds_read_b64_tr_b16 v[74:75], v25 offset:8448
    v_rcp_f32 v49, v49
    v_rcp_f32 v50, v50
    ds_read_b128 v[112:115], v29 offset:16384
    v_mfma_f32_16x16x32_bf16 v[84:87], v[36:39], v[148:151], v[84:87]
    ds_read_b64_tr_b16 v[76:77], v25 offset:10240
    v_rcp_f32 v51, v51
    v_mul_f32 v96, v96, v48
    v_mul_f32 v97, v97, v49
    v_mul_f32 v98, v98, v50
    v_mfma_f32_16x16x32_bf16 v[84:87], v[64:67], v[156:159], v[84:87]
    ds_read_b64_tr_b16 v[78:79], v25 offset:10496
    v_mul_f32 v99, v99, v51
    v_cvt_pk_bf16_f32 v56, v96, v97
    v_cvt_pk_bf16_f32 v57, v98, v99
    v_mul_f32 v52, v100, v100
    v_mul_f32 v53, v101, v101
    ds_read_b128 v[116:119], v29 offset:17408
    s_waitcnt lgkmcnt(6)
    v_mfma_f32_16x16x32_bf16 v[80:83], v[68:71], v[160:163], v[80:83]
    ds_read_b64_tr_b16 v[36:37], v25 offset:12288
    v_mul_f32 v54, v102, v102
    v_mul_f32 v55, v103, v103
    v_fma_f32 v52, v52, s53, v23
    v_fma_f32 v53, v53, s53, v23
    v_fma_f32 v54, v54, s53, v23
    v_mfma_f32_16x16x32_bf16 v[80:83], v[32:35], v[168:171], v[80:83]
    ds_read_b64_tr_b16 v[38:39], v25 offset:12544
    v_fma_f32 v55, v55, s53, v23
    v_mul_f32 v52, v100, v52
    v_mul_f32 v53, v101, v53
    v_mul_f32 v54, v102, v54
    v_mul_f32 v55, v103, v55
    ds_read_b128 v[120:123], v29 offset:24576
    v_mfma_f32_16x16x32_bf16 v[84:87], v[68:71], v[164:167], v[84:87]
    ds_read_b64_tr_b16 v[64:65], v25 offset:14336
    v_exp_f32 v52, v52
    v_exp_f32 v53, v53
    v_exp_f32 v54, v54
    v_mfma_f32_16x16x32_bf16 v[84:87], v[32:35], v[172:175], v[84:87]
    ds_read_b64_tr_b16 v[66:67], v25 offset:14592
    v_exp_f32 v55, v55
    v_add_f32 v52, 1.0, v52
    v_add_f32 v53, 1.0, v53
    ds_read_b128 v[124:127], v29 offset:25600
    s_waitcnt lgkmcnt(7)
    v_mfma_f32_16x16x32_bf16 v[80:83], v[72:75], v[176:179], v[80:83]
    s_waitcnt vmcnt(0)
    s_barrier
    ds_read_b64_tr_b16 v[68:69], v25 offset:57344
    v_add_f32 v54, 1.0, v54
    v_add_f32 v55, 1.0, v55
    v_rcp_f32 v52, v52
    v_rcp_f32 v53, v53
    v_mfma_f32_16x16x32_bf16 v[80:83], v[76:79], v[184:187], v[80:83]
    ds_read_b64_tr_b16 v[70:71], v25 offset:57600
    v_rcp_f32 v54, v54
    v_rcp_f32 v55, v55
    ds_read_b128 v[128:131], v29 offset:32768
    buffer_atomic_add v4, v3, s[32:35], s85 offen
    v_mfma_f32_16x16x32_bf16 v[84:87], v[72:75], v[180:183], v[84:87]
    ds_read_b64_tr_b16 v[32:33], v25 offset:59392
    v_mul_f32 v100, v100, v52
    v_mul_f32 v101, v101, v53
    v_mul_f32 v102, v102, v54
    v_mul_f32 v103, v103, v55
    v_cvt_pk_bf16_f32 v58, v100, v101
    v_mfma_f32_16x16x32_bf16 v[84:87], v[76:79], v[188:191], v[84:87]
    ds_read_b64_tr_b16 v[34:35], v25 offset:59648
    v_cvt_pk_bf16_f32 v59, v102, v103
    ds_write_b128 v30, v[56:59] offset:8192
    s_add_u32 s52, s82, 57344
    buffer_store_dwordx4 v[56:59], v28, s[32:35], s52 offen sc1
    ds_read_b128 v[132:135], v29 offset:33792
    s_waitcnt lgkmcnt(8)
    v_mfma_f32_16x16x32_bf16 v[80:83], v[36:39], v[192:195], v[80:83]
    ds_read_b64_tr_b16 v[72:73], v25 offset:61440
    v_mul_f32 v48, v104, v104
    v_mul_f32 v49, v105, v105
    v_mul_f32 v50, v106, v106
    v_mul_f32 v51, v107, v107
    v_fma_f32 v48, v48, s53, v23
    v_mfma_f32_16x16x32_bf16 v[80:83], v[64:67], v[200:203], v[80:83]
    ds_read_b64_tr_b16 v[74:75], v25 offset:61696
    v_fma_f32 v49, v49, s53, v23
    v_fma_f32 v50, v50, s53, v23
    v_fma_f32 v51, v51, s53, v23
    v_mul_f32 v48, v104, v48
    v_mul_f32 v49, v105, v49
    ds_read_b128 v[136:139], v29 offset:40960
    v_mfma_f32_16x16x32_bf16 v[84:87], v[36:39], v[196:199], v[84:87]
    ds_read_b64_tr_b16 v[76:77], v25 offset:63488
    v_mul_f32 v50, v106, v50
    v_mul_f32 v51, v107, v51
    v_exp_f32 v48, v48
    v_exp_f32 v49, v49
    v_mfma_f32_16x16x32_bf16 v[84:87], v[64:67], v[204:207], v[84:87]
    ds_read_b64_tr_b16 v[78:79], v25 offset:63744
    v_exp_f32 v50, v50
    v_exp_f32 v51, v51
    ds_read_b128 v[140:143], v29 offset:41984
    s_waitcnt lgkmcnt(8)
    v_mfma_f32_16x16x32_bf16 v[80:83], v[68:71], v[208:211], v[80:83]
    s_barrier
    ds_read_b64_tr_b16 v[36:37], v25 offset:20480
    v_add_f32 v48, 1.0, v48
    v_add_f32 v49, 1.0, v49
    v_add_f32 v50, 1.0, v50
    v_add_f32 v51, 1.0, v51
    v_rcp_f32 v48, v48
    v_mfma_f32_16x16x32_bf16 v[80:83], v[32:35], v[216:219], v[80:83]
    ds_read_b64_tr_b16 v[38:39], v25 offset:20736
    v_rcp_f32 v49, v49
    v_rcp_f32 v50, v50
    ds_read_b128 v[144:147], v29 offset:49152
    v_mfma_f32_16x16x32_bf16 v[84:87], v[68:71], v[212:215], v[84:87]
    ds_read_b64_tr_b16 v[64:65], v25 offset:22528
    v_rcp_f32 v51, v51
    v_mul_f32 v104, v104, v48
    v_mul_f32 v105, v105, v49
    v_mul_f32 v106, v106, v50
    v_mfma_f32_16x16x32_bf16 v[84:87], v[32:35], v[220:223], v[84:87]
    ds_read_b64_tr_b16 v[66:67], v25 offset:22784
    v_mul_f32 v107, v107, v51
    v_cvt_pk_bf16_f32 v60, v104, v105
    v_cvt_pk_bf16_f32 v61, v106, v107
    v_mul_f32 v52, v108, v108
    v_mul_f32 v53, v109, v109
    ds_read_b128 v[148:151], v29 offset:50176
    s_waitcnt lgkmcnt(7)
    v_mfma_f32_16x16x32_bf16 v[80:83], v[72:75], v[224:227], v[80:83]
    v_mul_f32 v54, v110, v110
    v_mul_f32 v55, v111, v111
    v_fma_f32 v52, v52, s53, v23
    v_fma_f32 v53, v53, s53, v23
    v_fma_f32 v54, v54, s53, v23
    v_mfma_f32_16x16x32_bf16 v[80:83], v[76:79], v[232:235], v[80:83]
    v_fma_f32 v55, v55, s53, v23
    v_mul_f32 v52, v108, v52
    v_mul_f32 v53, v109, v53
    v_mul_f32 v54, v110, v54
    v_mul_f32 v55, v111, v55
    ds_read_b128 v[152:155], v29 offset:57344
    v_mfma_f32_16x16x32_bf16 v[84:87], v[72:75], v[228:231], v[84:87]
    v_exp_f32 v52, v52
    v_exp_f32 v53, v53
    v_exp_f32 v54, v54
    v_mfma_f32_16x16x32_bf16 v[84:87], v[76:79], v[236:239], v[84:87]
    v_exp_f32 v55, v55
    v_add_f32 v52, 1.0, v52
    v_add_f32 v53, 1.0, v53
    ds_read_b128 v[156:159], v29 offset:58368
    s_waitcnt lgkmcnt(3)
    v_mfma_f32_16x16x32_bf16 v[80:83], v[36:39], v[240:243], v[80:83]
    s_barrier
    ds_read_b64_tr_b16 v[68:69], v14 offset:24576
    ds_read_b64_tr_b16 v[70:71], v14 offset:26624
    v_add_f32 v54, 1.0, v54
    v_add_f32 v55, 1.0, v55
    v_rcp_f32 v52, v52
    v_rcp_f32 v53, v53
    v_mfma_f32_16x16x32_bf16 v[80:83], v[64:67], v[248:251], v[80:83]
    ds_read_b64_tr_b16 v[32:33], v14 offset:28672
    ds_read_b64_tr_b16 v[34:35], v14 offset:30720
    v_rcp_f32 v54, v54
    v_rcp_f32 v55, v55
    v_mfma_f32_16x16x32_bf16 v[84:87], v[36:39], v[244:247], v[84:87]
    ds_read_b64_tr_b16 v[72:73], v17 offset:24576
    ds_read_b64_tr_b16 v[74:75], v17 offset:26624
    v_mul_f32 v108, v108, v52
    v_mul_f32 v109, v109, v53
    v_mul_f32 v110, v110, v54
    v_mul_f32 v111, v111, v55
    v_cvt_pk_bf16_f32 v62, v108, v109
    buffer_load_dword v46, v3, s[32:35], s86 offen sc1
    v_mfma_f32_16x16x32_bf16 v[84:87], v[64:67], v[252:255], v[84:87]
    ds_read_b64_tr_b16 v[76:77], v17 offset:28672
    ds_read_b64_tr_b16 v[78:79], v17 offset:30720
    v_cvt_pk_bf16_f32 v63, v110, v111
    ds_write_b128 v30, v[60:63] offset:9216
    s_add_u32 s52, s82, 58368
    buffer_store_dwordx4 v[60:63], v28, s[32:35], s52 offen sc1
    s_waitcnt lgkmcnt(5)
    v_mfma_f32_16x16x32_bf16 v[96:99], v[68:71], v[112:115], 0
    s_barrier
    ds_read_b64_tr_b16 v[64:65], v14 offset:32768
    v_mfma_f32_16x16x32_bf16 v[96:99], v[32:35], v[120:123], v[96:99]
    ds_read_b64_tr_b16 v[66:67], v14 offset:34816
    v_mul_f32 v48, v80, v80
    v_mul_f32 v49, v81, v81
    v_mul_f32 v50, v82, v82
    v_mfma_f32_16x16x32_bf16 v[100:103], v[68:71], v[116:119], 0
    ds_read_b64_tr_b16 v[232:233], v14 offset:36864
    v_mul_f32 v51, v83, v83
    v_fma_f32 v48, v48, s53, v23
    v_fma_f32 v49, v49, s53, v23
    v_fma_f32 v50, v50, s53, v23
    v_mfma_f32_16x16x32_bf16 v[100:103], v[32:35], v[124:127], v[100:103]
    ds_read_b64_tr_b16 v[234:235], v14 offset:38912
    v_fma_f32 v51, v51, s53, v23
    v_mul_f32 v48, v80, v48
    v_mul_f32 v49, v81, v49
    s_waitcnt lgkmcnt(5)
    v_mfma_f32_16x16x32_bf16 v[104:107], v[72:75], v[112:115], 0
    ds_read_b64_tr_b16 v[236:237], v17 offset:32768
    v_mul_f32 v50, v82, v50
    v_mul_f32 v51, v83, v51
    v_exp_f32 v48, v48
    v_mfma_f32_16x16x32_bf16 v[104:107], v[76:79], v[120:123], v[104:107]
    ds_read_b64_tr_b16 v[238:239], v17 offset:34816
    v_exp_f32 v49, v49
    v_exp_f32 v50, v50
    v_mfma_f32_16x16x32_bf16 v[108:111], v[72:75], v[116:119], 0
    ds_read_b64_tr_b16 v[240:241], v17 offset:36864
    v_exp_f32 v51, v51
    v_add_f32 v48, 1.0, v48
    v_mfma_f32_16x16x32_bf16 v[108:111], v[76:79], v[124:127], v[108:111]
    ds_read_b64_tr_b16 v[242:243], v17 offset:38912
    v_add_f32 v49, 1.0, v49
    v_add_f32 v50, 1.0, v50
    v_add_f32 v51, 1.0, v51
    s_waitcnt lgkmcnt(4)
    v_mfma_f32_16x16x32_bf16 v[96:99], v[64:67], v[128:131], v[96:99]
    s_barrier
    ds_read_b64_tr_b16 v[244:245], v15 offset:0
    v_rcp_f32 v48, v48
    v_rcp_f32 v49, v49
    v_mfma_f32_16x16x32_bf16 v[96:99], v[232:235], v[136:139], v[96:99]
    ds_read_b64_tr_b16 v[246:247], v15 offset:2048
    v_rcp_f32 v50, v50
    v_rcp_f32 v51, v51
    ds_read_b128 v[160:163], v30 offset:0
    v_mfma_f32_16x16x32_bf16 v[100:103], v[64:67], v[132:135], v[100:103]
    ds_read_b64_tr_b16 v[68:69], v15 offset:4096
    v_mul_f32 v80, v80, v48
    v_mul_f32 v81, v81, v49
    v_mul_f32 v82, v82, v50
    v_mfma_f32_16x16x32_bf16 v[100:103], v[232:235], v[140:143], v[100:103]
    ds_read_b64_tr_b16 v[70:71], v15 offset:6144
    v_mul_f32 v83, v83, v51
    v_cvt_pk_bf16_f32 v56, v80, v81
    v_cvt_pk_bf16_f32 v57, v82, v83
    ds_read_b128 v[164:167], v30 offset:1024
    s_waitcnt lgkmcnt(6)
    v_mfma_f32_16x16x32_bf16 v[104:107], v[236:239], v[128:131], v[104:107]
    ds_read_b64_tr_b16 v[72:73], v18 offset:0
    v_mul_f32 v52, v84, v84
    v_mul_f32 v53, v85, v85
    v_mul_f32 v54, v86, v86
    v_mul_f32 v55, v87, v87
    v_mfma_f32_16x16x32_bf16 v[104:107], v[240:243], v[136:139], v[104:107]
    ds_read_b64_tr_b16 v[74:75], v18 offset:2048
    v_fma_f32 v52, v52, s53, v23
    v_fma_f32 v53, v53, s53, v23
    v_fma_f32 v54, v54, s53, v23
    ds_read_b128 v[168:171], v30 offset:8192
    v_mfma_f32_16x16x32_bf16 v[108:111], v[236:239], v[132:135], v[108:111]
    ds_read_b64_tr_b16 v[76:77], v18 offset:4096
    v_fma_f32 v55, v55, s53, v23
    v_mul_f32 v52, v84, v52
    v_mul_f32 v53, v85, v53
    v_mul_f32 v54, v86, v54
    v_mfma_f32_16x16x32_bf16 v[108:111], v[240:243], v[140:143], v[108:111]
    ds_read_b64_tr_b16 v[78:79], v18 offset:6144
    v_mul_f32 v55, v87, v55
    v_exp_f32 v52, v52
    ds_read_b128 v[172:175], v30 offset:9216
    s_waitcnt lgkmcnt(7)
    v_mfma_f32_16x16x32_bf16 v[96:99], v[244:247], v[144:147], v[96:99]
    s_waitcnt vmcnt(1)
    v_readfirstlane_b32 s97, v46
    s_nop 3
    s_cmp_lt_u32 s97, s88
    s_cbranch_scc1 L_slow_1_2
L_back_1_2:
    s_barrier
    ds_read_b64_tr_b16 v[64:65], v14 offset:40960
    v_exp_f32 v53, v53
    v_exp_f32 v54, v54
    v_mfma_f32_16x16x32_bf16 v[96:99], v[68:71], v[152:155], v[96:99]
    ds_read_b64_tr_b16 v[66:67], v14 offset:43008
    s_add_u32 m0, s50, 24576
    s_add_u32 s51, s83, 0
    buffer_load_dwordx4 v2, s[32:35], s51 offen sc1 lds
    v_exp_f32 v55, v55
    v_add_f32 v52, 1.0, v52
    v_mfma_f32_16x16x32_bf16 v[100:103], v[244:247], v[148:151], v[100:103]
    ds_read_b64_tr_b16 v[232:233], v14 offset:45056
    v_add_f32 v53, 1.0, v53
    v_add_f32 v54, 1.0, v54
    v_add_f32 v55, 1.0, v55
    v_mfma_f32_16x16x32_bf16 v[100:103], v[68:71], v[156:159], v[100:103]
    ds_read_b64_tr_b16 v[234:235], v14 offset:47104
    v_rcp_f32 v52, v52
    v_rcp_f32 v53, v53
    s_waitcnt lgkmcnt(5)
    v_mfma_f32_16x16x32_bf16 v[104:107], v[72:75], v[144:147], v[104:107]
    ds_read_b64_tr_b16 v[236:237], v17 offset:40960
    v_rcp_f32 v54, v54
    v_rcp_f32 v55, v55
    v_mfma_f32_16x16x32_bf16 v[104:107], v[76:79], v[152:155], v[104:107]
    ds_read_b64_tr_b16 v[238:239], v17 offset:43008
    buffer_load_dwordx4 v2, s[32:35], s51 offen offset:1024 sc1 lds
    v_mul_f32 v84, v84, v52
    v_mul_f32 v85, v85, v53
    v_mul_f32 v86, v86, v54
    v_mfma_f32_16x16x32_bf16 v[108:111], v[72:75], v[148:151], v[108:111]
    ds_read_b64_tr_b16 v[240:241], v17 offset:45056
    v_mul_f32 v87, v87, v55
    v_cvt_pk_bf16_f32 v58, v84, v85
    v_cvt_pk_bf16_f32 v59, v86, v87
    s_nop 0
    v_permlane16_swap_b32 v56, v58
    v_mfma_f32_16x16x32_bf16 v[108:111], v[76:79], v[156:159], v[108:111]
    ds_read_b64_tr_b16 v[242:243], v17 offset:47104
    v_permlane16_swap_b32 v57, v59
    ds_write_b128 v22, v[56:59] offset:0
    s_sub_u32 s52, s82, 81920
    buffer_store_dwordx4 v[56:59], v22, s[32:35], s52 offen sc1
    s_waitcnt lgkmcnt(5)
    v_mfma_f32_16x16x32_bf16 v[96:99], v[64:67], v[160:163], v[96:99]
    s_barrier
    ds_read_b64_tr_b16 v[244:245], v8 offset:49152
    v_mfma_f32_16x16x32_bf16 v[96:99], v[232:235], v[168:171], v[96:99]
    ds_read_b64_tr_b16 v[246:247], v8 offset:50176
    s_add_u32 m0, s50, 32768
    s_add_u32 s51, s83, 8192
    buffer_load_dwordx4 v2, s[32:35], s51 offen sc1 lds
    v_mfma_f32_16x16x32_bf16 v[100:103], v[64:67], v[164:167], v[100:103]
    ds_read_b64_tr_b16 v[68:69], v8 offset:51200
    v_mfma_f32_16x16x32_bf16 v[100:103], v[232:235], v[172:175], v[100:103]
    ds_read_b64_tr_b16 v[70:71], v8 offset:52224
    s_waitcnt lgkmcnt(5)
    v_mfma_f32_16x16x32_bf16 v[104:107], v[236:239], v[160:163], v[104:107]
    ds_read_b64_tr_b16 v[72:73], v8 offset:53248
    v_mfma_f32_16x16x32_bf16 v[104:107], v[240:243], v[168:171], v[104:107]
    ds_read_b64_tr_b16 v[74:75], v8 offset:54272
    buffer_load_dwordx4 v2, s[32:35], s51 offen offset:1024 sc1 lds
    v_mfma_f32_16x16x32_bf16 v[108:111], v[236:239], v[164:167], v[108:111]
    ds_read_b64_tr_b16 v[76:77], v8 offset:55296
    v_mfma_f32_16x16x32_bf16 v[108:111], v[240:243], v[172:175], v[108:111]
    ds_read_b64_tr_b16 v[78:79], v8 offset:56320
    s_waitcnt lgkmcnt(4)
    v_mfma_f32_16x16x32_bf16 v[32:35], v[244:247], v[112:115], 0
    s_waitcnt vmcnt(5)
    s_barrier
    ds_read_b64_tr_b16 v[64:65], v8 offset:0
    v_mfma_f32_16x16x32_bf16 v[32:35], v[68:71], v[120:123], v[32:35]
    ds_read_b64_tr_b16 v[66:67], v8 offset:1024
    buffer_atomic_add v4, v3, s[32:35], s85 offen offset:256
    v_mfma_f32_16x16x32_bf16 v[36:39], v[244:247], v[116:119], 0
    ds_read_b64_tr_b16 v[232:233], v8 offset:2048
    v_mfma_f32_16x16x32_bf16 v[36:39], v[68:71], v[124:127], v[36:39]
    ds_read_b64_tr_b16 v[234:235], v8 offset:3072
    s_waitcnt lgkmcnt(4)
    v_mfma_f32_16x16x32_bf16 v[32:35], v[72:75], v[128:131], v[32:35]
    ds_read_b64_tr_b16 v[236:237], v8 offset:4096
    v_mfma_f32_16x16x32_bf16 v[32:35], v[76:79], v[136:139], v[32:35]
    ds_read_b64_tr_b16 v[238:239], v8 offset:5120
    v_mfma_f32_16x16x32_bf16 v[36:39], v[72:75], v[132:135], v[36:39]
    ds_read_b64_tr_b16 v[240:241], v8 offset:6144
    v_mfma_f32_16x16x32_bf16 v[36:39], v[76:79], v[140:143], v[36:39]
    ds_read_b64_tr_b16 v[242:243], v8 offset:7168
    s_waitcnt lgkmcnt(4)
    v_mfma_f32_16x16x32_bf16 v[32:35], v[64:67], v[144:147], v[32:35]
    s_barrier
    ds_read_b64_tr_b16 v[244:245], v15 offset:8192
    v_mfma_f32_16x16x32_bf16 v[32:35], v[232:235], v[152:155], v[32:35]
    ds_read_b64_tr_b16 v[246:247], v15 offset:10240
    s_add_u32 m0, s50, 40960
    s_add_u32 s51, s83, 16384
    buffer_load_dwordx4 v2, s[32:35], s51 offen sc1 lds
    v_mfma_f32_16x16x32_bf16 v[36:39], v[64:67], v[148:151], v[36:39]
    ds_read_b64_tr_b16 v[68:69], v15 offset:12288
    v_mfma_f32_16x16x32_bf16 v[36:39], v[232:235], v[156:159], v[36:39]
    ds_read_b64_tr_b16 v[70:71], v15 offset:14336
    s_waitcnt lgkmcnt(4)
    v_mfma_f32_16x16x32_bf16 v[32:35], v[236:239], v[160:163], v[32:35]
    ds_read_b64_tr_b16 v[72:73], v18 offset:8192
    v_mfma_f32_16x16x32_bf16 v[32:35], v[240:243], v[168:171], v[32:35]
    ds_read_b64_tr_b16 v[74:75], v18 offset:10240
    buffer_load_dwordx4 v2, s[32:35], s51 offen offset:1024 sc1 lds
    v_mfma_f32_16x16x32_bf16 v[36:39], v[236:239], v[164:167], v[36:39]
    ds_read_b64_tr_b16 v[76:77], v18 offset:12288
    v_mfma_f32_16x16x32_bf16 v[36:39], v[240:243], v[172:175], v[36:39]
    ds_read_b64_tr_b16 v[78:79], v18 offset:14336
    s_waitcnt lgkmcnt(4)
    v_mfma_f32_16x16x32_bf16 v[80:83], v[244:247], v[112:115], 0
    s_barrier
    ds_read_b64_tr_b16 v[64:65], v14 offset:8192
    v_mfma_f32_16x16x32_bf16 v[80:83], v[68:71], v[120:123], v[80:83]
    ds_read_b64_tr_b16 v[66:67], v14 offset:10240
    s_add_u32 m0, s50, 0
    s_add_u32 s51, s83, 24576
    buffer_load_dwordx4 v2, s[32:35], s51 offen sc1 lds
    ds_read_b128 v[176:179], v30 offset:16384
    v_mfma_f32_16x16x32_bf16 v[84:87], v[244:247], v[116:119], 0
    ds_read_b64_tr_b16 v[232:233], v14 offset:12288
    v_mfma_f32_16x16x32_bf16 v[84:87], v[68:71], v[124:127], v[84:87]
    ds_read_b64_tr_b16 v[234:235], v14 offset:14336
    ds_read_b128 v[180:183], v30 offset:17408
    s_waitcnt lgkmcnt(6)
    v_mfma_f32_16x16x32_bf16 v[88:91], v[72:75], v[112:115], 0
    ds_read_b64_tr_b16 v[236:237], v17 offset:8192
    v_mfma_f32_16x16x32_bf16 v[88:91], v[76:79], v[120:123], v[88:91]
    ds_read_b64_tr_b16 v[238:239], v17 offset:10240
    buffer_load_dwordx4 v2, s[32:35], s51 offen offset:1024 sc1 lds
    v_mfma_f32_16x16x32_bf16 v[92:95], v[72:75], v[116:119], 0
    ds_read_b64_tr_b16 v[240:241], v17 offset:12288
    v_mfma_f32_16x16x32_bf16 v[92:95], v[76:79], v[124:127], v[92:95]
    ds_read_b64_tr_b16 v[242:243], v17 offset:14336
    s_waitcnt lgkmcnt(5)
    v_mfma_f32_16x16x32_bf16 v[80:83], v[64:67], v[128:131], v[80:83]
    s_barrier
    ds_read_b64_tr_b16 v[244:245], v15 offset:16384
    v_mfma_f32_16x16x32_bf16 v[80:83], v[232:235], v[136:139], v[80:83]
    ds_read_b64_tr_b16 v[246:247], v15 offset:18432
    v_mfma_f32_16x16x32_bf16 v[84:87], v[64:67], v[132:135], v[84:87]
    ds_read_b64_tr_b16 v[68:69], v15 offset:20480
    v_mfma_f32_16x16x32_bf16 v[84:87], v[232:235], v[140:143], v[84:87]
    ds_read_b64_tr_b16 v[70:71], v15 offset:22528
    s_waitcnt lgkmcnt(4)
    v_mfma_f32_16x16x32_bf16 v[88:91], v[236:239], v[128:131], v[88:91]
    ds_read_b64_tr_b16 v[72:73], v18 offset:16384
    v_mfma_f32_16x16x32_bf16 v[88:91], v[240:243], v[136:139], v[88:91]
    ds_read_b64_tr_b16 v[74:75], v18 offset:18432
    v_mfma_f32_16x16x32_bf16 v[92:95], v[236:239], v[132:135], v[92:95]
    ds_read_b64_tr_b16 v[76:77], v18 offset:20480
    v_mfma_f32_16x16x32_bf16 v[92:95], v[240:243], v[140:143], v[92:95]
    ds_read_b64_tr_b16 v[78:79], v18 offset:22528
    s_waitcnt lgkmcnt(4)
    v_mfma_f32_16x16x32_bf16 v[80:83], v[244:247], v[144:147], v[80:83]
    s_waitcnt vmcnt(5)
    s_barrier
    ds_read_b64_tr_b16 v[64:65], v14 offset:57344
    v_mfma_f32_16x16x32_bf16 v[80:83], v[68:71], v[152:155], v[80:83]
    ds_read_b64_tr_b16 v[66:67], v14 offset:59392
    s_add_u32 m0, s50, 8192
    s_add_u32 s51, s83, 32768
    buffer_load_dwordx4 v2, s[32:35], s51 offen sc1 lds
    ds_read_b128 v[192:195], v28 offset:32768
    buffer_atomic_add v4, v3, s[32:35], s85 offen offset:512
    v_mfma_f32_16x16x32_bf16 v[84:87], v[244:247], v[148:151], v[84:87]
    ds_read_b64_tr_b16 v[232:233], v14 offset:61440
    buffer_load_dword v46, v3, s[32:35], s86 offen offset:256 sc1
    v_mfma_f32_16x16x32_bf16 v[84:87], v[68:71], v[156:159], v[84:87]
    ds_read_b64_tr_b16 v[234:235], v14 offset:63488
    ds_read_b128 v[196:199], v28 offset:33792
    s_waitcnt lgkmcnt(6)
    v_mfma_f32_16x16x32_bf16 v[88:91], v[72:75], v[144:147], v[88:91]
    ds_read_b64_tr_b16 v[236:237], v17 offset:57344
    v_mfma_f32_16x16x32_bf16 v[88:91], v[76:79], v[152:155], v[88:91]
    ds_read_b64_tr_b16 v[238:239], v17 offset:59392
    buffer_load_dwordx4 v2, s[32:35], s51 offen offset:1024 sc1 lds
    ds_read_b128 v[184:187], v28 offset:24576
    v_mfma_f32_16x16x32_bf16 v[92:95], v[72:75], v[148:151], v[92:95]
    ds_read_b64_tr_b16 v[240:241], v17 offset:61440
    v_mfma_f32_16x16x32_bf16 v[92:95], v[76:79], v[156:159], v[92:95]
    ds_read_b64_tr_b16 v[242:243], v17 offset:63488
    ds_read_b128 v[188:191], v28 offset:25600
    s_waitcnt lgkmcnt(7)
    v_mfma_f32_16x16x32_bf16 v[80:83], v[64:67], v[160:163], v[80:83]
    s_barrier
    ds_read_b64_tr_b16 v[244:245], v15 offset:24576
    v_mfma_f32_16x16x32_bf16 v[80:83], v[232:235], v[168:171], v[80:83]
    ds_read_b64_tr_b16 v[246:247], v15 offset:26624
    s_add_u32 m0, s50, 73728
    s_add_u32 s51, s83, 40960
    buffer_load_dwordx4 v2, s[32:35], s51 offen sc1 lds
    v_mfma_f32_16x16x32_bf16 v[84:87], v[64:67], v[164:167], v[84:87]
    ds_read_b64_tr_b16 v[68:69], v15 offset:28672
    v_mfma_f32_16x16x32_bf16 v[84:87], v[232:235], v[172:175], v[84:87]
    ds_read_b64_tr_b16 v[70:71], v15 offset:30720
    s_waitcnt lgkmcnt(5)
    v_mfma_f32_16x16x32_bf16 v[88:91], v[236:239], v[160:163], v[88:91]
    ds_read_b64_tr_b16 v[72:73], v18 offset:24576
    v_mfma_f32_16x16x32_bf16 v[88:91], v[240:243], v[168:171], v[88:91]
    ds_read_b64_tr_b16 v[74:75], v18 offset:26624
    buffer_load_dwordx4 v2, s[32:35], s51 offen offset:1024 sc1 lds
    v_mfma_f32_16x16x32_bf16 v[92:95], v[236:239], v[164:167], v[92:95]
    ds_read_b64_tr_b16 v[76:77], v18 offset:28672
    v_mfma_f32_16x16x32_bf16 v[92:95], v[240:243], v[172:175], v[92:95]
    ds_read_b64_tr_b16 v[78:79], v18 offset:30720
    s_waitcnt lgkmcnt(4)
    v_mfma_f32_16x16x32_bf16 v[96:99], v[244:247], v[184:187], v[96:99]
    s_waitcnt vmcnt(6)
    s_barrier
    ds_read_b64_tr_b16 v[64:65], v14 offset:16384
    v_mfma_f32_16x16x32_bf16 v[96:99], v[68:71], v[192:195], v[96:99]
    ds_read_b64_tr_b16 v[66:67], v14 offset:18432
    ds_read_b128 v[208:211], v28 offset:0
    v_mfma_f32_16x16x32_bf16 v[100:103], v[244:247], v[188:191], v[100:103]
    ds_read_b64_tr_b16 v[232:233], v14 offset:20480
    v_mfma_f32_16x16x32_bf16 v[100:103], v[68:71], v[196:199], v[100:103]
    ds_read_b64_tr_b16 v[234:235], v14 offset:22528
    ds_read_b128 v[212:215], v28 offset:1024
    s_waitcnt lgkmcnt(6)
    v_mfma_f32_16x16x32_bf16 v[104:107], v[72:75], v[184:187], v[104:107]
    ds_read_b64_tr_b16 v[236:237], v17 offset:16384
    v_mfma_f32_16x16x32_bf16 v[104:107], v[76:79], v[192:195], v[104:107]
    ds_read_b64_tr_b16 v[238:239], v17 offset:18432
    ds_read_b128 v[200:203], v28 offset:40960
    v_mfma_f32_16x16x32_bf16 v[108:111], v[72:75], v[188:191], v[108:111]
    ds_read_b64_tr_b16 v[240:241], v17 offset:20480
    v_mfma_f32_16x16x32_bf16 v[108:111], v[76:79], v[196:199], v[108:111]
    ds_read_b64_tr_b16 v[242:243], v17 offset:22528
    ds_read_b128 v[204:207], v28 offset:41984
    s_waitcnt lgkmcnt(7)
    v_mfma_f32_16x16x32_bf16 v[80:83], v[64:67], v[184:187], v[80:83]
    s_waitcnt vmcnt(3)
    v_readfirstlane_b32 s97, v46
    s_nop 3
    s_cmp_lt_u32 s97, s88
    s_cbranch_scc1 L_slow_1_3
L_back_1_3:
    s_barrier
    ds_read_b64_tr_b16 v[244:245], v15 offset:32768
    v_mfma_f32_16x16x32_bf16 v[80:83], v[232:235], v[192:195], v[80:83]
    ds_read_b64_tr_b16 v[246:247], v15 offset:34816
    s_add_u32 m0, s50, 24576
    s_add_u32 s51, s83, 49152
    buffer_load_dwordx4 v2, s[32:35], s51 offen sc1 lds
    v_mfma_f32_16x16x32_bf16 v[84:87], v[64:67], v[188:191], v[84:87]
    ds_read_b64_tr_b16 v[68:69], v15 offset:36864
    buffer_load_dword v46, v3, s[32:35], s86 offen offset:512 sc1
    v_mfma_f32_16x16x32_bf16 v[84:87], v[232:235], v[196:199], v[84:87]
    ds_read_b64_tr_b16 v[70:71], v15 offset:38912
    s_waitcnt lgkmcnt(5)
    v_mfma_f32_16x16x32_bf16 v[88:91], v[236:239], v[184:187], v[88:91]
    ds_read_b64_tr_b16 v[72:73], v18 offset:32768
    v_mfma_f32_16x16x32_bf16 v[88:91], v[240:243], v[192:195], v[88:91]
    ds_read_b64_tr_b16 v[74:75], v18 offset:34816
    buffer_load_dwordx4 v2, s[32:35], s51 offen offset:1024 sc1 lds
    v_mfma_f32_16x16x32_bf16 v[92:95], v[236:239], v[188:191], v[92:95]
    ds_read_b64_tr_b16 v[76:77], v18 offset:36864
    v_mfma_f32_16x16x32_bf16 v[92:95], v[240:243], v[196:199], v[92:95]
    ds_read_b64_tr_b16 v[78:79], v18 offset:38912
    s_waitcnt lgkmcnt(4)
    v_mfma_f32_16x16x32_bf16 v[96:99], v[244:247], v[200:203], v[96:99]
    s_barrier
    ds_read_b64_tr_b16 v[64:65], v15 offset:0
    v_mfma_f32_16x16x32_bf16 v[96:99], v[68:71], v[208:211], v[96:99]
    ds_read_b64_tr_b16 v[66:67], v15 offset:2048
    v_mfma_f32_16x16x32_bf16 v[100:103], v[244:247], v[204:207], v[100:103]
    ds_read_b64_tr_b16 v[232:233], v15 offset:4096
    v_mfma_f32_16x16x32_bf16 v[100:103], v[68:71], v[212:215], v[100:103]
    ds_read_b64_tr_b16 v[234:235], v15 offset:6144
    s_waitcnt lgkmcnt(4)
    v_mfma_f32_16x16x32_bf16 v[104:107], v[72:75], v[200:203], v[104:107]
    ds_read_b64_tr_b16 v[236:237], v18 offset:0
    v_mfma_f32_16x16x32_bf16 v[104:107], v[76:79], v[208:211], v[104:107]
    ds_read_b64_tr_b16 v[238:239], v18 offset:2048
    v_mfma_f32_16x16x32_bf16 v[108:111], v[72:75], v[204:207], v[108:111]
    ds_read_b64_tr_b16 v[240:241], v18 offset:4096
    v_mfma_f32_16x16x32_bf16 v[108:111], v[76:79], v[212:215], v[108:111]
    ds_read_b64_tr_b16 v[242:243], v18 offset:6144
    s_waitcnt lgkmcnt(4)
    v_mfma_f32_16x16x32_bf16 v[80:83], v[64:67], v[200:203], v[80:83]
    s_waitcnt vmcnt(3)
    s_barrier
    ds_read_b64_tr_b16 v[68:69], v9 offset:40960
    v_mfma_f32_16x16x32_bf16 v[80:83], v[232:235], v[208:211], v[80:83]
    ds_read_b64_tr_b16 v[70:71], v9 offset:41984
    s_add_u32 m0, s50, 0
    s_add_u32 s51, s83, 57344
    buffer_load_dwordx4 v2, s[32:35], s51 offen sc1 lds
    ds_read_b128 v[224:227], v29 offset:8192
    v_mfma_f32_16x16x32_bf16 v[84:87], v[64:67], v[204:207], v[84:87]
    ds_read_b64_tr_b16 v[72:73], v9 offset:43008
    v_mfma_f32_16x16x32_bf16 v[84:87], v[232:235], v[212:215], v[84:87]
    ds_read_b64_tr_b16 v[74:75], v9 offset:44032
    ds_read_b128 v[228:231], v29 offset:9216
    s_waitcnt lgkmcnt(6)
    v_mfma_f32_16x16x32_bf16 v[88:91], v[236:239], v[200:203], v[88:91]
    ds_read_b64_tr_b16 v[76:77], v9 offset:45056
    v_mfma_f32_16x16x32_bf16 v[88:91], v[240:243], v[208:211], v[88:91]
    ds_read_b64_tr_b16 v[78:79], v9 offset:46080
    buffer_load_dwordx4 v2, s[32:35], s51 offen offset:1024 sc1 lds
    ds_read_b128 v[216:219], v28 offset:8192
    v_mfma_f32_16x16x32_bf16 v[92:95], v[236:239], v[204:207], v[92:95]
    ds_read_b64_tr_b16 v[64:65], v9 offset:47104
    v_mfma_f32_16x16x32_bf16 v[92:95], v[240:243], v[212:215], v[92:95]
    ds_read_b64_tr_b16 v[66:67], v9 offset:48128
    ds_read_b128 v[220:223], v28 offset:9216
    s_waitcnt lgkmcnt(7)
    v_mfma_f32_16x16x32_bf16 v[32:35], v[68:71], v[184:187], v[32:35]
    s_waitcnt vmcnt(3)
    v_readfirstlane_b32 s97, v46
    s_nop 3
    s_cmp_lt_u32 s97, s88
    s_cbranch_scc1 L_slow_1_4
L_back_1_4:
    s_barrier
    v_mfma_f32_16x16x32_bf16 v[32:35], v[72:75], v[192:195], v[32:35]
    v_mfma_f32_16x16x32_bf16 v[36:39], v[68:71], v[188:191], v[36:39]
    ds_read_b64_tr_b16 v[68:69], v14 offset:49152
    ds_read_b64_tr_b16 v[70:71], v14 offset:51200
    v_mfma_f32_16x16x32_bf16 v[36:39], v[72:75], v[196:199], v[36:39]
    ds_read_b64_tr_b16 v[72:73], v14 offset:53248
    ds_read_b64_tr_b16 v[74:75], v14 offset:55296
    s_waitcnt lgkmcnt(5)
    v_mfma_f32_16x16x32_bf16 v[32:35], v[76:79], v[200:203], v[32:35]
    v_mfma_f32_16x16x32_bf16 v[32:35], v[64:67], v[208:211], v[32:35]
    v_mfma_f32_16x16x32_bf16 v[36:39], v[76:79], v[204:207], v[36:39]
    ds_read_b64_tr_b16 v[76:77], v17 offset:49152
    ds_read_b64_tr_b16 v[78:79], v17 offset:51200
    v_mfma_f32_16x16x32_bf16 v[36:39], v[64:67], v[212:215], v[36:39]
    ds_read_b64_tr_b16 v[64:65], v17 offset:53248
    ds_read_b64_tr_b16 v[66:67], v17 offset:55296
    s_waitcnt lgkmcnt(4)
    v_mfma_f32_16x16x32_bf16 v[96:99], v[68:71], v[216:219], v[96:99]
    s_barrier
    v_mfma_f32_16x16x32_bf16 v[96:99], v[72:75], v[224:227], v[96:99]
    s_add_u32 m0, s50, 8192
    s_add_u32 s51, s83, 65536
    buffer_load_dwordx4 v2, s[32:35], s51 offen sc1 lds
    v_mfma_f32_16x16x32_bf16 v[100:103], v[68:71], v[220:223], v[100:103]
    ds_read_b64_tr_b16 v[68:69], v15 offset:49152
    ds_read_b64_tr_b16 v[70:71], v15 offset:51200
    v_mfma_f32_16x16x32_bf16 v[100:103], v[72:75], v[228:231], v[100:103]
    ds_read_b64_tr_b16 v[72:73], v15 offset:53248
    ds_read_b64_tr_b16 v[74:75], v15 offset:55296
    s_waitcnt lgkmcnt(4)
    v_mfma_f32_16x16x32_bf16 v[104:107], v[76:79], v[216:219], v[104:107]
    v_mfma_f32_16x16x32_bf16 v[104:107], v[64:67], v[224:227], v[104:107]
    buffer_load_dwordx4 v2, s[32:35], s51 offen offset:1024 sc1 lds
    v_mfma_f32_16x16x32_bf16 v[108:111], v[76:79], v[220:223], v[108:111]
    ds_read_b64_tr_b16 v[76:77], v18 offset:49152
    ds_read_b64_tr_b16 v[78:79], v18 offset:51200
    v_mfma_f32_16x16x32_bf16 v[108:111], v[64:67], v[228:231], v[108:111]
    ds_read_b64_tr_b16 v[64:65], v18 offset:53248
    ds_read_b64_tr_b16 v[66:67], v18 offset:55296
    s_waitcnt lgkmcnt(4)
    v_mfma_f32_16x16x32_bf16 v[80:83], v[68:71], v[216:219], v[80:83]
    s_barrier
    v_mfma_f32_16x16x32_bf16 v[80:83], v[72:75], v[224:227], v[80:83]
    v_mfma_f32_16x16x32_bf16 v[84:87], v[68:71], v[220:223], v[84:87]
    ds_read_b64_tr_b16 v[68:69], v15 offset:16384
    ds_read_b64_tr_b16 v[70:71], v15 offset:18432
    v_mfma_f32_16x16x32_bf16 v[84:87], v[72:75], v[228:231], v[84:87]
    ds_read_b64_tr_b16 v[72:73], v15 offset:20480
    ds_read_b64_tr_b16 v[74:75], v15 offset:22528
    s_waitcnt lgkmcnt(4)
    v_mfma_f32_16x16x32_bf16 v[88:91], v[76:79], v[216:219], v[88:91]
    v_mfma_f32_16x16x32_bf16 v[88:91], v[64:67], v[224:227], v[88:91]
    v_mfma_f32_16x16x32_bf16 v[92:95], v[76:79], v[220:223], v[92:95]
    ds_read_b64_tr_b16 v[76:77], v18 offset:16384
    ds_read_b64_tr_b16 v[78:79], v18 offset:18432
    v_mfma_f32_16x16x32_bf16 v[92:95], v[64:67], v[228:231], v[92:95]
    ds_read_b64_tr_b16 v[64:65], v18 offset:20480
    ds_read_b64_tr_b16 v[66:67], v18 offset:22528
    s_waitcnt lgkmcnt(4)
    v_mfma_f32_16x16x32_bf16 v[48:51], v[68:71], v[112:115], 0
    s_waitcnt vmcnt(2)
    s_barrier
    v_mfma_f32_16x16x32_bf16 v[48:51], v[72:75], v[120:123], v[48:51]
    ds_read_b128 v[240:243], v28 offset:0
    v_mfma_f32_16x16x32_bf16 v[52:55], v[68:71], v[116:119], 0
    ds_read_b64_tr_b16 v[68:69], v15 offset:57344
    ds_read_b64_tr_b16 v[70:71], v15 offset:59392
    v_mfma_f32_16x16x32_bf16 v[52:55], v[72:75], v[124:127], v[52:55]
    ds_read_b64_tr_b16 v[72:73], v15 offset:61440
    ds_read_b64_tr_b16 v[74:75], v15 offset:63488
    ds_read_b128 v[244:247], v28 offset:1024
    s_waitcnt lgkmcnt(6)
    v_mfma_f32_16x16x32_bf16 v[20:23], v[76:79], v[112:115], 0
    v_mfma_f32_16x16x32_bf16 v[20:23], v[64:67], v[120:123], v[20:23]
    ds_read_b128 v[232:235], v28 offset:24576
    v_mfma_f32_16x16x32_bf16 v[24:27], v[76:79], v[116:119], 0
    ds_read_b64_tr_b16 v[76:77], v18 offset:57344
    ds_read_b64_tr_b16 v[78:79], v18 offset:59392
    v_mfma_f32_16x16x32_bf16 v[24:27], v[64:67], v[124:127], v[24:27]
    ds_read_b64_tr_b16 v[64:65], v18 offset:61440
    ds_read_b64_tr_b16 v[66:67], v18 offset:63488
    ds_read_b128 v[236:239], v28 offset:25600
    s_waitcnt lgkmcnt(7)
    v_mfma_f32_16x16x32_bf16 v[48:51], v[68:71], v[128:131], v[48:51]
    s_barrier
    v_mfma_f32_16x16x32_bf16 v[48:51], v[72:75], v[136:139], v[48:51]
    v_mfma_f32_16x16x32_bf16 v[52:55], v[68:71], v[132:135], v[52:55]
    ds_read_b64_tr_b16 v[68:69], v14 offset:32768
    ds_read_b64_tr_b16 v[70:71], v14 offset:34816
    v_mfma_f32_16x16x32_bf16 v[52:55], v[72:75], v[140:143], v[52:55]
    ds_read_b64_tr_b16 v[72:73], v14 offset:36864
    ds_read_b64_tr_b16 v[74:75], v14 offset:38912
    s_waitcnt lgkmcnt(5)
    v_mfma_f32_16x16x32_bf16 v[20:23], v[76:79], v[128:131], v[20:23]
    v_mfma_f32_16x16x32_bf16 v[20:23], v[64:67], v[136:139], v[20:23]
    v_mfma_f32_16x16x32_bf16 v[24:27], v[76:79], v[132:135], v[24:27]
    ds_read_b64_tr_b16 v[76:77], v17 offset:32768
    ds_read_b64_tr_b16 v[78:79], v17 offset:34816
    v_mfma_f32_16x16x32_bf16 v[24:27], v[64:67], v[140:143], v[24:27]
    ds_read_b64_tr_b16 v[64:65], v17 offset:36864
    ds_read_b64_tr_b16 v[66:67], v17 offset:38912
    s_waitcnt lgkmcnt(4)
    v_mfma_f32_16x16x32_bf16 v[96:99], v[68:71], v[232:235], v[96:99]
    s_barrier
    v_mfma_f32_16x16x32_bf16 v[96:99], v[72:75], v[240:243], v[96:99]
    v_mfma_f32_16x16x32_bf16 v[100:103], v[68:71], v[236:239], v[100:103]
    ds_read_b64_tr_b16 v[68:69], v14 offset:57344
    ds_read_b64_tr_b16 v[70:71], v14 offset:59392
    v_mfma_f32_16x16x32_bf16 v[100:103], v[72:75], v[244:247], v[100:103]
    ds_read_b64_tr_b16 v[72:73], v14 offset:61440
    ds_read_b64_tr_b16 v[74:75], v14 offset:63488
    s_waitcnt lgkmcnt(4)
    v_mfma_f32_16x16x32_bf16 v[104:107], v[76:79], v[232:235], v[104:107]
    v_mfma_f32_16x16x32_bf16 v[104:107], v[64:67], v[240:243], v[104:107]
    v_mfma_f32_16x16x32_bf16 v[108:111], v[76:79], v[236:239], v[108:111]
    ds_read_b64_tr_b16 v[76:77], v17 offset:57344
    ds_read_b64_tr_b16 v[78:79], v17 offset:59392
    v_mfma_f32_16x16x32_bf16 v[108:111], v[64:67], v[244:247], v[108:111]
    ds_read_b64_tr_b16 v[64:65], v17 offset:61440
    ds_read_b64_tr_b16 v[66:67], v17 offset:63488
    s_waitcnt lgkmcnt(4)
    v_mfma_f32_16x16x32_bf16 v[80:83], v[68:71], v[232:235], v[80:83]
    s_waitcnt vmcnt(0)
    s_barrier
    v_mfma_f32_16x16x32_bf16 v[80:83], v[72:75], v[240:243], v[80:83]
    v_mfma_f32_16x16x32_bf16 v[84:87], v[68:71], v[236:239], v[84:87]
    ds_read_b64_tr_b16 v[68:69], v8 offset:16384
    ds_read_b64_tr_b16 v[70:71], v8 offset:17408
    v_mfma_f32_16x16x32_bf16 v[84:87], v[72:75], v[244:247], v[84:87]
    ds_read_b64_tr_b16 v[72:73], v8 offset:18432
    ds_read_b64_tr_b16 v[74:75], v8 offset:19456
    s_waitcnt lgkmcnt(4)
    v_mfma_f32_16x16x32_bf16 v[88:91], v[76:79], v[232:235], v[88:91]
    v_mfma_f32_16x16x32_bf16 v[88:91], v[64:67], v[240:243], v[88:91]
    ds_read_b128 v[248:251], v28 offset:8192
    v_mfma_f32_16x16x32_bf16 v[92:95], v[76:79], v[236:239], v[92:95]
    ds_read_b64_tr_b16 v[76:77], v8 offset:20480
    ds_read_b64_tr_b16 v[78:79], v8 offset:21504
    v_mfma_f32_16x16x32_bf16 v[92:95], v[64:67], v[244:247], v[92:95]
    ds_read_b64_tr_b16 v[64:65], v8 offset:22528
    ds_read_b64_tr_b16 v[66:67], v8 offset:23552
    ds_read_b128 v[252:255], v28 offset:9216
    s_waitcnt lgkmcnt(6)
    v_mfma_f32_16x16x32_bf16 v[32:35], v[68:71], v[216:219], v[32:35]
    s_barrier
    v_mfma_f32_16x16x32_bf16 v[32:35], v[72:75], v[224:227], v[32:35]
    v_mfma_f32_16x16x32_bf16 v[36:39], v[68:71], v[220:223], v[36:39]
    ds_read_b64_tr_b16 v[68:69], v14 offset:40960
    ds_read_b64_tr_b16 v[70:71], v14 offset:43008
    v_mfma_f32_16x16x32_bf16 v[36:39], v[72:75], v[228:231], v[36:39]
    ds_read_b64_tr_b16 v[72:73], v14 offset:45056
    ds_read_b64_tr_b16 v[74:75], v14 offset:47104
    s_waitcnt lgkmcnt(5)
    v_mfma_f32_16x16x32_bf16 v[32:35], v[76:79], v[232:235], v[32:35]
    v_mfma_f32_16x16x32_bf16 v[32:35], v[64:67], v[240:243], v[32:35]
    v_mfma_f32_16x16x32_bf16 v[36:39], v[76:79], v[236:239], v[36:39]
    ds_read_b64_tr_b16 v[76:77], v17 offset:40960
    ds_read_b64_tr_b16 v[78:79], v17 offset:43008
    v_mfma_f32_16x16x32_bf16 v[36:39], v[64:67], v[244:247], v[36:39]
    ds_read_b64_tr_b16 v[64:65], v17 offset:45056
    ds_read_b64_tr_b16 v[66:67], v17 offset:47104
    s_waitcnt lgkmcnt(4)
    v_mfma_f32_16x16x32_bf16 v[96:99], v[68:71], v[176:179], v[96:99]
    s_barrier
    v_mfma_f32_16x16x32_bf16 v[96:99], v[72:75], v[248:251], v[96:99]
    v_mfma_f32_16x16x32_bf16 v[100:103], v[68:71], v[180:183], v[100:103]
    ds_read_b64_tr_b16 v[68:69], v15 offset:0
    ds_read_b64_tr_b16 v[70:71], v15 offset:2048
    v_mfma_f32_16x16x32_bf16 v[100:103], v[72:75], v[252:255], v[100:103]
    ds_read_b64_tr_b16 v[72:73], v15 offset:4096
    ds_read_b64_tr_b16 v[74:75], v15 offset:6144
    s_waitcnt lgkmcnt(4)
    v_mfma_f32_16x16x32_bf16 v[104:107], v[76:79], v[176:179], v[104:107]
    v_mfma_f32_16x16x32_bf16 v[104:107], v[64:67], v[248:251], v[104:107]
    v_mfma_f32_16x16x32_bf16 v[108:111], v[76:79], v[180:183], v[108:111]
    ds_read_b64_tr_b16 v[76:77], v18 offset:0
    ds_read_b64_tr_b16 v[78:79], v18 offset:2048
    v_mfma_f32_16x16x32_bf16 v[108:111], v[64:67], v[252:255], v[108:111]
    ds_read_b64_tr_b16 v[64:65], v18 offset:4096
    ds_read_b64_tr_b16 v[66:67], v18 offset:6144
    s_waitcnt lgkmcnt(4)
    v_mfma_f32_16x16x32_bf16 v[80:83], v[68:71], v[176:179], v[80:83]
    s_barrier
    v_mfma_f32_16x16x32_bf16 v[80:83], v[72:75], v[248:251], v[80:83]
    v_cvt_pk_bf16_f32 v56, v96, v97
    v_mfma_f32_16x16x32_bf16 v[84:87], v[68:71], v[180:183], v[84:87]
    ds_read_b64_tr_b16 v[68:69], v9 offset:8192
    ds_read_b64_tr_b16 v[70:71], v9 offset:9216
    v_cvt_pk_bf16_f32 v57, v98, v99
    v_mfma_f32_16x16x32_bf16 v[84:87], v[72:75], v[252:255], v[84:87]
    ds_read_b64_tr_b16 v[72:73], v9 offset:10240
    ds_read_b64_tr_b16 v[74:75], v9 offset:11264
    v_cvt_pk_bf16_f32 v58, v100, v101
    s_waitcnt lgkmcnt(4)
    v_mfma_f32_16x16x32_bf16 v[88:91], v[76:79], v[176:179], v[88:91]
    v_cvt_pk_bf16_f32 v59, v102, v103
    v_mfma_f32_16x16x32_bf16 v[88:91], v[64:67], v[248:251], v[88:91]
    s_add_u32 s52, s72, s80
    buffer_store_dwordx4 v[56:59], v2, s[32:35], s52 offen sc1
    v_mfma_f32_16x16x32_bf16 v[92:95], v[76:79], v[180:183], v[92:95]
    v_mfma_f32_16x16x32_bf16 v[92:95], v[64:67], v[252:255], v[92:95]
    s_waitcnt lgkmcnt(0)
    v_mfma_f32_16x16x32_bf16 v[32:35], v[68:71], v[176:179], v[32:35]
    s_barrier
    ds_read_b64_tr_b16 v[76:77], v14 offset:49152
    ds_read_b64_tr_b16 v[78:79], v14 offset:51200
    v_mfma_f32_16x16x32_bf16 v[32:35], v[72:75], v[248:251], v[32:35]
    ds_read_b64_tr_b16 v[64:65], v14 offset:53248
    ds_read_b64_tr_b16 v[66:67], v14 offset:55296
    v_cvt_pk_bf16_f32 v60, v104, v105
    v_cvt_pk_bf16_f32 v61, v106, v107
    v_mfma_f32_16x16x32_bf16 v[36:39], v[68:71], v[180:183], v[36:39]
    ds_read_b64_tr_b16 v[68:69], v17 offset:49152
    ds_read_b64_tr_b16 v[70:71], v17 offset:51200
    v_cvt_pk_bf16_f32 v62, v108, v109
    v_mfma_f32_16x16x32_bf16 v[36:39], v[72:75], v[252:255], v[36:39]
    ds_read_b64_tr_b16 v[72:73], v17 offset:53248
    ds_read_b64_tr_b16 v[74:75], v17 offset:55296
    v_cvt_pk_bf16_f32 v63, v110, v111
    s_add_u32 s52, s72, s81
    buffer_store_dwordx4 v[60:63], v2, s[32:35], s52 offen sc1
    s_waitcnt lgkmcnt(4)
    v_mfma_f32_16x16x32_bf16 v[48:51], v[76:79], v[144:147], v[48:51]
    s_barrier
    ds_read_b64_tr_b16 v[96:97], v15 offset:24576
    v_mfma_f32_16x16x32_bf16 v[48:51], v[64:67], v[152:155], v[48:51]
    ds_read_b64_tr_b16 v[98:99], v15 offset:26624
    v_cvt_pk_bf16_f32 v56, v80, v81
    v_mfma_f32_16x16x32_bf16 v[52:55], v[76:79], v[148:151], v[52:55]
    ds_read_b64_tr_b16 v[100:101], v15 offset:28672
    v_cvt_pk_bf16_f32 v57, v82, v83
    v_mfma_f32_16x16x32_bf16 v[52:55], v[64:67], v[156:159], v[52:55]
    ds_read_b64_tr_b16 v[102:103], v15 offset:30720
    v_cvt_pk_bf16_f32 v58, v84, v85
    s_waitcnt lgkmcnt(4)
    v_mfma_f32_16x16x32_bf16 v[20:23], v[68:71], v[144:147], v[20:23]
    ds_read_b64_tr_b16 v[76:77], v18 offset:24576
    v_cvt_pk_bf16_f32 v59, v86, v87
    v_mfma_f32_16x16x32_bf16 v[20:23], v[72:75], v[152:155], v[20:23]
    ds_read_b64_tr_b16 v[78:79], v18 offset:26624
    s_add_u32 s52, s73, s80
    buffer_store_dwordx4 v[56:59], v2, s[32:35], s52 offen sc1
    v_mfma_f32_16x16x32_bf16 v[24:27], v[68:71], v[148:151], v[24:27]
    ds_read_b64_tr_b16 v[64:65], v18 offset:28672
    v_mfma_f32_16x16x32_bf16 v[24:27], v[72:75], v[156:159], v[24:27]
    ds_read_b64_tr_b16 v[66:67], v18 offset:30720
    s_waitcnt lgkmcnt(4)
    v_mfma_f32_16x16x32_bf16 v[48:51], v[96:99], v[160:163], v[48:51]
    s_barrier
    ds_read_b64_tr_b16 v[68:69], v15 offset:32768
    v_mfma_f32_16x16x32_bf16 v[48:51], v[100:103], v[168:171], v[48:51]
    ds_read_b64_tr_b16 v[70:71], v15 offset:34816
    v_cvt_pk_bf16_f32 v60, v88, v89
    v_mfma_f32_16x16x32_bf16 v[52:55], v[96:99], v[164:167], v[52:55]
    ds_read_b64_tr_b16 v[72:73], v15 offset:36864
    v_cvt_pk_bf16_f32 v61, v90, v91
    v_mfma_f32_16x16x32_bf16 v[52:55], v[100:103], v[172:175], v[52:55]
    ds_read_b64_tr_b16 v[74:75], v15 offset:38912
    v_cvt_pk_bf16_f32 v62, v92, v93
    s_waitcnt lgkmcnt(4)
    v_mfma_f32_16x16x32_bf16 v[20:23], v[76:79], v[160:163], v[20:23]
    ds_read_b64_tr_b16 v[96:97], v18 offset:32768
    v_cvt_pk_bf16_f32 v63, v94, v95
    v_mfma_f32_16x16x32_bf16 v[20:23], v[64:67], v[168:171], v[20:23]
    ds_read_b64_tr_b16 v[98:99], v18 offset:34816
    s_add_u32 s52, s73, s81
    buffer_store_dwordx4 v[60:63], v2, s[32:35], s52 offen sc1
    v_mfma_f32_16x16x32_bf16 v[24:27], v[76:79], v[164:167], v[24:27]
    ds_read_b64_tr_b16 v[100:101], v18 offset:36864
    v_mfma_f32_16x16x32_bf16 v[24:27], v[64:67], v[172:175], v[24:27]
    ds_read_b64_tr_b16 v[102:103], v18 offset:38912
    s_waitcnt lgkmcnt(4)
    v_mfma_f32_16x16x32_bf16 v[48:51], v[68:71], v[184:187], v[48:51]
    s_barrier
    ds_read_b64_tr_b16 v[76:77], v15 offset:40960
    v_mfma_f32_16x16x32_bf16 v[48:51], v[72:75], v[192:195], v[48:51]
    ds_read_b64_tr_b16 v[78:79], v15 offset:43008
    v_cvt_pk_bf16_f32 v56, v32, v33
    v_mfma_f32_16x16x32_bf16 v[52:55], v[68:71], v[188:191], v[52:55]
    ds_read_b64_tr_b16 v[64:65], v15 offset:45056
    v_cvt_pk_bf16_f32 v57, v34, v35
    v_mfma_f32_16x16x32_bf16 v[52:55], v[72:75], v[196:199], v[52:55]
    ds_read_b64_tr_b16 v[66:67], v15 offset:47104
    v_cvt_pk_bf16_f32 v58, v36, v37
    s_waitcnt lgkmcnt(4)
    v_mfma_f32_16x16x32_bf16 v[20:23], v[96:99], v[184:187], v[20:23]
    ds_read_b64_tr_b16 v[68:69], v18 offset:40960
    v_cvt_pk_bf16_f32 v59, v38, v39
    v_mfma_f32_16x16x32_bf16 v[20:23], v[100:103], v[192:195], v[20:23]
    ds_read_b64_tr_b16 v[70:71], v18 offset:43008
    s_mov_b32 s52, s71
    buffer_store_dwordx4 v[56:59], v2, s[32:35], s52 offen sc1
    v_mfma_f32_16x16x32_bf16 v[24:27], v[96:99], v[188:191], v[24:27]
    ds_read_b64_tr_b16 v[72:73], v18 offset:45056
    v_mfma_f32_16x16x32_bf16 v[24:27], v[100:103], v[196:199], v[24:27]
    ds_read_b64_tr_b16 v[74:75], v18 offset:47104
    s_waitcnt lgkmcnt(4)
    v_mfma_f32_16x16x32_bf16 v[48:51], v[76:79], v[200:203], v[48:51]
    s_barrier
    ds_read_b64_tr_b16 v[96:97], v15 offset:16384
    v_mfma_f32_16x16x32_bf16 v[48:51], v[64:67], v[208:211], v[48:51]
    ds_read_b64_tr_b16 v[98:99], v15 offset:18432
    v_mfma_f32_16x16x32_bf16 v[52:55], v[76:79], v[204:207], v[52:55]
    ds_read_b64_tr_b16 v[100:101], v15 offset:20480
    v_mfma_f32_16x16x32_bf16 v[52:55], v[64:67], v[212:215], v[52:55]
    ds_read_b64_tr_b16 v[102:103], v15 offset:22528
    s_waitcnt lgkmcnt(4)
    v_mfma_f32_16x16x32_bf16 v[20:23], v[68:71], v[200:203], v[20:23]
    ds_read_b64_tr_b16 v[76:77], v18 offset:16384
    v_mfma_f32_16x16x32_bf16 v[20:23], v[72:75], v[208:211], v[20:23]
    ds_read_b64_tr_b16 v[78:79], v18 offset:18432
    v_mfma_f32_16x16x32_bf16 v[24:27], v[68:71], v[204:207], v[24:27]
    ds_read_b64_tr_b16 v[64:65], v18 offset:20480
    v_mfma_f32_16x16x32_bf16 v[24:27], v[72:75], v[212:215], v[24:27]
    ds_read_b64_tr_b16 v[66:67], v18 offset:22528
    s_waitcnt lgkmcnt(4)
    v_mfma_f32_16x16x32_bf16 v[48:51], v[96:99], v[216:219], v[48:51]
    s_barrier
    ds_read_b64_tr_b16 v[68:69], v15 offset:49152
    v_mfma_f32_16x16x32_bf16 v[48:51], v[100:103], v[224:227], v[48:51]
    ds_read_b64_tr_b16 v[70:71], v15 offset:51200
    v_mfma_f32_16x16x32_bf16 v[52:55], v[96:99], v[220:223], v[52:55]
    ds_read_b64_tr_b16 v[72:73], v15 offset:53248
    v_mfma_f32_16x16x32_bf16 v[52:55], v[100:103], v[228:231], v[52:55]
    ds_read_b64_tr_b16 v[74:75], v15 offset:55296
    s_waitcnt lgkmcnt(4)
    v_mfma_f32_16x16x32_bf16 v[20:23], v[76:79], v[216:219], v[20:23]
    ds_read_b64_tr_b16 v[96:97], v18 offset:49152
    v_mfma_f32_16x16x32_bf16 v[20:23], v[64:67], v[224:227], v[20:23]
    ds_read_b64_tr_b16 v[98:99], v18 offset:51200
    v_mfma_f32_16x16x32_bf16 v[24:27], v[76:79], v[220:223], v[24:27]
    ds_read_b64_tr_b16 v[100:101], v18 offset:53248
    v_mfma_f32_16x16x32_bf16 v[24:27], v[64:67], v[228:231], v[24:27]
    ds_read_b64_tr_b16 v[102:103], v18 offset:55296
    s_waitcnt lgkmcnt(4)
    v_mfma_f32_16x16x32_bf16 v[48:51], v[68:71], v[232:235], v[48:51]
    s_barrier
    ds_read_b64_tr_b16 v[76:77], v14 offset:0
    v_mfma_f32_16x16x32_bf16 v[48:51], v[72:75], v[240:243], v[48:51]
    ds_read_b64_tr_b16 v[78:79], v14 offset:2048
    v_mfma_f32_16x16x32_bf16 v[52:55], v[68:71], v[236:239], v[52:55]
    ds_read_b64_tr_b16 v[64:65], v14 offset:4096
    v_mfma_f32_16x16x32_bf16 v[52:55], v[72:75], v[244:247], v[52:55]
    ds_read_b64_tr_b16 v[66:67], v14 offset:6144
    s_waitcnt lgkmcnt(4)
    v_mfma_f32_16x16x32_bf16 v[20:23], v[96:99], v[232:235], v[20:23]
    ds_read_b64_tr_b16 v[68:69], v17 offset:0
    v_mfma_f32_16x16x32_bf16 v[20:23], v[100:103], v[240:243], v[20:23]
    ds_read_b64_tr_b16 v[70:71], v17 offset:2048
    v_mfma_f32_16x16x32_bf16 v[24:27], v[96:99], v[236:239], v[24:27]
    ds_read_b64_tr_b16 v[72:73], v17 offset:4096
    v_mfma_f32_16x16x32_bf16 v[24:27], v[100:103], v[244:247], v[24:27]
    ds_read_b64_tr_b16 v[74:75], v17 offset:6144
    s_waitcnt lgkmcnt(4)
    v_mfma_f32_16x16x32_bf16 v[48:51], v[76:79], v[176:179], v[48:51]
    s_waitcnt vmcnt(0)
    s_barrier
    ds_read_b64_tr_b16 v[96:97], v14 offset:24576
    v_mfma_f32_16x16x32_bf16 v[48:51], v[64:67], v[248:251], v[48:51]
    ds_read_b64_tr_b16 v[98:99], v14 offset:26624
    buffer_atomic_add v4, v3, s[32:35], s84 offen
    v_mfma_f32_16x16x32_bf16 v[52:55], v[76:79], v[180:183], v[52:55]
    ds_read_b64_tr_b16 v[100:101], v14 offset:28672
    v_mfma_f32_16x16x32_bf16 v[52:55], v[64:67], v[252:255], v[52:55]
    ds_read_b64_tr_b16 v[102:103], v14 offset:30720
    s_waitcnt lgkmcnt(4)
    v_mfma_f32_16x16x32_bf16 v[20:23], v[68:71], v[176:179], v[20:23]
    ds_read_b64_tr_b16 v[76:77], v14 offset:32768
    v_mfma_f32_16x16x32_bf16 v[20:23], v[72:75], v[248:251], v[20:23]
    ds_read_b64_tr_b16 v[78:79], v14 offset:34816
    v_mfma_f32_16x16x32_bf16 v[24:27], v[68:71], v[180:183], v[24:27]
    ds_read_b64_tr_b16 v[64:65], v14 offset:36864
    v_mfma_f32_16x16x32_bf16 v[24:27], v[72:75], v[252:255], v[24:27]
    ds_read_b64_tr_b16 v[66:67], v14 offset:38912
    s_waitcnt lgkmcnt(4)
    v_mfma_f32_16x16x32_bf16 v[80:83], v[96:99], v[112:115], 0
    ds_read_b64_tr_b16 v[68:69], v14 offset:57344
    v_mfma_f32_16x16x32_bf16 v[80:83], v[100:103], v[120:123], v[80:83]
    ds_read_b64_tr_b16 v[70:71], v14 offset:59392
    v_cvt_pk_bf16_f32 v56, v48, v49
    v_mfma_f32_16x16x32_bf16 v[84:87], v[96:99], v[116:119], 0
    ds_read_b64_tr_b16 v[72:73], v14 offset:61440
    v_cvt_pk_bf16_f32 v57, v50, v51
    v_mfma_f32_16x16x32_bf16 v[84:87], v[100:103], v[124:127], v[84:87]
    ds_read_b64_tr_b16 v[74:75], v14 offset:63488
    v_cvt_pk_bf16_f32 v58, v52, v53
    s_waitcnt lgkmcnt(4)
    v_mfma_f32_16x16x32_bf16 v[80:83], v[76:79], v[128:131], v[80:83]
    ds_read_b64_tr_b16 v[96:97], v15 offset:57344
    v_cvt_pk_bf16_f32 v59, v54, v55
    v_mfma_f32_16x16x32_bf16 v[80:83], v[64:67], v[136:139], v[80:83]
    ds_read_b64_tr_b16 v[98:99], v15 offset:59392
    s_add_u32 s52, s74, s80
    buffer_store_dwordx4 v[56:59], v2, s[32:35], s52 offen sc1
    v_mfma_f32_16x16x32_bf16 v[84:87], v[76:79], v[132:135], v[84:87]
    ds_read_b64_tr_b16 v[100:101], v15 offset:61440
    v_mfma_f32_16x16x32_bf16 v[84:87], v[64:67], v[140:143], v[84:87]
    ds_read_b64_tr_b16 v[102:103], v15 offset:63488
    s_waitcnt lgkmcnt(4)
    v_mfma_f32_16x16x32_bf16 v[80:83], v[68:71], v[144:147], v[80:83]
    ds_read_b64_tr_b16 v[76:77], v14 offset:8192
    v_mfma_f32_16x16x32_bf16 v[80:83], v[72:75], v[152:155], v[80:83]
    ds_read_b64_tr_b16 v[78:79], v14 offset:10240
    v_cvt_pk_bf16_f32 v60, v20, v21
    v_mfma_f32_16x16x32_bf16 v[84:87], v[68:71], v[148:151], v[84:87]
    ds_read_b64_tr_b16 v[64:65], v14 offset:12288
    v_cvt_pk_bf16_f32 v61, v22, v23
    v_mfma_f32_16x16x32_bf16 v[84:87], v[72:75], v[156:159], v[84:87]
    ds_read_b64_tr_b16 v[66:67], v14 offset:14336
    v_cvt_pk_bf16_f32 v62, v24, v25
    s_waitcnt lgkmcnt(4)
    v_mfma_f32_16x16x32_bf16 v[80:83], v[96:99], v[160:163], v[80:83]
    ds_read_b64_tr_b16 v[68:69], v14 offset:16384
    v_cvt_pk_bf16_f32 v63, v26, v27
    v_mfma_f32_16x16x32_bf16 v[80:83], v[100:103], v[168:171], v[80:83]
    ds_read_b64_tr_b16 v[70:71], v14 offset:18432
    s_add_u32 s52, s74, s81
    buffer_store_dwordx4 v[60:63], v2, s[32:35], s52 offen sc1
    v_mfma_f32_16x16x32_bf16 v[84:87], v[96:99], v[164:167], v[84:87]
    ds_read_b64_tr_b16 v[72:73], v14 offset:20480
    v_mfma_f32_16x16x32_bf16 v[84:87], v[100:103], v[172:175], v[84:87]
    ds_read_b64_tr_b16 v[74:75], v14 offset:22528
    s_waitcnt lgkmcnt(4)
    v_mfma_f32_16x16x32_bf16 v[80:83], v[76:79], v[184:187], v[80:83]
    ds_read_b64_tr_b16 v[96:97], v14 offset:40960
    v_mfma_f32_16x16x32_bf16 v[80:83], v[64:67], v[192:195], v[80:83]
    ds_read_b64_tr_b16 v[98:99], v14 offset:43008
    v_mfma_f32_16x16x32_bf16 v[84:87], v[76:79], v[188:191], v[84:87]
    ds_read_b64_tr_b16 v[100:101], v14 offset:45056
    v_mfma_f32_16x16x32_bf16 v[84:87], v[64:67], v[196:199], v[84:87]
    ds_read_b64_tr_b16 v[102:103], v14 offset:47104
    s_waitcnt lgkmcnt(4)
    v_mfma_f32_16x16x32_bf16 v[80:83], v[68:71], v[200:203], v[80:83]
    ds_read_b64_tr_b16 v[76:77], v16 offset:0
    v_mfma_f32_16x16x32_bf16 v[80:83], v[72:75], v[208:211], v[80:83]
    ds_read_b64_tr_b16 v[78:79], v16 offset:2048
    v_mfma_f32_16x16x32_bf16 v[84:87], v[68:71], v[204:207], v[84:87]
    ds_read_b64_tr_b16 v[64:65], v16 offset:4096
    v_mfma_f32_16x16x32_bf16 v[84:87], v[72:75], v[212:215], v[84:87]
    ds_read_b64_tr_b16 v[66:67], v16 offset:6144
    s_waitcnt lgkmcnt(4)
    v_mfma_f32_16x16x32_bf16 v[80:83], v[96:99], v[216:219], v[80:83]
    ds_read_b64_tr_b16 v[68:69], v15 offset:0
    v_mfma_f32_16x16x32_bf16 v[80:83], v[100:103], v[224:227], v[80:83]
    ds_read_b64_tr_b16 v[70:71], v15 offset:2048
    v_mfma_f32_16x16x32_bf16 v[84:87], v[96:99], v[220:223], v[84:87]
    ds_read_b64_tr_b16 v[72:73], v15 offset:4096
    buffer_load_dword v46, v3, s[32:35], s84 offen sc1
    v_mfma_f32_16x16x32_bf16 v[84:87], v[100:103], v[228:231], v[84:87]
    ds_read_b64_tr_b16 v[74:75], v15 offset:6144
    s_waitcnt lgkmcnt(4)
    v_mfma_f32_16x16x32_bf16 v[80:83], v[76:79], v[232:235], v[80:83]
    ds_read_b64_tr_b16 v[96:97], v17 offset:24576
    v_mfma_f32_16x16x32_bf16 v[80:83], v[64:67], v[240:243], v[80:83]
    ds_read_b64_tr_b16 v[98:99], v17 offset:26624
    v_mfma_f32_16x16x32_bf16 v[84:87], v[76:79], v[236:239], v[84:87]
    ds_read_b64_tr_b16 v[100:101], v17 offset:28672
    v_mfma_f32_16x16x32_bf16 v[84:87], v[64:67], v[244:247], v[84:87]
    ds_read_b64_tr_b16 v[102:103], v17 offset:30720
    s_waitcnt lgkmcnt(4)
    v_mfma_f32_16x16x32_bf16 v[80:83], v[68:71], v[176:179], v[80:83]
    ds_read_b64_tr_b16 v[76:77], v17 offset:32768
    v_mfma_f32_16x16x32_bf16 v[80:83], v[72:75], v[248:251], v[80:83]
    ds_read_b64_tr_b16 v[78:79], v17 offset:34816
    v_mfma_f32_16x16x32_bf16 v[84:87], v[68:71], v[180:183], v[84:87]
    ds_read_b64_tr_b16 v[64:65], v17 offset:36864
    v_mfma_f32_16x16x32_bf16 v[84:87], v[72:75], v[252:255], v[84:87]
    ds_read_b64_tr_b16 v[66:67], v17 offset:38912
    s_waitcnt lgkmcnt(4)
    v_mfma_f32_16x16x32_bf16 v[88:91], v[96:99], v[112:115], 0
    ds_read_b64_tr_b16 v[68:69], v17 offset:57344
    v_mfma_f32_16x16x32_bf16 v[88:91], v[100:103], v[120:123], v[88:91]
    ds_read_b64_tr_b16 v[70:71], v17 offset:59392
    v_cvt_pk_bf16_f32 v56, v80, v81
    v_cvt_pk_bf16_f32 v57, v82, v83
    v_mfma_f32_16x16x32_bf16 v[92:95], v[96:99], v[116:119], 0
    ds_read_b64_tr_b16 v[72:73], v17 offset:61440
    v_cvt_pk_bf16_f32 v58, v84, v85
    v_mfma_f32_16x16x32_bf16 v[92:95], v[100:103], v[124:127], v[92:95]
    ds_read_b64_tr_b16 v[74:75], v17 offset:63488
    v_cvt_pk_bf16_f32 v59, v86, v87
    s_add_u32 s52, s75, s80
    buffer_store_dwordx4 v[56:59], v2, s[32:35], s52 offen sc1
    s_waitcnt lgkmcnt(4)
    v_mfma_f32_16x16x32_bf16 v[88:91], v[76:79], v[128:131], v[88:91]
    ds_read_b64_tr_b16 v[96:97], v18 offset:57344
    v_mfma_f32_16x16x32_bf16 v[88:91], v[64:67], v[136:139], v[88:91]
    ds_read_b64_tr_b16 v[98:99], v18 offset:59392
    v_mfma_f32_16x16x32_bf16 v[92:95], v[76:79], v[132:135], v[92:95]
    ds_read_b64_tr_b16 v[100:101], v18 offset:61440
    v_mfma_f32_16x16x32_bf16 v[92:95], v[64:67], v[140:143], v[92:95]
    ds_read_b64_tr_b16 v[102:103], v18 offset:63488
    s_waitcnt lgkmcnt(4)
    v_mfma_f32_16x16x32_bf16 v[88:91], v[68:71], v[144:147], v[88:91]
    ds_read_b64_tr_b16 v[76:77], v17 offset:8192
    v_mfma_f32_16x16x32_bf16 v[88:91], v[72:75], v[152:155], v[88:91]
    ds_read_b64_tr_b16 v[78:79], v17 offset:10240
    v_mfma_f32_16x16x32_bf16 v[92:95], v[68:71], v[148:151], v[92:95]
    ds_read_b64_tr_b16 v[64:65], v17 offset:12288
    v_mfma_f32_16x16x32_bf16 v[92:95], v[72:75], v[156:159], v[92:95]
    ds_read_b64_tr_b16 v[66:67], v17 offset:14336
    s_waitcnt lgkmcnt(4)
    v_mfma_f32_16x16x32_bf16 v[88:91], v[96:99], v[160:163], v[88:91]
    s_waitcnt vmcnt(1)
    v_readfirstlane_b32 s97, v46
    s_nop 3
    s_cmp_lt_u32 s97, s87
    s_cbranch_scc1 L_slow_1_5
L_back_1_5:
    s_waitcnt vmcnt(0)
    s_barrier
    ds_read_b64_tr_b16 v[68:69], v17 offset:16384
    buffer_atomic_add v4, v3, s[32:35], s84 offen offset:512
    v_mfma_f32_16x16x32_bf16 v[88:91], v[100:103], v[168:171], v[88:91]
    ds_read_b64_tr_b16 v[70:71], v17 offset:18432
    buffer_load_dwordx4 v[32:35], v40, s[32:35], s92 offen sc1
    v_mfma_f32_16x16x32_bf16 v[92:95], v[96:99], v[164:167], v[92:95]
    ds_read_b64_tr_b16 v[72:73], v17 offset:20480
    buffer_load_dwordx4 v[112:115], v2, s[32:35], s77 offen sc1
    v_mfma_f32_16x16x32_bf16 v[92:95], v[100:103], v[172:175], v[92:95]
    ds_read_b64_tr_b16 v[74:75], v17 offset:22528
    s_waitcnt lgkmcnt(4)
    v_mfma_f32_16x16x32_bf16 v[88:91], v[76:79], v[184:187], v[88:91]
    ds_read_b64_tr_b16 v[96:97], v17 offset:40960
    v_mfma_f32_16x16x32_bf16 v[88:91], v[64:67], v[192:195], v[88:91]
    ds_read_b64_tr_b16 v[98:99], v17 offset:43008
    v_mfma_f32_16x16x32_bf16 v[92:95], v[76:79], v[188:191], v[92:95]
    ds_read_b64_tr_b16 v[100:101], v17 offset:45056
    v_mfma_f32_16x16x32_bf16 v[92:95], v[64:67], v[196:199], v[92:95]
    ds_read_b64_tr_b16 v[102:103], v17 offset:47104
    s_waitcnt lgkmcnt(4)
    v_mfma_f32_16x16x32_bf16 v[88:91], v[68:71], v[200:203], v[88:91]
    ds_read_b64_tr_b16 v[76:77], v19 offset:0
    v_mfma_f32_16x16x32_bf16 v[88:91], v[72:75], v[208:211], v[88:91]
    ds_read_b64_tr_b16 v[78:79], v19 offset:2048
    v_mfma_f32_16x16x32_bf16 v[92:95], v[68:71], v[204:207], v[92:95]
    ds_read_b64_tr_b16 v[64:65], v19 offset:4096
    v_mfma_f32_16x16x32_bf16 v[92:95], v[72:75], v[212:215], v[92:95]
    ds_read_b64_tr_b16 v[66:67], v19 offset:6144
    buffer_load_dwordx4 v[116:119], v2, s[32:35], s77 offen offset:1024 sc1
    s_waitcnt lgkmcnt(4)
    v_mfma_f32_16x16x32_bf16 v[88:91], v[96:99], v[216:219], v[88:91]
    ds_read_b64_tr_b16 v[68:69], v18 offset:0
    buffer_load_dwordx4 v[120:123], v2, s[32:35], s78 offen sc1
    v_mfma_f32_16x16x32_bf16 v[88:91], v[100:103], v[224:227], v[88:91]
    ds_read_b64_tr_b16 v[70:71], v18 offset:2048
    v_mfma_f32_16x16x32_bf16 v[92:95], v[96:99], v[220:223], v[92:95]
    ds_read_b64_tr_b16 v[72:73], v18 offset:4096
    v_mfma_f32_16x16x32_bf16 v[92:95], v[100:103], v[228:231], v[92:95]
    ds_read_b64_tr_b16 v[74:75], v18 offset:6144
    s_waitcnt lgkmcnt(4)
    v_mfma_f32_16x16x32_bf16 v[88:91], v[76:79], v[232:235], v[88:91]
    v_mfma_f32_16x16x32_bf16 v[88:91], v[64:67], v[240:243], v[88:91]
    v_mfma_f32_16x16x32_bf16 v[92:95], v[76:79], v[236:239], v[92:95]
    v_mfma_f32_16x16x32_bf16 v[92:95], v[64:67], v[244:247], v[92:95]
    s_waitcnt lgkmcnt(0)
    v_mfma_f32_16x16x32_bf16 v[88:91], v[68:71], v[176:179], v[88:91]
    v_mfma_f32_16x16x32_bf16 v[88:91], v[72:75], v[248:251], v[88:91]
    buffer_load_dwordx4 v[124:127], v2, s[32:35], s78 offen offset:1024 sc1
    v_mfma_f32_16x16x32_bf16 v[92:95], v[68:71], v[180:183], v[92:95]
    v_mfma_f32_16x16x32_bf16 v[92:95], v[72:75], v[252:255], v[92:95]
    v_lshlrev_b32 v60, 16, v42
    v_and_b32 v61, s3, v42
    v_lshlrev_b32 v62, 16, v43
    v_and_b32 v63, s3, v43
    s_nop 0
    v_add_f32 v88, v88, v60
    v_add_f32 v89, v89, v61
    v_add_f32 v90, v90, v62
    v_add_f32 v91, v91, v63
    v_add_f32 v92, v92, v60
    v_add_f32 v93, v93, v61
    v_add_f32 v94, v94, v62
    v_add_f32 v95, v95, v63
    s_waitcnt vmcnt(4)
    v_lshlrev_b32 v64, 16, v32
    v_and_b32 v65, s3, v32
    v_lshlrev_b32 v66, 16, v33
    v_and_b32 v67, s3, v33
    v_lshlrev_b32 v68, 16, v34
    v_and_b32 v69, s3, v34
    v_lshlrev_b32 v70, 16, v35
    v_and_b32 v71, s3, v35
    v_permlane32_swap_b32 v64, v68
    v_permlane32_swap_b32 v65, v69
    v_permlane32_swap_b32 v66, v70
    v_permlane32_swap_b32 v67, v71
    v_add_f32 v64, v64, v68
    v_add_f32 v65, v65, v69
    v_add_f32 v66, v66, v70
    v_add_f32 v67, v67, v71
    s_nop 0
    v_permlane16_swap_b32 v64, v66
    v_permlane16_swap_b32 v65, v67
    v_add_f32 v64, v64, v66
    v_add_f32 v65, v65, v67
    s_nop 0
    v_add_f32_dpp v66, v64, v64 row_ror:8 row_mask:0xf bank_mask:0xf
    v_add_f32_dpp v67, v65, v65 row_ror:8 row_mask:0xf bank_mask:0xf
    v_lshlrev_b32 v64, 16, v45
    v_and_b32 v65, s3, v45
    v_add_f32 v64, v64, v66
    v_add_f32 v65, v65, v67
    v_cvt_pk_bf16_f32 v64, v64, v65
    buffer_store_dword v64, v44, s[8:11], s95 offen
    buffer_load_dword v46, v3, s[32:35], s84 offen offset:512 sc1
    s_waitcnt vmcnt(0)
    v_readfirstlane_b32 s97, v46
    s_nop 3
    s_cmp_lt_u32 s97, s87
    s_cbranch_scc1 L_slow_1_6
L_back_1_6:
    s_barrier
    buffer_load_dwordx4 v[128:131], v2, s[32:35], s79 offen sc1
    buffer_load_dwordx4 v[132:135], v2, s[32:35], s79 offen offset:1024 sc1
    buffer_load_dwordx4 v[36:39], v2, s[32:35], s76 offen sc1
    v_lshlrev_b32 v6, 16, v112
    v_and_b32 v112, s3, v112
    v_add_f32 v88, v88, v6
    v_add_f32 v89, v89, v112
    v_lshlrev_b32 v6, 16, v113
    v_and_b32 v113, s3, v113
    v_add_f32 v90, v90, v6
    v_add_f32 v91, v91, v113
    v_lshlrev_b32 v6, 16, v114
    v_and_b32 v114, s3, v114
    v_add_f32 v92, v92, v6
    v_add_f32 v93, v93, v114
    v_lshlrev_b32 v6, 16, v115
    v_and_b32 v115, s3, v115
    v_add_f32 v94, v94, v6
    v_add_f32 v95, v95, v115
    v_lshlrev_b32 v6, 16, v116
    v_and_b32 v116, s3, v116
    v_add_f32 v88, v88, v6
    v_add_f32 v89, v89, v116
    v_lshlrev_b32 v6, 16, v117
    v_and_b32 v117, s3, v117
    v_add_f32 v90, v90, v6
    v_add_f32 v91, v91, v117
    v_lshlrev_b32 v6, 16, v118
    v_and_b32 v118, s3, v118
    v_add_f32 v92, v92, v6
    v_add_f32 v93, v93, v118
    v_lshlrev_b32 v6, 16, v119
    v_and_b32 v119, s3, v119
    v_add_f32 v94, v94, v6
    v_add_f32 v95, v95, v119
    v_lshlrev_b32 v6, 16, v120
    v_and_b32 v120, s3, v120
    v_add_f32 v88, v88, v6
    v_add_f32 v89, v89, v120
    v_lshlrev_b32 v6, 16, v121
    v_and_b32 v121, s3, v121
    v_add_f32 v90, v90, v6
    v_add_f32 v91, v91, v121
    v_lshlrev_b32 v6, 16, v122
    v_and_b32 v122, s3, v122
    v_add_f32 v92, v92, v6
    v_add_f32 v93, v93, v122
    v_lshlrev_b32 v6, 16, v123
    v_and_b32 v123, s3, v123
    v_add_f32 v94, v94, v6
    v_add_f32 v95, v95, v123
    v_lshlrev_b32 v6, 16, v124
    v_and_b32 v124, s3, v124
    v_add_f32 v88, v88, v6
    v_add_f32 v89, v89, v124
    v_lshlrev_b32 v6, 16, v125
    v_and_b32 v125, s3, v125
    v_add_f32 v90, v90, v6
    v_add_f32 v91, v91, v125
    v_lshlrev_b32 v6, 16, v126
    v_and_b32 v126, s3, v126
    v_add_f32 v92, v92, v6
    v_add_f32 v93, v93, v126
    v_lshlrev_b32 v6, 16, v127
    v_and_b32 v127, s3, v127
    v_add_f32 v94, v94, v6
    v_add_f32 v95, v95, v127
    s_waitcnt vmcnt(1)
    v_lshlrev_b32 v6, 16, v128
    v_and_b32 v128, s3, v128
    v_add_f32 v88, v88, v6
    v_add_f32 v89, v89, v128
    v_lshlrev_b32 v6, 16, v129
    v_and_b32 v129, s3, v129
    v_add_f32 v90, v90, v6
    v_add_f32 v91, v91, v129
    v_lshlrev_b32 v6, 16, v130
    v_and_b32 v130, s3, v130
    v_add_f32 v92, v92, v6
    v_add_f32 v93, v93, v130
    v_lshlrev_b32 v6, 16, v131
    v_and_b32 v131, s3, v131
    v_add_f32 v94, v94, v6
    v_add_f32 v95, v95, v131
    v_lshlrev_b32 v6, 16, v132
    v_and_b32 v132, s3, v132
    v_add_f32 v88, v88, v6
    v_add_f32 v89, v89, v132
    v_lshlrev_b32 v6, 16, v133
    v_and_b32 v133, s3, v133
    v_add_f32 v90, v90, v6
    v_add_f32 v91, v91, v133
    v_lshlrev_b32 v6, 16, v134
    v_and_b32 v134, s3, v134
    v_add_f32 v92, v92, v6
    v_add_f32 v93, v93, v134
    v_lshlrev_b32 v6, 16, v135
    v_and_b32 v135, s3, v135
    v_add_f32 v94, v94, v6
    v_add_f32 v95, v95, v135
    s_waitcnt vmcnt(0)
    v_lshlrev_b32 v6, 16, v36
    v_and_b32 v36, s3, v36
    v_add_f32 v88, v88, v6
    v_add_f32 v89, v89, v36
    v_lshlrev_b32 v6, 16, v37
    v_and_b32 v37, s3, v37
    v_add_f32 v90, v90, v6
    v_add_f32 v91, v91, v37
    v_lshlrev_b32 v6, 16, v38
    v_and_b32 v38, s3, v38
    v_add_f32 v92, v92, v6
    v_add_f32 v93, v93, v38
    v_lshlrev_b32 v6, 16, v39
    v_and_b32 v39, s3, v39
    v_add_f32 v94, v94, v6
    v_add_f32 v95, v95, v39
    v_cvt_pk_bf16_f32 v56, v88, v89
    v_cvt_pk_bf16_f32 v57, v90, v91
    v_cvt_pk_bf16_f32 v58, v92, v93
    v_cvt_pk_bf16_f32 v59, v94, v95
    s_nop 0
    v_permlane16_swap_b32 v56, v58
    v_permlane16_swap_b32 v57, v59
    buffer_store_dwordx4 v[56:59], v41, s[8:11], s94 offen
    s_endpgm
L_slow_1_1:
    s_mov_b32 s93, 1000000
L_spin_1_1:
    s_lshl_b32 s96, s42, 2
    buffer_load_dword v46, v3, s[36:39], s96 offen sc1
    s_waitcnt vmcnt(0)
    v_readfirstlane_b32 s97, v46
    s_nop 3
    s_cmp_lt_u32 s97, 1
    s_cbranch_scc0 L_back_1_1
    s_sub_u32 s93, s93, 1
    s_cmp_lg_u32 s93, 0
    s_cbranch_scc1 L_spin_1_1
    s_branch L_back_1_1
L_slow_1_2:
    s_mov_b32 s93, 1000000
L_spin_1_2:
    buffer_load_dword v46, v3, s[32:35], s86 offen sc1
    s_waitcnt vmcnt(0)
    v_readfirstlane_b32 s97, v46
    s_nop 3
    s_cmp_lt_u32 s97, s88
    s_cbranch_scc0 L_back_1_2
    s_sub_u32 s93, s93, 1
    s_cmp_lg_u32 s93, 0
    s_cbranch_scc1 L_spin_1_2
    s_branch L_back_1_2
L_slow_1_3:
    s_mov_b32 s93, 1000000
L_spin_1_3:
    buffer_load_dword v46, v3, s[32:35], s86 offen offset:256 sc1
    s_waitcnt vmcnt(0)
    v_readfirstlane_b32 s97, v46
    s_nop 3
    s_cmp_lt_u32 s97, s88
    s_cbranch_scc0 L_back_1_3
    s_sub_u32 s93, s93, 1
    s_cmp_lg_u32 s93, 0
    s_cbranch_scc1 L_spin_1_3
    s_branch L_back_1_3
L_slow_1_4:
    s_mov_b32 s93, 1000000
L_spin_1_4:
    buffer_load_dword v46, v3, s[32:35], s86 offen offset:512 sc1
    s_waitcnt vmcnt(0)
    v_readfirstlane_b32 s97, v46
    s_nop 3
    s_cmp_lt_u32 s97, s88
    s_cbranch_scc0 L_back_1_4
    s_sub_u32 s93, s93, 1
    s_cmp_lg_u32 s93, 0
    s_cbranch_scc1 L_spin_1_4
    s_branch L_back_1_4
L_slow_1_5:
    s_mov_b32 s93, 1000000
L_spin_1_5:
    buffer_load_dword v46, v3, s[32:35], s84 offen sc1
    s_waitcnt vmcnt(0)
    v_readfirstlane_b32 s97, v46
    s_nop 3
    s_cmp_lt_u32 s97, s87
    s_cbranch_scc0 L_back_1_5
    s_sub_u32 s93, s93, 1
    s_cmp_lg_u32 s93, 0
    s_cbranch_scc1 L_spin_1_5
    s_branch L_back_1_5
L_slow_1_6:
    s_mov_b32 s93, 1000000
L_spin_1_6:
    buffer_load_dword v46, v3, s[32:35], s84 offen offset:512 sc1
    s_waitcnt vmcnt(0)
    v_readfirstlane_b32 s97, v46
    s_nop 3
    s_cmp_lt_u32 s97, s87
    s_cbranch_scc0 L_back_1_6
    s_sub_u32 s93, s93, 1
    s_cmp_lg_u32 s93, 0
    s_cbranch_scc1 L_spin_1_6
    s_branch L_back_1_6
L_main_end:
    s_endpgm

.section .rodata,"a"
.p2align 6
.amdhsa_kernel standalone__dense_activation_gelu__prompt_kernel
  .amdhsa_next_free_vgpr 256
  .amdhsa_next_free_sgpr 102
  .amdhsa_accum_offset 256
  .amdhsa_group_segment_fixed_size 0
  .amdhsa_kernarg_size 64
  .amdhsa_user_sgpr_count 2
  .amdhsa_user_sgpr_kernarg_segment_ptr 1
  .amdhsa_system_sgpr_workgroup_id_x 1
  .amdhsa_float_denorm_mode_32 3
.end_amdhsa_kernel
```
